```python
import torch

def _softmax(x, axis=-1):
    return torch.softmax(x, dim=axis)
def _gelu(x):
    return torch.nn.functional.gelu(x, approximate="tanh")
def _silu(x):
    return torch.nn.functional.silu(x)
def _sigmoid(x):
    return torch.sigmoid(x)
def _layernorm(x, axis=-1, eps=1e-5):
    m = x.mean(dim=axis, keepdim=True)
    v = x.var(dim=axis, keepdim=True, unbiased=False)
    return (x - m) / torch.sqrt(v + eps)
def _scatter_add(tgt, idx, src, axis=0):
    return tgt.clone().index_add_(axis, idx, src)
def _segment_sum(src, seg, n):
    out = torch.zeros((n,) + src.shape[1:], dtype=src.dtype)
    return out.index_add_(0, seg, src)
def _pad(x, pw):
    flat = tuple(v for pair in reversed(pw) for v in pair)
    return torch.nn.functional.pad(x, flat)

kernel_name = 'recurrent_scan__spectral_fnet__dense_activation_silu__prompt'

def setup_inputs():

    _w = (lambda a: (lambda t: t.to(torch.bfloat16) if t.is_floating_point() else t)(torch.as_tensor(a)))
    def _A_setup():
        B, S, D = 1, 2048, 1024
        ns = torch.arange(S)[:, None] * torch.arange(S)[None, :]
        nd = torch.arange(D)[:, None] * torch.arange(D)[None, :]
        Ws_re = torch.cos(-2.0 * torch.pi * ns / S).to(float)
        Ws_im = torch.sin(-2.0 * torch.pi * ns / S).to(float)
        Wd_re = torch.cos(-2.0 * torch.pi * nd / D).to(float)
        Wd_im = torch.sin(-2.0 * torch.pi * nd / D).to(float)
        return {
            "x": _w((lambda *s: torch.randn(*s, dtype=torch.bfloat16) * 0.05)(B, S, D)),
            "dft_seq_re": _w(Ws_re),
            "dft_seq_im": _w(Ws_im),
            "dft_hid_re": _w(Wd_re),
            "dft_hid_im": _w(Wd_im),
        }
    _A_in = _A_setup()

    def _B_setup():
        B, S, D, F = 1, 2048, 1024, 3584
        return {
            "x": _w((lambda *s: torch.randn(*s, dtype=torch.bfloat16) * 0.05)(B, S, D)),
            "w1": _w((lambda *s: torch.randn(*s, dtype=torch.bfloat16) * 0.4)(D, F) * (D ** -0.5)),
            "w2": _w((lambda *s: torch.randn(*s, dtype=torch.bfloat16) * 0.05)(F, D) * (F ** -0.5)),
        }
    _B_in = _B_setup()

    return {
        "A_x": _A_in["x"],
        "A_dft_seq_re": _A_in["dft_seq_re"],
        "A_dft_seq_im": _A_in["dft_seq_im"],
        "A_dft_hid_re": _A_in["dft_hid_re"],
        "A_dft_hid_im": _A_in["dft_hid_im"],
        "B_x": _B_in["x"],
        "B_w1": _B_in["w1"],
        "B_w2": _B_in["w2"],
    }

def reference(A_x, A_dft_seq_re, A_dft_seq_im, A_dft_hid_re, A_dft_hid_im, B_x, B_w1, B_w2):
    def _A_ref(x, dft_seq_re, dft_seq_im, dft_hid_re, dft_hid_im):
        a = torch.einsum("bsd,ed->bse", x, dft_hid_re)
        b = torch.einsum("bsd,ed->bse", x, dft_hid_im)
        y = torch.einsum("ts,bse->bte", dft_seq_re, a) - torch.einsum("ts,bse->bte", dft_seq_im, b)
        return y

    def _B_ref(x, w1, w2):
        h = torch.einsum("bsd,df->bsf", x, w1)
        h = _silu(h)
        out = torch.einsum("bsf,fd->bsd", h, w2)
        return out

    x = A_x
    xn = _layernorm(x, axis=-1)
    s = _A_ref(xn, A_dft_seq_re, A_dft_seq_im, A_dft_hid_re, A_dft_hid_im)
    g = _silu(_B_ref(xn, B_w1, B_w2))
    return x + s * g
```

```asm
; @launch grid=(256,1,1) block=(512,1,1) lds=163840
.amdgcn_target "amdgcn-amd-amdhsa--gfx950"
.text
.globl recurrent_scan__spectral_fnet__dense_activation_silu__prompt_kernel
.p2align 8
.type recurrent_scan__spectral_fnet__dense_activation_silu__prompt_kernel,@function
recurrent_scan__spectral_fnet__dense_activation_silu__prompt_kernel:
    s_cmp_ge_u32 s2, 256
    s_cbranch_scc1 L_end
    s_getpc_b64 s[96:97]
L_pc:
    s_lshr_b32 s98, s2, 3
    s_lshl_b32 s98, s98, 13
    v_lshl_add_u32 v2, v0, 4, s98
    v_cmp_gt_u32 vcc, L_end-L_pc, v2
    s_and_saveexec_b64 s[98:99], vcc
    s_cbranch_execz L_nocpf
    global_load_dwordx4 v[244:247], v2, s[96:97]
L_nocpf:
    s_mov_b64 exec, -1
    s_load_dwordx16 s[16:31], s[0:1], 0
    s_load_dwordx4 s[32:35], s[0:1], 64
    s_load_dwordx2 s[36:37], s[0:1], 80
    v_lshrrev_b32 v1, 6, v0
    v_and_b32 v3, 63, v0
    s_and_b32 s4, s2, 7
    s_lshr_b32 s5, s2, 3
    v_readfirstlane_b32 s3, v1
    s_and_b32 s6, s4, 1
    s_lshl_b32 s6, s6, 3
    s_and_b32 s7, s5, 7
    s_add_u32 s6, s6, s7
    s_lshr_b32 s7, s4, 1
    s_lshl_b32 s7, s7, 2
    s_lshr_b32 s8, s5, 3
    s_add_u32 s7, s7, s8
    s_lshl_b32 s8, s4, 5
    s_add_u32 s8, s8, s5
    s_mov_b32 s9, s6
    s_lshr_b32 s11, s7, 3
    s_and_b32 s10, s7, 7
    s_mov_b32 s80, 0xbfb8aa3b
    s_mov_b32 s81, 0xbfb8aa3b
    s_mov_b32 s82, 0xffff0000
    s_lshr_b32 s38, s8, 1
    s_and_b32 s39, s8, 1
    v_lshlrev_b32 v26, 18, v1
    v_and_b32 v27, 31, v3
    v_lshl_add_u32 v26, v27, 3, v26
    v_lshrrev_b32 v27, 5, v3
    v_lshl_add_u32 v26, v27, 9, v26
    s_lshl_b32 s95, s38, 11
    v_add_u32 v26, s95, v26
    s_lshl_b32 s95, s39, 8
    v_add_u32 v26, s95, v26
    v_xor_b32 v27, 0x100, v26
    v_mov_b32 v28, 159744
    v_mov_b32 v29, 0
    ds_write_b32 v28, v29
    s_waitcnt lgkmcnt(0)
    s_mov_b32 s68, s16
    s_mov_b32 s69, s17
    s_mov_b32 s70, 0x400000
    s_mov_b32 s71, 0x20000
    s_cmp_ge_u32 s3, 4
    s_cbranch_scc1 L_nox
    s_mov_b32 s95, 0x0
    buffer_load_dwordx2 v[32:33], v26, s[68:71], s95 offen offset:0
    buffer_load_dwordx2 v[34:35], v26, s[68:71], s95 offen offset:1024
    buffer_load_dwordx2 v[36:37], v27, s[68:71], s95 offen offset:0
    buffer_load_dwordx2 v[38:39], v27, s[68:71], s95 offen offset:1024
    s_mov_b32 s95, 0x100000
    buffer_load_dwordx2 v[76:77], v26, s[68:71], s95 offen offset:0
    buffer_load_dwordx2 v[78:79], v26, s[68:71], s95 offen offset:1024
    buffer_load_dwordx2 v[80:81], v27, s[68:71], s95 offen offset:0
    buffer_load_dwordx2 v[82:83], v27, s[68:71], s95 offen offset:1024
    s_mov_b32 s95, 0x200000
    buffer_load_dwordx2 v[240:241], v26, s[68:71], s95 offen offset:0
    buffer_load_dwordx2 v[242:243], v26, s[68:71], s95 offen offset:1024
    buffer_load_dwordx2 v[244:245], v27, s[68:71], s95 offen offset:0
    buffer_load_dwordx2 v[246:247], v27, s[68:71], s95 offen offset:1024
    s_mov_b32 s95, 0x300000
    buffer_load_dwordx2 v[120:121], v26, s[68:71], s95 offen offset:0
    buffer_load_dwordx2 v[122:123], v26, s[68:71], s95 offen offset:1024
    buffer_load_dwordx2 v[124:125], v27, s[68:71], s95 offen offset:0
    buffer_load_dwordx2 v[126:127], v27, s[68:71], s95 offen offset:1024
L_nox:
    s_mov_b32 s40, s36
    s_mov_b32 s41, s37
    s_mov_b32 s42, 0x10000000
    s_mov_b32 s43, 0x20000
    s_mov_b32 s44, s28
    s_mov_b32 s45, s29
    s_mov_b32 s46, 0x700000
    s_mov_b32 s47, 0x20000
    s_mov_b32 s48, s22
    s_mov_b32 s49, s23
    s_mov_b32 s50, 0x200000
    s_mov_b32 s51, 0x20000
    s_mov_b32 s52, s24
    s_mov_b32 s53, s25
    s_mov_b32 s54, 0x200000
    s_mov_b32 s55, 0x20000
    s_mov_b32 s56, s30
    s_mov_b32 s57, s31
    s_mov_b32 s58, 0x700000
    s_mov_b32 s59, 0x20000
    s_mov_b32 s60, s18
    s_mov_b32 s61, s19
    s_mov_b32 s62, 0x800000
    s_mov_b32 s63, 0x20000
    s_mov_b32 s64, s20
    s_mov_b32 s65, s21
    s_mov_b32 s66, 0x800000
    s_mov_b32 s67, 0x20000
    s_mov_b32 s72, s32
    s_mov_b32 s73, s33
    s_mov_b32 s74, 0x400000
    s_mov_b32 s75, 0x20000
    s_mov_b32 s26, s38
    s_mov_b32 s27, s39
    s_lshl_b32 s28, s6, 4
    s_add_u32 s28, s28, s7
    s_lshr_b32 s95, s28, 3
    s_lshl_b32 s95, s95, 9
    s_lshl_b32 s28, s10, 2
    s_add_u32 s28, s28, s3
    s_lshl_b32 s28, s28, 2
    s_and_b32 s28, s28, 127
    s_add_u32 s28, s28, s95
    s_add_u32 s28, s28, 0x60000
    s_lshl_b32 s39, s10, 1
    s_load_dword s38, s[36:37], 0x58000
    s_cmp_ge_u32 s3, 4
    s_cbranch_scc1 L_loader
    s_lshr_b32 s12, s3, 1
    s_and_b32 s13, s3, 1
    s_lshl_b32 s16, s2, 15
    s_lshl_b32 s17, s3, 13
    s_add_u32 s16, s16, s17
    s_add_u32 s16, s16, 0x1c00000
    v_lshlrev_b32 v24, 4, v3
    v_add_u32 v24, s16, v24
    v_add_u32 v25, 4096, v24
    s_lshl_b32 s16, s12, 13
    v_and_b32 v4, 15, v3
    v_lshlrev_b32 v4, 7, v4
    v_lshrrev_b32 v5, 4, v3
    v_bfe_u32 v2, v3, 1, 3
    v_xor_b32 v5, v5, v2
    v_lshl_add_u32 v4, v5, 4, v4
    v_add_u32 v4, s16, v4
    v_xor_b32 v5, 64, v4
    s_lshl_b32 s16, s13, 13
    s_add_u32 s16, s16, 16384
    v_and_b32 v14, 15, v3
    v_lshlrev_b32 v14, 7, v14
    v_lshrrev_b32 v15, 4, v3
    v_bfe_u32 v2, v3, 1, 3
    v_xor_b32 v15, v15, v2
    v_lshl_add_u32 v14, v15, 4, v14
    v_add_u32 v14, s16, v14
    v_xor_b32 v15, 64, v14
    v_lshrrev_b32 v18, 4, v3
    v_bfe_u32 v17, v3, 2, 2
    v_lshl_add_u32 v17, v18, 3, v17
    v_mul_u32_u24 v17, 448, v17
    v_and_b32 v19, 3, v3
    v_lshl_add_u32 v17, v19, 3, v17
    v_and_b32 v19, 1, v18
    v_lshlrev_b32 v19, 5, v19
    s_lshl_b32 s16, s13, 6
    s_add_u32 s16, s16, 16384
    v_add_u32 v20, s16, v17
    v_add_u32 v6, v20, v19
    v_sub_u32 v7, v20, v19
    s_lshl_b32 s16, s13, 5
    v_xor_b32 v20, s16, v19
    v_add_u32 v20, v20, v17
    v_add_u32 v8, 16768, v20
    v_and_b32 v21, 1, v18
    v_lshlrev_b32 v21, 5, v21
    v_lshrrev_b32 v19, 1, v18
    v_lshl_add_u32 v21, v19, 4, v21
    s_lshl_b32 s16, s6, 4
    s_add_u32 s16, s16, s7
    s_mul_i32 s17, s16, 49152
    s_lshl_b32 s18, s13, 13
    s_add_u32 s17, s17, s18
    s_lshl_b32 s18, s12, 12
    s_add_u32 s17, s17, s18
    s_add_u32 s17, s17, 0xd00000
    v_and_b32 v22, 15, v3
    v_lshl_add_u32 v17, v22, 6, v21
    v_add_u32 v17, s17, v17
    s_lshl_b32 s17, s16, 13
    s_lshl_b32 s18, s13, 12
    s_add_u32 s17, s17, s18
    s_lshl_b32 s18, s12, 11
    s_add_u32 s17, s17, s18
    s_add_u32 s17, s17, 0x1900000
    v_and_b32 v20, 1, v18
    v_lshl_add_u32 v20, v20, 4, v22
    v_lshlrev_b32 v20, 5, v20
    v_lshl_add_u32 v20, v19, 4, v20
    v_add_u32 v20, s17, v20
    s_lshl_b32 s17, s13, 7
    s_add_u32 s17, s17, 161792
    v_lshlrev_b32 v26, 4, v18
    v_add_u32 v26, s17, v26
    s_lshl_b32 s17, s13, 6
    s_add_u32 s17, s17, 162560
    v_lshlrev_b32 v27, 4, v18
    v_add_u32 v27, s17, v27
    s_lshl_b32 s17, s12, 9
    s_add_u32 s17, s17, 162816
    v_lshlrev_b32 v28, 3, v22
    v_add_u32 v28, s17, v28
    v_mov_b32 v128, 0
    v_mov_b32 v129, 0
    v_mov_b32 v130, 0
    v_mov_b32 v131, 0
    v_mov_b32 v132, 0
    v_mov_b32 v133, 0
    v_mov_b32 v134, 0
    v_mov_b32 v135, 0
    v_mov_b32 v136, 0
    v_mov_b32 v137, 0
    v_mov_b32 v138, 0
    v_mov_b32 v139, 0
    v_mov_b32 v140, 0
    v_mov_b32 v141, 0
    v_mov_b32 v142, 0
    v_mov_b32 v143, 0
    v_mov_b32 v144, 0
    v_mov_b32 v145, 0
    v_mov_b32 v146, 0
    v_mov_b32 v147, 0
    v_mov_b32 v148, 0
    v_mov_b32 v149, 0
    v_mov_b32 v150, 0
    v_mov_b32 v151, 0
    v_mov_b32 v152, 0
    v_mov_b32 v153, 0
    v_mov_b32 v154, 0
    v_mov_b32 v155, 0
    v_mov_b32 v156, 0
    v_mov_b32 v157, 0
    v_mov_b32 v158, 0
    v_mov_b32 v159, 0
    v_mov_b32 v160, 0
    v_mov_b32 v161, 0
    v_mov_b32 v162, 0
    v_mov_b32 v163, 0
    v_mov_b32 v164, 0
    v_mov_b32 v165, 0
    v_mov_b32 v166, 0
    v_mov_b32 v167, 0
    v_mov_b32 v168, 0
    v_mov_b32 v169, 0
    v_mov_b32 v170, 0
    v_mov_b32 v171, 0
    v_mov_b32 v172, 0
    v_mov_b32 v173, 0
    v_mov_b32 v174, 0
    v_mov_b32 v175, 0
    v_mov_b32 v176, 0
    v_mov_b32 v177, 0
    v_mov_b32 v178, 0
    v_mov_b32 v179, 0
    v_mov_b32 v180, 0
    v_mov_b32 v181, 0
    v_mov_b32 v182, 0
    v_mov_b32 v183, 0
    v_mov_b32 v184, 0
    v_mov_b32 v185, 0
    v_mov_b32 v186, 0
    v_mov_b32 v187, 0
    v_mov_b32 v188, 0
    v_mov_b32 v189, 0
    v_mov_b32 v190, 0
    v_mov_b32 v191, 0
    v_mov_b32 v192, 0
    v_mov_b32 v193, 0
    v_mov_b32 v194, 0
    v_mov_b32 v195, 0
    v_mov_b32 v196, 0
    v_mov_b32 v197, 0
    v_mov_b32 v198, 0
    v_mov_b32 v199, 0
    v_mov_b32 v200, 0
    v_mov_b32 v201, 0
    v_mov_b32 v202, 0
    v_mov_b32 v203, 0
    v_mov_b32 v204, 0
    v_mov_b32 v205, 0
    v_mov_b32 v206, 0
    v_mov_b32 v207, 0
    v_mov_b32 v208, 0
    v_mov_b32 v209, 0
    v_mov_b32 v210, 0
    v_mov_b32 v211, 0
    v_mov_b32 v212, 0
    v_mov_b32 v213, 0
    v_mov_b32 v214, 0
    v_mov_b32 v215, 0
    v_mov_b32 v216, 0
    v_mov_b32 v217, 0
    v_mov_b32 v218, 0
    v_mov_b32 v219, 0
    v_mov_b32 v220, 0
    v_mov_b32 v221, 0
    v_mov_b32 v222, 0
    v_mov_b32 v223, 0
    v_mov_b32 v224, 0
    v_mov_b32 v225, 0
    v_mov_b32 v226, 0
    v_mov_b32 v227, 0
    v_mov_b32 v228, 0
    v_mov_b32 v229, 0
    v_mov_b32 v230, 0
    v_mov_b32 v231, 0
    v_mov_b32 v232, 0
    v_mov_b32 v233, 0
    v_mov_b32 v234, 0
    v_mov_b32 v235, 0
    v_mov_b32 v236, 0
    v_mov_b32 v237, 0
    v_mov_b32 v238, 0
    v_mov_b32 v239, 0
    s_mov_b32 s14, 0
    s_barrier
    v_lshlrev_b32 v31, 8, v1
    v_and_b32 v2, 31, v3
    v_lshl_add_u32 v31, v2, 3, v31
    v_lshrrev_b32 v2, 5, v3
    v_lshl_add_u32 v31, v2, 12, v31
    v_add_u32 v31, 143360, v31
    s_and_b32 s16, s26, 15
    s_lshl_b32 s16, s16, 7
    s_lshr_b32 s17, s26, 4
    s_add_u32 s16, s16, s17
    s_lshl_b32 s17, s3, 3
    s_add_u32 s16, s16, s17
    s_lshl_b32 s16, s16, 3
    s_add_u32 s16, s16, 0x40000
    v_mov_b32 v2, s16
    s_waitcnt vmcnt(8)
    v_lshlrev_b32 v40, 16, v32
    v_lshlrev_b32 v84, 16, v76
    v_and_b32 v41, s82, v32
    v_and_b32 v85, s82, v76
    v_lshlrev_b32 v42, 16, v33
    v_lshlrev_b32 v86, 16, v77
    v_and_b32 v43, s82, v33
    v_and_b32 v87, s82, v77
    v_lshlrev_b32 v44, 16, v34
    v_lshlrev_b32 v88, 16, v78
    v_and_b32 v45, s82, v34
    v_and_b32 v89, s82, v78
    v_lshlrev_b32 v46, 16, v35
    v_lshlrev_b32 v90, 16, v79
    v_and_b32 v47, s82, v35
    v_and_b32 v91, s82, v79
    v_lshlrev_b32 v48, 16, v36
    v_lshlrev_b32 v92, 16, v80
    v_and_b32 v49, s82, v36
    v_and_b32 v93, s82, v80
    v_lshlrev_b32 v50, 16, v37
    v_lshlrev_b32 v94, 16, v81
    v_and_b32 v51, s82, v37
    v_and_b32 v95, s82, v81
    v_lshlrev_b32 v52, 16, v38
    v_lshlrev_b32 v96, 16, v82
    v_and_b32 v53, s82, v38
    v_and_b32 v97, s82, v82
    v_lshlrev_b32 v54, 16, v39
    v_lshlrev_b32 v98, 16, v83
    v_and_b32 v55, s82, v39
    v_and_b32 v99, s82, v83
    v_pk_add_f32 v[56:57], v[40:41], v[42:43]
    v_pk_add_f32 v[100:101], v[84:85], v[86:87]
    v_pk_add_f32 v[58:59], v[44:45], v[46:47]
    v_pk_add_f32 v[102:103], v[88:89], v[90:91]
    v_pk_add_f32 v[60:61], v[48:49], v[50:51]
    v_pk_add_f32 v[104:105], v[92:93], v[94:95]
    v_pk_add_f32 v[62:63], v[52:53], v[54:55]
    v_pk_add_f32 v[106:107], v[96:97], v[98:99]
    v_pk_add_f32 v[56:57], v[56:57], v[58:59]
    v_pk_add_f32 v[100:101], v[100:101], v[102:103]
    v_pk_add_f32 v[60:61], v[60:61], v[62:63]
    v_pk_add_f32 v[104:105], v[104:105], v[106:107]
    v_pk_add_f32 v[56:57], v[56:57], v[60:61]
    v_pk_add_f32 v[100:101], v[100:101], v[104:105]
    v_add_f32 v56, v56, v57
    v_add_f32 v100, v100, v101
    s_nop 0
    s_nop 0
    v_add_f32_dpp v56, v56, v56 quad_perm:[1,0,3,2] row_mask:0xf bank_mask:0xf
    v_add_f32_dpp v100, v100, v100 quad_perm:[1,0,3,2] row_mask:0xf bank_mask:0xf
    s_nop 0
    s_nop 0
    v_add_f32_dpp v56, v56, v56 quad_perm:[2,3,0,1] row_mask:0xf bank_mask:0xf
    v_add_f32_dpp v100, v100, v100 quad_perm:[2,3,0,1] row_mask:0xf bank_mask:0xf
    s_nop 0
    s_nop 0
    v_add_f32_dpp v56, v56, v56 row_half_mirror row_mask:0xf bank_mask:0xf
    v_add_f32_dpp v100, v100, v100 row_half_mirror row_mask:0xf bank_mask:0xf
    s_nop 0
    s_nop 0
    v_add_f32_dpp v56, v56, v56 row_mirror row_mask:0xf bank_mask:0xf
    v_add_f32_dpp v100, v100, v100 row_mirror row_mask:0xf bank_mask:0xf
    s_nop 0
    s_nop 0
    v_add_f32_dpp v56, v56, v56 row_bcast:15 row_mask:0xa bank_mask:0xf
    v_add_f32_dpp v100, v100, v100 row_bcast:15 row_mask:0xa bank_mask:0xf
    s_nop 0
    s_nop 0
    v_add_f32_dpp v56, v56, v56 row_bcast:31 row_mask:0xc bank_mask:0xf
    v_add_f32_dpp v100, v100, v100 row_bcast:31 row_mask:0xc bank_mask:0xf
    s_nop 0
    s_nop 0
    v_readlane_b32 s21, v56, 63
    v_readlane_b32 s24, v100, 63
    s_nop 0
    s_nop 0
    v_mov_b32 v64, 0x3a800000
    v_mov_b32 v108, 0x3a800000
    v_mul_f32 v64, s21, v64
    v_mul_f32 v108, s24, v108
    v_pk_add_f32 v[68:69], v[40:41], v[64:65] op_sel_hi:[1,0] neg_lo:[0,1] neg_hi:[0,1]
    v_pk_add_f32 v[112:113], v[84:85], v[108:109] op_sel_hi:[1,0] neg_lo:[0,1] neg_hi:[0,1]
    v_pk_add_f32 v[70:71], v[42:43], v[64:65] op_sel_hi:[1,0] neg_lo:[0,1] neg_hi:[0,1]
    v_pk_add_f32 v[114:115], v[86:87], v[108:109] op_sel_hi:[1,0] neg_lo:[0,1] neg_hi:[0,1]
    v_pk_add_f32 v[72:73], v[44:45], v[64:65] op_sel_hi:[1,0] neg_lo:[0,1] neg_hi:[0,1]
    v_pk_add_f32 v[116:117], v[88:89], v[108:109] op_sel_hi:[1,0] neg_lo:[0,1] neg_hi:[0,1]
    v_pk_add_f32 v[74:75], v[46:47], v[64:65] op_sel_hi:[1,0] neg_lo:[0,1] neg_hi:[0,1]
    v_pk_add_f32 v[118:119], v[90:91], v[108:109] op_sel_hi:[1,0] neg_lo:[0,1] neg_hi:[0,1]
    v_pk_mul_f32 v[56:57], v[68:69], v[68:69]
    v_pk_mul_f32 v[100:101], v[112:113], v[112:113]
    v_pk_mul_f32 v[58:59], v[70:71], v[70:71]
    v_pk_mul_f32 v[102:103], v[114:115], v[114:115]
    v_pk_fma_f32 v[56:57], v[72:73], v[72:73], v[56:57]
    v_pk_fma_f32 v[100:101], v[116:117], v[116:117], v[100:101]
    v_pk_fma_f32 v[58:59], v[74:75], v[74:75], v[58:59]
    v_pk_fma_f32 v[102:103], v[118:119], v[118:119], v[102:103]
    v_pk_add_f32 v[68:69], v[48:49], v[64:65] op_sel_hi:[1,0] neg_lo:[0,1] neg_hi:[0,1]
    v_pk_add_f32 v[112:113], v[92:93], v[108:109] op_sel_hi:[1,0] neg_lo:[0,1] neg_hi:[0,1]
    v_pk_add_f32 v[70:71], v[50:51], v[64:65] op_sel_hi:[1,0] neg_lo:[0,1] neg_hi:[0,1]
    v_pk_add_f32 v[114:115], v[94:95], v[108:109] op_sel_hi:[1,0] neg_lo:[0,1] neg_hi:[0,1]
    v_pk_add_f32 v[72:73], v[52:53], v[64:65] op_sel_hi:[1,0] neg_lo:[0,1] neg_hi:[0,1]
    v_pk_add_f32 v[116:117], v[96:97], v[108:109] op_sel_hi:[1,0] neg_lo:[0,1] neg_hi:[0,1]
    v_pk_add_f32 v[74:75], v[54:55], v[64:65] op_sel_hi:[1,0] neg_lo:[0,1] neg_hi:[0,1]
    v_pk_add_f32 v[118:119], v[98:99], v[108:109] op_sel_hi:[1,0] neg_lo:[0,1] neg_hi:[0,1]
    v_pk_fma_f32 v[56:57], v[68:69], v[68:69], v[56:57]
    v_pk_fma_f32 v[100:101], v[112:113], v[112:113], v[100:101]
    v_pk_fma_f32 v[58:59], v[70:71], v[70:71], v[58:59]
    v_pk_fma_f32 v[102:103], v[114:115], v[114:115], v[102:103]
    v_pk_fma_f32 v[56:57], v[72:73], v[72:73], v[56:57]
    v_pk_fma_f32 v[100:101], v[116:117], v[116:117], v[100:101]
    v_pk_fma_f32 v[58:59], v[74:75], v[74:75], v[58:59]
    v_pk_fma_f32 v[102:103], v[118:119], v[118:119], v[102:103]
    v_pk_add_f32 v[56:57], v[56:57], v[58:59]
    v_pk_add_f32 v[100:101], v[100:101], v[102:103]
    v_add_f32 v56, v56, v57
    v_add_f32 v100, v100, v101
    s_nop 0
    s_nop 0
    v_add_f32_dpp v56, v56, v56 quad_perm:[1,0,3,2] row_mask:0xf bank_mask:0xf
    v_add_f32_dpp v100, v100, v100 quad_perm:[1,0,3,2] row_mask:0xf bank_mask:0xf
    s_nop 0
    s_nop 0
    v_add_f32_dpp v56, v56, v56 quad_perm:[2,3,0,1] row_mask:0xf bank_mask:0xf
    v_add_f32_dpp v100, v100, v100 quad_perm:[2,3,0,1] row_mask:0xf bank_mask:0xf
    s_nop 0
    s_nop 0
    v_add_f32_dpp v56, v56, v56 row_half_mirror row_mask:0xf bank_mask:0xf
    v_add_f32_dpp v100, v100, v100 row_half_mirror row_mask:0xf bank_mask:0xf
    s_nop 0
    s_nop 0
    v_add_f32_dpp v56, v56, v56 row_mirror row_mask:0xf bank_mask:0xf
    v_add_f32_dpp v100, v100, v100 row_mirror row_mask:0xf bank_mask:0xf
    s_nop 0
    s_nop 0
    v_add_f32_dpp v56, v56, v56 row_bcast:15 row_mask:0xa bank_mask:0xf
    v_add_f32_dpp v100, v100, v100 row_bcast:15 row_mask:0xa bank_mask:0xf
    s_nop 0
    s_nop 0
    v_add_f32_dpp v56, v56, v56 row_bcast:31 row_mask:0xc bank_mask:0xf
    v_add_f32_dpp v100, v100, v100 row_bcast:31 row_mask:0xc bank_mask:0xf
    s_nop 0
    s_nop 0
    v_readlane_b32 s22, v56, 63
    v_readlane_b32 s25, v100, 63
    s_nop 0
    s_nop 0
    v_mov_b32 v66, 0x3a800000
    v_mov_b32 v110, 0x3a800000
    v_mul_f32 v66, s22, v66
    v_mul_f32 v110, s25, v110
    v_cvt_pk_bf16_f32 v66, v66, v66
    v_cvt_pk_bf16_f32 v110, v110, v110
    v_lshlrev_b32 v66, 16, v66
    v_lshlrev_b32 v110, 16, v110
    v_add_f32 v66, 0x3727c5ac, v66
    v_add_f32 v110, 0x3727c5ac, v110
    v_cvt_pk_bf16_f32 v66, v66, v66
    v_cvt_pk_bf16_f32 v110, v110, v110
    v_lshlrev_b32 v66, 16, v66
    v_lshlrev_b32 v110, 16, v110
    v_sqrt_f32 v66, v66
    v_sqrt_f32 v110, v110
    v_cvt_pk_bf16_f32 v64, v64, v64
    v_cvt_pk_bf16_f32 v108, v108, v108
    v_cvt_pk_bf16_f32 v66, v66, v66
    v_cvt_pk_bf16_f32 v110, v110, v110
    v_lshlrev_b32 v64, 16, v64
    v_lshlrev_b32 v108, 16, v108
    v_lshlrev_b32 v66, 16, v66
    v_lshlrev_b32 v110, 16, v110
    v_rcp_f32 v66, v66
    v_rcp_f32 v110, v110
    v_pk_add_f32 v[68:69], v[40:41], v[64:65] op_sel_hi:[1,0] neg_lo:[0,1] neg_hi:[0,1]
    v_pk_add_f32 v[112:113], v[84:85], v[108:109] op_sel_hi:[1,0] neg_lo:[0,1] neg_hi:[0,1]
    v_pk_add_f32 v[70:71], v[42:43], v[64:65] op_sel_hi:[1,0] neg_lo:[0,1] neg_hi:[0,1]
    v_pk_add_f32 v[114:115], v[86:87], v[108:109] op_sel_hi:[1,0] neg_lo:[0,1] neg_hi:[0,1]
    v_pk_add_f32 v[72:73], v[44:45], v[64:65] op_sel_hi:[1,0] neg_lo:[0,1] neg_hi:[0,1]
    v_pk_add_f32 v[116:117], v[88:89], v[108:109] op_sel_hi:[1,0] neg_lo:[0,1] neg_hi:[0,1]
    v_pk_add_f32 v[74:75], v[46:47], v[64:65] op_sel_hi:[1,0] neg_lo:[0,1] neg_hi:[0,1]
    v_pk_add_f32 v[118:119], v[90:91], v[108:109] op_sel_hi:[1,0] neg_lo:[0,1] neg_hi:[0,1]
    v_mov_b32 v32, v64
    v_mov_b32 v76, v108
    v_mov_b32 v33, v66
    v_mov_b32 v77, v110
    v_cvt_pk_bf16_f32 v56, v68, v69
    v_cvt_pk_bf16_f32 v100, v112, v113
    v_cvt_pk_bf16_f32 v57, v70, v71
    v_cvt_pk_bf16_f32 v101, v114, v115
    v_cvt_pk_bf16_f32 v58, v72, v73
    v_cvt_pk_bf16_f32 v102, v116, v117
    v_cvt_pk_bf16_f32 v59, v74, v75
    v_cvt_pk_bf16_f32 v103, v118, v119
    v_lshlrev_b32 v68, 16, v56
    v_lshlrev_b32 v112, 16, v100
    v_and_b32 v69, s82, v56
    v_and_b32 v113, s82, v100
    v_lshlrev_b32 v70, 16, v57
    v_lshlrev_b32 v114, 16, v101
    v_and_b32 v71, s82, v57
    v_and_b32 v115, s82, v101
    v_lshlrev_b32 v72, 16, v58
    v_lshlrev_b32 v116, 16, v102
    v_and_b32 v73, s82, v58
    v_and_b32 v117, s82, v102
    v_lshlrev_b32 v74, 16, v59
    v_lshlrev_b32 v118, 16, v103
    v_and_b32 v75, s82, v59
    v_and_b32 v119, s82, v103
    v_pk_mul_f32 v[68:69], v[68:69], v[66:67] op_sel_hi:[1,0]
    v_pk_mul_f32 v[112:113], v[112:113], v[110:111] op_sel_hi:[1,0]
    v_pk_mul_f32 v[70:71], v[70:71], v[66:67] op_sel_hi:[1,0]
    v_pk_mul_f32 v[114:115], v[114:115], v[110:111] op_sel_hi:[1,0]
    v_pk_mul_f32 v[72:73], v[72:73], v[66:67] op_sel_hi:[1,0]
    v_pk_mul_f32 v[116:117], v[116:117], v[110:111] op_sel_hi:[1,0]
    v_pk_mul_f32 v[74:75], v[74:75], v[66:67] op_sel_hi:[1,0]
    v_pk_mul_f32 v[118:119], v[118:119], v[110:111] op_sel_hi:[1,0]
    v_cvt_pk_bf16_f32 v56, v68, v69
    v_cvt_pk_bf16_f32 v100, v112, v113
    v_cvt_pk_bf16_f32 v57, v70, v71
    v_cvt_pk_bf16_f32 v101, v114, v115
    v_cvt_pk_bf16_f32 v58, v72, v73
    v_cvt_pk_bf16_f32 v102, v116, v117
    v_cvt_pk_bf16_f32 v59, v74, v75
    v_cvt_pk_bf16_f32 v103, v118, v119
    v_lshlrev_b32 v40, 16, v56
    v_lshlrev_b32 v84, 16, v100
    v_and_b32 v41, s82, v56
    v_and_b32 v85, s82, v100
    v_lshlrev_b32 v42, 16, v57
    v_lshlrev_b32 v86, 16, v101
    v_and_b32 v43, s82, v57
    v_and_b32 v87, s82, v101
    v_lshlrev_b32 v44, 16, v58
    v_lshlrev_b32 v88, 16, v102
    v_and_b32 v45, s82, v58
    v_and_b32 v89, s82, v102
    v_lshlrev_b32 v46, 16, v59
    v_lshlrev_b32 v90, 16, v103
    v_and_b32 v47, s82, v59
    v_and_b32 v91, s82, v103
    v_pk_add_f32 v[68:69], v[40:41], v[44:45]
    v_pk_add_f32 v[112:113], v[84:85], v[88:89]
    v_pk_add_f32 v[70:71], v[42:43], v[46:47]
    v_pk_add_f32 v[114:115], v[86:87], v[90:91]
    v_pk_add_f32 v[72:73], v[40:41], v[44:45] neg_lo:[0,1] neg_hi:[0,1]
    v_pk_add_f32 v[116:117], v[84:85], v[88:89] neg_lo:[0,1] neg_hi:[0,1]
    v_pk_add_f32 v[74:75], v[42:43], v[46:47] neg_lo:[0,1] neg_hi:[0,1]
    v_pk_add_f32 v[118:119], v[86:87], v[90:91] neg_lo:[0,1] neg_hi:[0,1]
    v_cvt_pk_f16_f32 v56, v68, v69
    v_cvt_pk_f16_f32 v100, v112, v113
    v_cvt_pk_f16_f32 v57, v70, v71
    v_cvt_pk_f16_f32 v101, v114, v115
    v_cvt_pk_f16_f32 v58, v72, v73
    v_cvt_pk_f16_f32 v102, v116, v117
    v_cvt_pk_f16_f32 v59, v74, v75
    v_cvt_pk_f16_f32 v103, v118, v119
    ds_write_b64 v31, v[56:57] offset:0
    ds_write_b64 v31, v[100:101] offset:1024
    ds_write_b64 v31, v[58:59] offset:8192
    ds_write_b64 v31, v[102:103] offset:9216
    s_waitcnt vmcnt(0)
    v_lshlrev_b32 v40, 16, v240
    v_lshlrev_b32 v84, 16, v120
    v_and_b32 v41, s82, v240
    v_and_b32 v85, s82, v120
    v_lshlrev_b32 v42, 16, v241
    v_lshlrev_b32 v86, 16, v121
    v_and_b32 v43, s82, v241
    v_and_b32 v87, s82, v121
    v_lshlrev_b32 v44, 16, v242
    v_lshlrev_b32 v88, 16, v122
    v_and_b32 v45, s82, v242
    v_and_b32 v89, s82, v122
    v_lshlrev_b32 v46, 16, v243
    v_lshlrev_b32 v90, 16, v123
    v_and_b32 v47, s82, v243
    v_and_b32 v91, s82, v123
    v_lshlrev_b32 v48, 16, v244
    v_lshlrev_b32 v92, 16, v124
    v_and_b32 v49, s82, v244
    v_and_b32 v93, s82, v124
    v_lshlrev_b32 v50, 16, v245
    v_lshlrev_b32 v94, 16, v125
    v_and_b32 v51, s82, v245
    v_and_b32 v95, s82, v125
    v_lshlrev_b32 v52, 16, v246
    v_lshlrev_b32 v96, 16, v126
    v_and_b32 v53, s82, v246
    v_and_b32 v97, s82, v126
    v_lshlrev_b32 v54, 16, v247
    v_lshlrev_b32 v98, 16, v127
    v_and_b32 v55, s82, v247
    v_and_b32 v99, s82, v127
    v_pk_add_f32 v[56:57], v[40:41], v[42:43]
    v_pk_add_f32 v[100:101], v[84:85], v[86:87]
    v_pk_add_f32 v[58:59], v[44:45], v[46:47]
    v_pk_add_f32 v[102:103], v[88:89], v[90:91]
    v_pk_add_f32 v[60:61], v[48:49], v[50:51]
    v_pk_add_f32 v[104:105], v[92:93], v[94:95]
    v_pk_add_f32 v[62:63], v[52:53], v[54:55]
    v_pk_add_f32 v[106:107], v[96:97], v[98:99]
    v_pk_add_f32 v[56:57], v[56:57], v[58:59]
    v_pk_add_f32 v[100:101], v[100:101], v[102:103]
    v_pk_add_f32 v[60:61], v[60:61], v[62:63]
    v_pk_add_f32 v[104:105], v[104:105], v[106:107]
    v_pk_add_f32 v[56:57], v[56:57], v[60:61]
    v_pk_add_f32 v[100:101], v[100:101], v[104:105]
    v_add_f32 v56, v56, v57
    v_add_f32 v100, v100, v101
    s_nop 0
    s_nop 0
    v_add_f32_dpp v56, v56, v56 quad_perm:[1,0,3,2] row_mask:0xf bank_mask:0xf
    v_add_f32_dpp v100, v100, v100 quad_perm:[1,0,3,2] row_mask:0xf bank_mask:0xf
    s_nop 0
    s_nop 0
    v_add_f32_dpp v56, v56, v56 quad_perm:[2,3,0,1] row_mask:0xf bank_mask:0xf
    v_add_f32_dpp v100, v100, v100 quad_perm:[2,3,0,1] row_mask:0xf bank_mask:0xf
    s_nop 0
    s_nop 0
    v_add_f32_dpp v56, v56, v56 row_half_mirror row_mask:0xf bank_mask:0xf
    v_add_f32_dpp v100, v100, v100 row_half_mirror row_mask:0xf bank_mask:0xf
    s_nop 0
    s_nop 0
    v_add_f32_dpp v56, v56, v56 row_mirror row_mask:0xf bank_mask:0xf
    v_add_f32_dpp v100, v100, v100 row_mirror row_mask:0xf bank_mask:0xf
    s_nop 0
    s_nop 0
    v_add_f32_dpp v56, v56, v56 row_bcast:15 row_mask:0xa bank_mask:0xf
    v_add_f32_dpp v100, v100, v100 row_bcast:15 row_mask:0xa bank_mask:0xf
    s_nop 0
    s_nop 0
    v_add_f32_dpp v56, v56, v56 row_bcast:31 row_mask:0xc bank_mask:0xf
    v_add_f32_dpp v100, v100, v100 row_bcast:31 row_mask:0xc bank_mask:0xf
    s_nop 0
    s_nop 0
    v_readlane_b32 s21, v56, 63
    v_readlane_b32 s24, v100, 63
    s_nop 0
    s_nop 0
    v_mov_b32 v64, 0x3a800000
    v_mov_b32 v108, 0x3a800000
    v_mul_f32 v64, s21, v64
    v_mul_f32 v108, s24, v108
    v_pk_add_f32 v[68:69], v[40:41], v[64:65] op_sel_hi:[1,0] neg_lo:[0,1] neg_hi:[0,1]
    v_pk_add_f32 v[112:113], v[84:85], v[108:109] op_sel_hi:[1,0] neg_lo:[0,1] neg_hi:[0,1]
    v_pk_add_f32 v[70:71], v[42:43], v[64:65] op_sel_hi:[1,0] neg_lo:[0,1] neg_hi:[0,1]
    v_pk_add_f32 v[114:115], v[86:87], v[108:109] op_sel_hi:[1,0] neg_lo:[0,1] neg_hi:[0,1]
    v_pk_add_f32 v[72:73], v[44:45], v[64:65] op_sel_hi:[1,0] neg_lo:[0,1] neg_hi:[0,1]
    v_pk_add_f32 v[116:117], v[88:89], v[108:109] op_sel_hi:[1,0] neg_lo:[0,1] neg_hi:[0,1]
    v_pk_add_f32 v[74:75], v[46:47], v[64:65] op_sel_hi:[1,0] neg_lo:[0,1] neg_hi:[0,1]
    v_pk_add_f32 v[118:119], v[90:91], v[108:109] op_sel_hi:[1,0] neg_lo:[0,1] neg_hi:[0,1]
    v_pk_mul_f32 v[56:57], v[68:69], v[68:69]
    v_pk_mul_f32 v[100:101], v[112:113], v[112:113]
    v_pk_mul_f32 v[58:59], v[70:71], v[70:71]
    v_pk_mul_f32 v[102:103], v[114:115], v[114:115]
    v_pk_fma_f32 v[56:57], v[72:73], v[72:73], v[56:57]
    v_pk_fma_f32 v[100:101], v[116:117], v[116:117], v[100:101]
    v_pk_fma_f32 v[58:59], v[74:75], v[74:75], v[58:59]
    v_pk_fma_f32 v[102:103], v[118:119], v[118:119], v[102:103]
    v_pk_add_f32 v[68:69], v[48:49], v[64:65] op_sel_hi:[1,0] neg_lo:[0,1] neg_hi:[0,1]
    v_pk_add_f32 v[112:113], v[92:93], v[108:109] op_sel_hi:[1,0] neg_lo:[0,1] neg_hi:[0,1]
    v_pk_add_f32 v[70:71], v[50:51], v[64:65] op_sel_hi:[1,0] neg_lo:[0,1] neg_hi:[0,1]
    v_pk_add_f32 v[114:115], v[94:95], v[108:109] op_sel_hi:[1,0] neg_lo:[0,1] neg_hi:[0,1]
    v_pk_add_f32 v[72:73], v[52:53], v[64:65] op_sel_hi:[1,0] neg_lo:[0,1] neg_hi:[0,1]
    v_pk_add_f32 v[116:117], v[96:97], v[108:109] op_sel_hi:[1,0] neg_lo:[0,1] neg_hi:[0,1]
    v_pk_add_f32 v[74:75], v[54:55], v[64:65] op_sel_hi:[1,0] neg_lo:[0,1] neg_hi:[0,1]
    v_pk_add_f32 v[118:119], v[98:99], v[108:109] op_sel_hi:[1,0] neg_lo:[0,1] neg_hi:[0,1]
    v_pk_fma_f32 v[56:57], v[68:69], v[68:69], v[56:57]
    v_pk_fma_f32 v[100:101], v[112:113], v[112:113], v[100:101]
    v_pk_fma_f32 v[58:59], v[70:71], v[70:71], v[58:59]
    v_pk_fma_f32 v[102:103], v[114:115], v[114:115], v[102:103]
    v_pk_fma_f32 v[56:57], v[72:73], v[72:73], v[56:57]
    v_pk_fma_f32 v[100:101], v[116:117], v[116:117], v[100:101]
    v_pk_fma_f32 v[58:59], v[74:75], v[74:75], v[58:59]
    v_pk_fma_f32 v[102:103], v[118:119], v[118:119], v[102:103]
    v_pk_add_f32 v[56:57], v[56:57], v[58:59]
    v_pk_add_f32 v[100:101], v[100:101], v[102:103]
    v_add_f32 v56, v56, v57
    v_add_f32 v100, v100, v101
    s_nop 0
    s_nop 0
    v_add_f32_dpp v56, v56, v56 quad_perm:[1,0,3,2] row_mask:0xf bank_mask:0xf
    v_add_f32_dpp v100, v100, v100 quad_perm:[1,0,3,2] row_mask:0xf bank_mask:0xf
    s_nop 0
    s_nop 0
    v_add_f32_dpp v56, v56, v56 quad_perm:[2,3,0,1] row_mask:0xf bank_mask:0xf
    v_add_f32_dpp v100, v100, v100 quad_perm:[2,3,0,1] row_mask:0xf bank_mask:0xf
    s_nop 0
    s_nop 0
    v_add_f32_dpp v56, v56, v56 row_half_mirror row_mask:0xf bank_mask:0xf
    v_add_f32_dpp v100, v100, v100 row_half_mirror row_mask:0xf bank_mask:0xf
    s_nop 0
    s_nop 0
    v_add_f32_dpp v56, v56, v56 row_mirror row_mask:0xf bank_mask:0xf
    v_add_f32_dpp v100, v100, v100 row_mirror row_mask:0xf bank_mask:0xf
    s_nop 0
    s_nop 0
    v_add_f32_dpp v56, v56, v56 row_bcast:15 row_mask:0xa bank_mask:0xf
    v_add_f32_dpp v100, v100, v100 row_bcast:15 row_mask:0xa bank_mask:0xf
    s_nop 0
    s_nop 0
    v_add_f32_dpp v56, v56, v56 row_bcast:31 row_mask:0xc bank_mask:0xf
    v_add_f32_dpp v100, v100, v100 row_bcast:31 row_mask:0xc bank_mask:0xf
    s_nop 0
    s_nop 0
    v_readlane_b32 s22, v56, 63
    v_readlane_b32 s25, v100, 63
    s_nop 0
    s_nop 0
    v_mov_b32 v66, 0x3a800000
    v_mov_b32 v110, 0x3a800000
    v_mul_f32 v66, s22, v66
    v_mul_f32 v110, s25, v110
    v_cvt_pk_bf16_f32 v66, v66, v66
    v_cvt_pk_bf16_f32 v110, v110, v110
    v_lshlrev_b32 v66, 16, v66
    v_lshlrev_b32 v110, 16, v110
    v_add_f32 v66, 0x3727c5ac, v66
    v_add_f32 v110, 0x3727c5ac, v110
    v_cvt_pk_bf16_f32 v66, v66, v66
    v_cvt_pk_bf16_f32 v110, v110, v110
    v_lshlrev_b32 v66, 16, v66
    v_lshlrev_b32 v110, 16, v110
    v_sqrt_f32 v66, v66
    v_sqrt_f32 v110, v110
    v_cvt_pk_bf16_f32 v64, v64, v64
    v_cvt_pk_bf16_f32 v108, v108, v108
    v_cvt_pk_bf16_f32 v66, v66, v66
    v_cvt_pk_bf16_f32 v110, v110, v110
    v_lshlrev_b32 v64, 16, v64
    v_lshlrev_b32 v108, 16, v108
    v_lshlrev_b32 v66, 16, v66
    v_lshlrev_b32 v110, 16, v110
    v_rcp_f32 v66, v66
    v_rcp_f32 v110, v110
    v_pk_add_f32 v[68:69], v[40:41], v[64:65] op_sel_hi:[1,0] neg_lo:[0,1] neg_hi:[0,1]
    v_pk_add_f32 v[112:113], v[84:85], v[108:109] op_sel_hi:[1,0] neg_lo:[0,1] neg_hi:[0,1]
    v_pk_add_f32 v[70:71], v[42:43], v[64:65] op_sel_hi:[1,0] neg_lo:[0,1] neg_hi:[0,1]
    v_pk_add_f32 v[114:115], v[86:87], v[108:109] op_sel_hi:[1,0] neg_lo:[0,1] neg_hi:[0,1]
    v_pk_add_f32 v[72:73], v[44:45], v[64:65] op_sel_hi:[1,0] neg_lo:[0,1] neg_hi:[0,1]
    v_pk_add_f32 v[116:117], v[88:89], v[108:109] op_sel_hi:[1,0] neg_lo:[0,1] neg_hi:[0,1]
    v_pk_add_f32 v[74:75], v[46:47], v[64:65] op_sel_hi:[1,0] neg_lo:[0,1] neg_hi:[0,1]
    v_pk_add_f32 v[118:119], v[90:91], v[108:109] op_sel_hi:[1,0] neg_lo:[0,1] neg_hi:[0,1]
    v_mov_b32 v65, v66
    v_mov_b32 v109, v110
    v_cvt_pk_bf16_f32 v56, v68, v69
    v_cvt_pk_bf16_f32 v100, v112, v113
    v_cvt_pk_bf16_f32 v57, v70, v71
    v_cvt_pk_bf16_f32 v101, v114, v115
    v_cvt_pk_bf16_f32 v58, v72, v73
    v_cvt_pk_bf16_f32 v102, v116, v117
    v_cvt_pk_bf16_f32 v59, v74, v75
    v_cvt_pk_bf16_f32 v103, v118, v119
    v_lshlrev_b32 v68, 16, v56
    v_lshlrev_b32 v112, 16, v100
    v_and_b32 v69, s82, v56
    v_and_b32 v113, s82, v100
    v_lshlrev_b32 v70, 16, v57
    v_lshlrev_b32 v114, 16, v101
    v_and_b32 v71, s82, v57
    v_and_b32 v115, s82, v101
    v_lshlrev_b32 v72, 16, v58
    v_lshlrev_b32 v116, 16, v102
    v_and_b32 v73, s82, v58
    v_and_b32 v117, s82, v102
    v_lshlrev_b32 v74, 16, v59
    v_lshlrev_b32 v118, 16, v103
    v_and_b32 v75, s82, v59
    v_and_b32 v119, s82, v103
    v_pk_mul_f32 v[68:69], v[68:69], v[66:67] op_sel_hi:[1,0]
    v_pk_mul_f32 v[112:113], v[112:113], v[110:111] op_sel_hi:[1,0]
    v_pk_mul_f32 v[70:71], v[70:71], v[66:67] op_sel_hi:[1,0]
    v_pk_mul_f32 v[114:115], v[114:115], v[110:111] op_sel_hi:[1,0]
    v_pk_mul_f32 v[72:73], v[72:73], v[66:67] op_sel_hi:[1,0]
    v_pk_mul_f32 v[116:117], v[116:117], v[110:111] op_sel_hi:[1,0]
    v_pk_mul_f32 v[74:75], v[74:75], v[66:67] op_sel_hi:[1,0]
    v_pk_mul_f32 v[118:119], v[118:119], v[110:111] op_sel_hi:[1,0]
    v_cvt_pk_bf16_f32 v56, v68, v69
    v_cvt_pk_bf16_f32 v100, v112, v113
    v_cvt_pk_bf16_f32 v57, v70, v71
    v_cvt_pk_bf16_f32 v101, v114, v115
    v_cvt_pk_bf16_f32 v58, v72, v73
    v_cvt_pk_bf16_f32 v102, v116, v117
    v_cvt_pk_bf16_f32 v59, v74, v75
    v_cvt_pk_bf16_f32 v103, v118, v119
    v_lshlrev_b32 v40, 16, v56
    v_lshlrev_b32 v84, 16, v100
    v_and_b32 v41, s82, v56
    v_and_b32 v85, s82, v100
    v_lshlrev_b32 v42, 16, v57
    v_lshlrev_b32 v86, 16, v101
    v_and_b32 v43, s82, v57
    v_and_b32 v87, s82, v101
    v_lshlrev_b32 v44, 16, v58
    v_lshlrev_b32 v88, 16, v102
    v_and_b32 v45, s82, v58
    v_and_b32 v89, s82, v102
    v_lshlrev_b32 v46, 16, v59
    v_lshlrev_b32 v90, 16, v103
    v_and_b32 v47, s82, v59
    v_and_b32 v91, s82, v103
    v_pk_add_f32 v[68:69], v[40:41], v[44:45]
    v_pk_add_f32 v[112:113], v[84:85], v[88:89]
    v_pk_add_f32 v[70:71], v[42:43], v[46:47]
    v_pk_add_f32 v[114:115], v[86:87], v[90:91]
    v_pk_add_f32 v[72:73], v[40:41], v[44:45] neg_lo:[0,1] neg_hi:[0,1]
    v_pk_add_f32 v[116:117], v[84:85], v[88:89] neg_lo:[0,1] neg_hi:[0,1]
    v_pk_add_f32 v[74:75], v[42:43], v[46:47] neg_lo:[0,1] neg_hi:[0,1]
    v_pk_add_f32 v[118:119], v[86:87], v[90:91] neg_lo:[0,1] neg_hi:[0,1]
    v_cvt_pk_f16_f32 v56, v68, v69
    v_cvt_pk_f16_f32 v100, v112, v113
    v_cvt_pk_f16_f32 v57, v70, v71
    v_cvt_pk_f16_f32 v101, v114, v115
    v_cvt_pk_f16_f32 v58, v72, v73
    v_cvt_pk_f16_f32 v102, v116, v117
    v_cvt_pk_f16_f32 v59, v74, v75
    v_cvt_pk_f16_f32 v103, v118, v119
    ds_write_b64 v31, v[56:57] offset:2048
    ds_write_b64 v31, v[100:101] offset:3072
    ds_write_b64 v31, v[58:59] offset:10240
    ds_write_b64 v31, v[102:103] offset:11264
    s_cmp_lg_u32 s27, 0
    s_cbranch_scc1 L_nostat_1
    s_mov_b64 exec, 1
    buffer_store_dwordx2 v[32:33], v2, s[40:43], 0 offen offset:0 sc1
    buffer_store_dwordx2 v[76:77], v2, s[40:43], 0 offen offset:256 sc1
    buffer_store_dwordx2 v[64:65], v2, s[40:43], 0 offen offset:512 sc1
    buffer_store_dwordx2 v[108:109], v2, s[40:43], 0 offen offset:768 sc1
    s_mov_b64 exec, -1
L_nostat_1:
    s_waitcnt lgkmcnt(0)
    s_add_u32 s38, s38, 0x9e3779b9
    v_mov_b32 v29, 159744
    v_mov_b32 v30, 1
    s_mov_b64 exec, 1
    ds_add_u32 v29, v30
    s_mov_b64 exec, -1
    s_mov_b32 s23, 0
L_sync:
    ds_read_b32 v30, v29
    s_add_u32 s23, s23, 1
    s_waitcnt lgkmcnt(0)
    v_readfirstlane_b32 s22, v30
    s_cmp_ge_u32 s23, 200000
    s_cbranch_scc1 L_synced
    s_cmp_lt_u32 s22, 4
    s_cbranch_scc1 L_sync
L_synced:
    s_lshr_b32 s16, s3, 1
    s_lshl_b32 s17, s16, 13
    s_add_u32 s17, s17, 143360
    v_lshlrev_b32 v122, 2, v3
    v_add_u32 v122, s17, v122
    ds_read2st64_b32 v[32:33], v122 offset0:0 offset1:8
    ds_read2st64_b32 v[34:35], v122 offset0:1 offset1:9
    ds_read2st64_b32 v[36:37], v122 offset0:2 offset1:10
    ds_read2st64_b32 v[38:39], v122 offset0:3 offset1:11
    ds_read2st64_b32 v[40:41], v122 offset0:4 offset1:12
    ds_read2st64_b32 v[42:43], v122 offset0:5 offset1:13
    ds_read2st64_b32 v[44:45], v122 offset0:6 offset1:14
    ds_read2st64_b32 v[46:47], v122 offset0:7 offset1:15
    ds_read2st64_b32 v[48:49], v122 offset0:16 offset1:24
    ds_read2st64_b32 v[50:51], v122 offset0:17 offset1:25
    ds_read2st64_b32 v[52:53], v122 offset0:18 offset1:26
    ds_read2st64_b32 v[54:55], v122 offset0:19 offset1:27
    ds_read2st64_b32 v[56:57], v122 offset0:20 offset1:28
    ds_read2st64_b32 v[58:59], v122 offset0:21 offset1:29
    ds_read2st64_b32 v[60:61], v122 offset0:22 offset1:30
    ds_read2st64_b32 v[62:63], v122 offset0:23 offset1:31
    s_lshl_b32 s17, s26, 9
    s_lshl_b32 s18, s27, 8
    s_add_u32 s17, s17, s18
    s_lshl_b32 s18, s16, 17
    s_add_u32 s17, s17, s18
    s_add_u32 s17, s17, 0x400000
    v_lshlrev_b32 v123, 2, v3
    v_add_u32 v123, s17, v123
    s_mov_b32 s84, 0x3f6c835e
    s_mov_b32 s85, 0x3f6c835e
    s_mov_b32 s86, 0x3f3504f3
    s_mov_b32 s87, 0x3f3504f3
    s_mov_b32 s88, 0x3ec3ef15
    s_mov_b32 s89, 0x3ec3ef15
    s_waitcnt lgkmcnt(0)
    s_bitcmp1_b32 s3, 0
    s_cbranch_scc1 L_dc_4
    v_fma_mix_f32 v64, v32, 1.0, v33 op_sel:[0,0,0] op_sel_hi:[1,0,1]
    v_fma_mix_f32 v65, v32, 1.0, v33 op_sel:[1,0,1] op_sel_hi:[1,0,1]
    v_fma_mix_f32 v66, v34, 1.0, v35 op_sel:[0,0,0] op_sel_hi:[1,0,1]
    v_fma_mix_f32 v67, v34, 1.0, v35 op_sel:[1,0,1] op_sel_hi:[1,0,1]
    v_fma_mix_f32 v68, v36, 1.0, v37 op_sel:[0,0,0] op_sel_hi:[1,0,1]
    v_fma_mix_f32 v69, v36, 1.0, v37 op_sel:[1,0,1] op_sel_hi:[1,0,1]
    v_fma_mix_f32 v70, v38, 1.0, v39 op_sel:[0,0,0] op_sel_hi:[1,0,1]
    v_fma_mix_f32 v71, v38, 1.0, v39 op_sel:[1,0,1] op_sel_hi:[1,0,1]
    v_fma_mix_f32 v72, v40, 1.0, v41 op_sel:[0,0,0] op_sel_hi:[1,0,1]
    v_fma_mix_f32 v73, v40, 1.0, v41 op_sel:[1,0,1] op_sel_hi:[1,0,1]
    v_fma_mix_f32 v74, v42, 1.0, v43 op_sel:[0,0,0] op_sel_hi:[1,0,1]
    v_fma_mix_f32 v75, v42, 1.0, v43 op_sel:[1,0,1] op_sel_hi:[1,0,1]
    v_fma_mix_f32 v76, v44, 1.0, v45 op_sel:[0,0,0] op_sel_hi:[1,0,1]
    v_fma_mix_f32 v77, v44, 1.0, v45 op_sel:[1,0,1] op_sel_hi:[1,0,1]
    v_fma_mix_f32 v78, v46, 1.0, v47 op_sel:[0,0,0] op_sel_hi:[1,0,1]
    v_fma_mix_f32 v79, v46, 1.0, v47 op_sel:[1,0,1] op_sel_hi:[1,0,1]
    v_pk_add_f32 v[80:81], v[64:65], v[72:73]
    v_pk_add_f32 v[82:83], v[64:65], v[72:73] neg_lo:[0,1] neg_hi:[0,1]
    v_pk_add_f32 v[84:85], v[66:67], v[74:75]
    v_pk_add_f32 v[86:87], v[66:67], v[74:75] neg_lo:[0,1] neg_hi:[0,1]
    v_pk_add_f32 v[88:89], v[68:69], v[76:77]
    v_pk_add_f32 v[90:91], v[68:69], v[76:77] neg_lo:[0,1] neg_hi:[0,1]
    v_pk_add_f32 v[92:93], v[70:71], v[78:79]
    v_pk_add_f32 v[94:95], v[70:71], v[78:79] neg_lo:[0,1] neg_hi:[0,1]
    v_pk_add_f32 v[96:97], v[80:81], v[88:89]
    v_pk_add_f32 v[98:99], v[84:85], v[92:93]
    v_pk_add_f32 v[100:101], v[80:81], v[88:89] neg_lo:[0,1] neg_hi:[0,1]
    v_pk_add_f32 v[102:103], v[84:85], v[92:93] neg_lo:[0,1] neg_hi:[0,1]
    v_pk_add_f32 v[104:105], v[96:97], v[98:99]
    v_pk_add_f32 v[106:107], v[96:97], v[98:99] neg_lo:[0,1] neg_hi:[0,1]
    v_pk_add_f32 v[108:109], v[86:87], v[94:95] neg_lo:[0,1] neg_hi:[0,1]
    v_pk_add_f32 v[110:111], v[86:87], v[94:95]
    v_pk_fma_f32 v[112:113], v[108:109], s[86:87], v[82:83]
    v_pk_fma_f32 v[114:115], v[108:109], s[86:87], v[82:83] neg_lo:[1,0,0] neg_hi:[1,0,0]
    v_pk_fma_f32 v[116:117], v[110:111], s[86:87], v[90:91]
    v_pk_fma_f32 v[118:119], v[110:111], s[86:87], v[90:91] neg_lo:[0,0,1] neg_hi:[0,0,1]
    v_fma_mix_f32 v32, v48, 1.0, v49 op_sel:[0,0,0] op_sel_hi:[1,0,1]
    v_fma_mix_f32 v33, v48, 1.0, v49 op_sel:[1,0,1] op_sel_hi:[1,0,1]
    v_fma_mix_f32 v34, v50, 1.0, v51 op_sel:[0,0,0] op_sel_hi:[1,0,1]
    v_fma_mix_f32 v35, v50, 1.0, v51 op_sel:[1,0,1] op_sel_hi:[1,0,1]
    v_fma_mix_f32 v36, v52, 1.0, v53 op_sel:[0,0,0] op_sel_hi:[1,0,1]
    v_fma_mix_f32 v37, v52, 1.0, v53 op_sel:[1,0,1] op_sel_hi:[1,0,1]
    v_fma_mix_f32 v38, v54, 1.0, v55 op_sel:[0,0,0] op_sel_hi:[1,0,1]
    v_fma_mix_f32 v39, v54, 1.0, v55 op_sel:[1,0,1] op_sel_hi:[1,0,1]
    v_fma_mix_f32 v40, v56, 1.0, v57 op_sel:[0,0,0] op_sel_hi:[1,0,1]
    v_fma_mix_f32 v41, v56, 1.0, v57 op_sel:[1,0,1] op_sel_hi:[1,0,1]
    v_fma_mix_f32 v42, v58, 1.0, v59 op_sel:[0,0,0] op_sel_hi:[1,0,1]
    v_fma_mix_f32 v43, v58, 1.0, v59 op_sel:[1,0,1] op_sel_hi:[1,0,1]
    v_fma_mix_f32 v44, v60, 1.0, v61 op_sel:[0,0,0] op_sel_hi:[1,0,1]
    v_fma_mix_f32 v45, v60, 1.0, v61 op_sel:[1,0,1] op_sel_hi:[1,0,1]
    v_fma_mix_f32 v46, v62, 1.0, v63 op_sel:[0,0,0] op_sel_hi:[1,0,1]
    v_fma_mix_f32 v47, v62, 1.0, v63 op_sel:[1,0,1] op_sel_hi:[1,0,1]
    v_pk_add_f32 v[64:65], v[32:33], v[40:41]
    v_pk_add_f32 v[72:73], v[32:33], v[40:41] neg_lo:[0,1] neg_hi:[0,1]
    v_pk_add_f32 v[66:67], v[34:35], v[42:43]
    v_pk_add_f32 v[74:75], v[34:35], v[42:43] neg_lo:[0,1] neg_hi:[0,1]
    v_pk_add_f32 v[68:69], v[36:37], v[44:45]
    v_pk_add_f32 v[76:77], v[36:37], v[44:45] neg_lo:[0,1] neg_hi:[0,1]
    v_pk_add_f32 v[70:71], v[38:39], v[46:47]
    v_pk_add_f32 v[78:79], v[38:39], v[46:47] neg_lo:[0,1] neg_hi:[0,1]
    v_pk_add_f32 v[80:81], v[64:65], v[68:69]
    v_pk_add_f32 v[84:85], v[66:67], v[70:71]
    v_pk_add_f32 v[88:89], v[64:65], v[68:69] neg_lo:[0,1] neg_hi:[0,1]
    v_pk_add_f32 v[92:93], v[66:67], v[70:71] neg_lo:[0,1] neg_hi:[0,1]
    v_pk_add_f32 v[96:97], v[80:81], v[84:85]
    v_pk_add_f32 v[98:99], v[80:81], v[84:85] neg_lo:[0,1] neg_hi:[0,1]
    v_pk_add_f32 v[108:109], v[74:75], v[78:79] neg_lo:[0,1] neg_hi:[0,1]
    v_pk_add_f32 v[110:111], v[74:75], v[78:79]
    v_pk_fma_f32 v[82:83], v[108:109], s[86:87], v[72:73]
    v_pk_fma_f32 v[86:87], v[108:109], s[86:87], v[72:73] neg_lo:[1,0,0] neg_hi:[1,0,0]
    v_pk_fma_f32 v[90:91], v[110:111], s[86:87], v[76:77]
    v_pk_fma_f32 v[94:95], v[110:111], s[86:87], v[76:77] neg_lo:[0,0,1] neg_hi:[0,0,1]
    s_branch L_dd_2
L_dc_4:
    v_fma_mix_f32 v64, v32, 1.0, -v33 op_sel:[0,0,0] op_sel_hi:[1,0,1]
    v_fma_mix_f32 v65, v32, 1.0, -v33 op_sel:[1,0,1] op_sel_hi:[1,0,1]
    v_fma_mix_f32 v66, v34, 1.0, -v35 op_sel:[0,0,0] op_sel_hi:[1,0,1]
    v_fma_mix_f32 v67, v34, 1.0, -v35 op_sel:[1,0,1] op_sel_hi:[1,0,1]
    v_fma_mix_f32 v68, v36, 1.0, -v37 op_sel:[0,0,0] op_sel_hi:[1,0,1]
    v_fma_mix_f32 v69, v36, 1.0, -v37 op_sel:[1,0,1] op_sel_hi:[1,0,1]
    v_fma_mix_f32 v70, v38, 1.0, -v39 op_sel:[0,0,0] op_sel_hi:[1,0,1]
    v_fma_mix_f32 v71, v38, 1.0, -v39 op_sel:[1,0,1] op_sel_hi:[1,0,1]
    v_fma_mix_f32 v72, v40, 1.0, -v41 op_sel:[0,0,0] op_sel_hi:[1,0,1]
    v_fma_mix_f32 v73, v40, 1.0, -v41 op_sel:[1,0,1] op_sel_hi:[1,0,1]
    v_fma_mix_f32 v74, v42, 1.0, -v43 op_sel:[0,0,0] op_sel_hi:[1,0,1]
    v_fma_mix_f32 v75, v42, 1.0, -v43 op_sel:[1,0,1] op_sel_hi:[1,0,1]
    v_fma_mix_f32 v76, v44, 1.0, -v45 op_sel:[0,0,0] op_sel_hi:[1,0,1]
    v_fma_mix_f32 v77, v44, 1.0, -v45 op_sel:[1,0,1] op_sel_hi:[1,0,1]
    v_fma_mix_f32 v78, v46, 1.0, -v47 op_sel:[0,0,0] op_sel_hi:[1,0,1]
    v_fma_mix_f32 v79, v46, 1.0, -v47 op_sel:[1,0,1] op_sel_hi:[1,0,1]
    v_pk_add_f32 v[80:81], v[66:67], v[78:79] neg_lo:[0,1] neg_hi:[0,1]
    v_pk_add_f32 v[82:83], v[66:67], v[78:79]
    v_pk_add_f32 v[84:85], v[68:69], v[76:77] neg_lo:[0,1] neg_hi:[0,1]
    v_pk_add_f32 v[86:87], v[68:69], v[76:77]
    v_pk_add_f32 v[88:89], v[70:71], v[74:75] neg_lo:[0,1] neg_hi:[0,1]
    v_pk_add_f32 v[90:91], v[70:71], v[74:75]
    v_pk_fma_f32 v[92:93], v[84:85], s[86:87], v[64:65]
    v_pk_fma_f32 v[94:95], v[84:85], s[86:87], v[64:65] neg_lo:[1,0,0] neg_hi:[1,0,0]
    v_pk_mul_f32 v[96:97], v[80:81], s[84:85]
    v_pk_fma_f32 v[98:99], v[88:89], s[88:89], v[96:97]
    v_pk_mul_f32 v[100:101], v[80:81], s[88:89]
    v_pk_fma_f32 v[102:103], v[88:89], s[84:85], v[100:101] neg_lo:[1,0,0] neg_hi:[1,0,0]
    v_pk_add_f32 v[104:105], v[92:93], v[98:99]
    v_pk_add_f32 v[106:107], v[92:93], v[98:99] neg_lo:[0,1] neg_hi:[0,1]
    v_pk_add_f32 v[108:109], v[94:95], v[102:103]
    v_pk_add_f32 v[110:111], v[94:95], v[102:103] neg_lo:[0,1] neg_hi:[0,1]
    v_pk_fma_f32 v[112:113], v[86:87], s[86:87], v[72:73]
    v_pk_fma_f32 v[114:115], v[86:87], s[86:87], v[72:73] neg_lo:[0,0,1] neg_hi:[0,0,1]
    v_pk_mul_f32 v[116:117], v[82:83], s[88:89]
    v_pk_fma_f32 v[118:119], v[90:91], s[84:85], v[116:117]
    v_pk_mul_f32 v[32:33], v[82:83], s[84:85]
    v_pk_fma_f32 v[34:35], v[90:91], s[88:89], v[32:33] neg_lo:[1,0,0] neg_hi:[1,0,0]
    v_pk_add_f32 v[36:37], v[118:119], v[112:113]
    v_pk_add_f32 v[38:39], v[118:119], v[112:113] neg_lo:[0,1] neg_hi:[0,1]
    v_pk_add_f32 v[40:41], v[34:35], v[114:115]
    v_pk_add_f32 v[42:43], v[34:35], v[114:115] neg_lo:[0,1] neg_hi:[0,1]
    v_fma_mix_f32 v44, v48, 1.0, -v49 op_sel:[0,0,0] op_sel_hi:[1,0,1]
    v_fma_mix_f32 v45, v48, 1.0, -v49 op_sel:[1,0,1] op_sel_hi:[1,0,1]
    v_fma_mix_f32 v46, v50, 1.0, -v51 op_sel:[0,0,0] op_sel_hi:[1,0,1]
    v_fma_mix_f32 v47, v50, 1.0, -v51 op_sel:[1,0,1] op_sel_hi:[1,0,1]
    v_fma_mix_f32 v66, v52, 1.0, -v53 op_sel:[0,0,0] op_sel_hi:[1,0,1]
    v_fma_mix_f32 v67, v52, 1.0, -v53 op_sel:[1,0,1] op_sel_hi:[1,0,1]
    v_fma_mix_f32 v78, v54, 1.0, -v55 op_sel:[0,0,0] op_sel_hi:[1,0,1]
    v_fma_mix_f32 v79, v54, 1.0, -v55 op_sel:[1,0,1] op_sel_hi:[1,0,1]
    v_fma_mix_f32 v68, v56, 1.0, -v57 op_sel:[0,0,0] op_sel_hi:[1,0,1]
    v_fma_mix_f32 v69, v56, 1.0, -v57 op_sel:[1,0,1] op_sel_hi:[1,0,1]
    v_fma_mix_f32 v76, v58, 1.0, -v59 op_sel:[0,0,0] op_sel_hi:[1,0,1]
    v_fma_mix_f32 v77, v58, 1.0, -v59 op_sel:[1,0,1] op_sel_hi:[1,0,1]
    v_fma_mix_f32 v70, v60, 1.0, -v61 op_sel:[0,0,0] op_sel_hi:[1,0,1]
    v_fma_mix_f32 v71, v60, 1.0, -v61 op_sel:[1,0,1] op_sel_hi:[1,0,1]
    v_fma_mix_f32 v74, v62, 1.0, -v63 op_sel:[0,0,0] op_sel_hi:[1,0,1]
    v_fma_mix_f32 v75, v62, 1.0, -v63 op_sel:[1,0,1] op_sel_hi:[1,0,1]
    v_pk_add_f32 v[84:85], v[46:47], v[74:75] neg_lo:[0,1] neg_hi:[0,1]
    v_pk_add_f32 v[64:65], v[46:47], v[74:75]
    v_pk_add_f32 v[96:97], v[66:67], v[70:71] neg_lo:[0,1] neg_hi:[0,1]
    v_pk_add_f32 v[100:101], v[66:67], v[70:71]
    v_pk_add_f32 v[80:81], v[78:79], v[76:77] neg_lo:[0,1] neg_hi:[0,1]
    v_pk_add_f32 v[88:89], v[78:79], v[76:77]
    v_pk_fma_f32 v[92:93], v[96:97], s[86:87], v[44:45]
    v_pk_fma_f32 v[94:95], v[96:97], s[86:87], v[44:45] neg_lo:[1,0,0] neg_hi:[1,0,0]
    v_pk_mul_f32 v[98:99], v[84:85], s[84:85]
    v_pk_fma_f32 v[102:103], v[80:81], s[88:89], v[98:99]
    v_pk_mul_f32 v[86:87], v[84:85], s[88:89]
    v_pk_fma_f32 v[72:73], v[80:81], s[84:85], v[86:87] neg_lo:[1,0,0] neg_hi:[1,0,0]
    v_pk_add_f32 v[116:117], v[92:93], v[102:103]
    v_pk_add_f32 v[32:33], v[92:93], v[102:103] neg_lo:[0,1] neg_hi:[0,1]
    v_pk_add_f32 v[82:83], v[94:95], v[72:73]
    v_pk_add_f32 v[90:91], v[94:95], v[72:73] neg_lo:[0,1] neg_hi:[0,1]
    v_pk_fma_f32 v[112:113], v[100:101], s[86:87], v[68:69]
    v_pk_fma_f32 v[114:115], v[100:101], s[86:87], v[68:69] neg_lo:[0,0,1] neg_hi:[0,0,1]
    v_pk_mul_f32 v[118:119], v[64:65], s[88:89]
    v_pk_fma_f32 v[34:35], v[88:89], s[84:85], v[118:119]
    v_pk_mul_f32 v[48:49], v[64:65], s[84:85]
    v_pk_fma_f32 v[50:51], v[88:89], s[88:89], v[48:49] neg_lo:[1,0,0] neg_hi:[1,0,0]
    v_pk_add_f32 v[52:53], v[34:35], v[112:113]
    v_pk_add_f32 v[54:55], v[34:35], v[112:113] neg_lo:[0,1] neg_hi:[0,1]
    v_pk_add_f32 v[56:57], v[50:51], v[114:115]
    v_pk_add_f32 v[58:59], v[50:51], v[114:115] neg_lo:[0,1] neg_hi:[0,1]
L_dd_2:
    s_cmp_eq_u32 s3, 1
    s_cbranch_scc1 L_dc_9
    s_cmp_eq_u32 s3, 2
    s_cbranch_scc1 L_dc_10
    s_cmp_eq_u32 s3, 3
    s_cbranch_scc1 L_dc_11
    v_pk_add_f32 v[56:57], v[104:105], v[96:97]
    v_pk_add_f32 v[58:59], v[104:105], v[96:97] neg_lo:[0,1] neg_hi:[0,1]
    v_cvt_pk_bf16_f32 v48, v56, v57
    s_mov_b32 s17, 0x0
    buffer_store_dword v48, v123, s[40:43], s17 offen sc1
    v_cvt_pk_bf16_f32 v49, v58, v59
    s_mov_b32 s17, 0x40000
    buffer_store_dword v49, v123, s[40:43], s17 offen sc1
    v_pk_add_f32 v[56:57], v[106:107], v[98:99]
    v_pk_add_f32 v[58:59], v[106:107], v[98:99] neg_lo:[0,1] neg_hi:[0,1]
    v_cvt_pk_bf16_f32 v50, v56, v57
    s_mov_b32 s17, 0x10000
    buffer_store_dword v50, v123, s[40:43], s17 offen sc1
    v_cvt_pk_bf16_f32 v51, v58, v59
    s_mov_b32 s17, 0x50000
    buffer_store_dword v51, v123, s[40:43], s17 offen sc1
    v_pk_add_f32 v[56:57], v[112:113], v[82:83]
    v_pk_add_f32 v[58:59], v[112:113], v[82:83] neg_lo:[0,1] neg_hi:[0,1]
    v_cvt_pk_bf16_f32 v52, v56, v57
    s_mov_b32 s17, 0x100000
    buffer_store_dword v52, v123, s[40:43], s17 offen sc1
    v_cvt_pk_bf16_f32 v53, v58, v59
    s_mov_b32 s17, 0x140000
    buffer_store_dword v53, v123, s[40:43], s17 offen sc1
    v_pk_add_f32 v[56:57], v[116:117], v[90:91]
    v_pk_add_f32 v[58:59], v[116:117], v[90:91] neg_lo:[0,1] neg_hi:[0,1]
    v_cvt_pk_bf16_f32 v54, v56, v57
    s_mov_b32 s17, 0x110000
    buffer_store_dword v54, v123, s[40:43], s17 offen sc1
    v_cvt_pk_bf16_f32 v55, v58, v59
    s_mov_b32 s17, 0x150000
    buffer_store_dword v55, v123, s[40:43], s17 offen sc1
    v_pk_add_f32 v[56:57], v[100:101], v[88:89]
    v_pk_add_f32 v[58:59], v[100:101], v[88:89] neg_lo:[0,1] neg_hi:[0,1]
    v_cvt_pk_bf16_f32 v48, v56, v57
    s_mov_b32 s17, 0x200000
    buffer_store_dword v48, v123, s[40:43], s17 offen sc1
    v_cvt_pk_bf16_f32 v49, v58, v59
    s_mov_b32 s17, 0x240000
    buffer_store_dword v49, v123, s[40:43], s17 offen sc1
    v_pk_add_f32 v[56:57], v[102:103], v[92:93]
    v_pk_add_f32 v[58:59], v[102:103], v[92:93] neg_lo:[0,1] neg_hi:[0,1]
    v_cvt_pk_bf16_f32 v50, v56, v57
    s_mov_b32 s17, 0x210000
    buffer_store_dword v50, v123, s[40:43], s17 offen sc1
    v_cvt_pk_bf16_f32 v51, v58, v59
    s_mov_b32 s17, 0x250000
    buffer_store_dword v51, v123, s[40:43], s17 offen sc1
    v_pk_add_f32 v[56:57], v[114:115], v[86:87]
    v_pk_add_f32 v[58:59], v[114:115], v[86:87] neg_lo:[0,1] neg_hi:[0,1]
    v_cvt_pk_bf16_f32 v52, v56, v57
    s_mov_b32 s17, 0x300000
    buffer_store_dword v52, v123, s[40:43], s17 offen sc1
    v_cvt_pk_bf16_f32 v53, v58, v59
    s_mov_b32 s17, 0x340000
    buffer_store_dword v53, v123, s[40:43], s17 offen sc1
    v_pk_add_f32 v[56:57], v[118:119], v[94:95]
    v_pk_add_f32 v[58:59], v[118:119], v[94:95] neg_lo:[0,1] neg_hi:[0,1]
    v_cvt_pk_bf16_f32 v54, v56, v57
    s_mov_b32 s17, 0x310000
    buffer_store_dword v54, v123, s[40:43], s17 offen sc1
    v_cvt_pk_bf16_f32 v55, v58, v59
    s_mov_b32 s17, 0x350000
    buffer_store_dword v55, v123, s[40:43], s17 offen sc1
    s_branch L_dd_7
L_dc_9:
    v_pk_add_f32 v[66:67], v[104:105], v[116:117]
    v_pk_add_f32 v[70:71], v[104:105], v[116:117] neg_lo:[0,1] neg_hi:[0,1]
    v_cvt_pk_bf16_f32 v60, v66, v67
    s_mov_b32 s17, 0x80000
    buffer_store_dword v60, v123, s[40:43], s17 offen sc1
    v_cvt_pk_bf16_f32 v61, v70, v71
    s_mov_b32 s17, 0xc0000
    buffer_store_dword v61, v123, s[40:43], s17 offen sc1
    v_pk_add_f32 v[66:67], v[36:37], v[52:53]
    v_pk_add_f32 v[70:71], v[36:37], v[52:53] neg_lo:[0,1] neg_hi:[0,1]
    v_cvt_pk_bf16_f32 v62, v66, v67
    s_mov_b32 s17, 0x90000
    buffer_store_dword v62, v123, s[40:43], s17 offen sc1
    v_cvt_pk_bf16_f32 v63, v70, v71
    s_mov_b32 s17, 0xd0000
    buffer_store_dword v63, v123, s[40:43], s17 offen sc1
    v_pk_add_f32 v[66:67], v[108:109], v[82:83]
    v_pk_add_f32 v[70:71], v[108:109], v[82:83] neg_lo:[0,1] neg_hi:[0,1]
    v_cvt_pk_bf16_f32 v46, v66, v67
    s_mov_b32 s17, 0x180000
    buffer_store_dword v46, v123, s[40:43], s17 offen sc1
    v_cvt_pk_bf16_f32 v47, v70, v71
    s_mov_b32 s17, 0x1c0000
    buffer_store_dword v47, v123, s[40:43], s17 offen sc1
    v_pk_add_f32 v[66:67], v[40:41], v[56:57]
    v_pk_add_f32 v[70:71], v[40:41], v[56:57] neg_lo:[0,1] neg_hi:[0,1]
    v_cvt_pk_bf16_f32 v74, v66, v67
    s_mov_b32 s17, 0x190000
    buffer_store_dword v74, v123, s[40:43], s17 offen sc1
    v_cvt_pk_bf16_f32 v75, v70, v71
    s_mov_b32 s17, 0x1d0000
    buffer_store_dword v75, v123, s[40:43], s17 offen sc1
    v_pk_add_f32 v[66:67], v[110:111], v[90:91]
    v_pk_add_f32 v[70:71], v[110:111], v[90:91] neg_lo:[0,1] neg_hi:[0,1]
    v_cvt_pk_bf16_f32 v60, v66, v67
    s_mov_b32 s17, 0x280000
    buffer_store_dword v60, v123, s[40:43], s17 offen sc1
    v_cvt_pk_bf16_f32 v61, v70, v71
    s_mov_b32 s17, 0x2c0000
    buffer_store_dword v61, v123, s[40:43], s17 offen sc1
    v_pk_add_f32 v[66:67], v[42:43], v[58:59]
    v_pk_add_f32 v[70:71], v[42:43], v[58:59] neg_lo:[0,1] neg_hi:[0,1]
    v_cvt_pk_bf16_f32 v62, v66, v67
    s_mov_b32 s17, 0x290000
    buffer_store_dword v62, v123, s[40:43], s17 offen sc1
    v_cvt_pk_bf16_f32 v63, v70, v71
    s_mov_b32 s17, 0x2d0000
    buffer_store_dword v63, v123, s[40:43], s17 offen sc1
    v_pk_add_f32 v[66:67], v[106:107], v[32:33]
    v_pk_add_f32 v[70:71], v[106:107], v[32:33] neg_lo:[0,1] neg_hi:[0,1]
    v_cvt_pk_bf16_f32 v46, v66, v67
    s_mov_b32 s17, 0x380000
    buffer_store_dword v46, v123, s[40:43], s17 offen sc1
    v_cvt_pk_bf16_f32 v47, v70, v71
    s_mov_b32 s17, 0x3c0000
    buffer_store_dword v47, v123, s[40:43], s17 offen sc1
    v_pk_add_f32 v[66:67], v[38:39], v[54:55]
    v_pk_add_f32 v[70:71], v[38:39], v[54:55] neg_lo:[0,1] neg_hi:[0,1]
    v_cvt_pk_bf16_f32 v74, v66, v67
    s_mov_b32 s17, 0x390000
    buffer_store_dword v74, v123, s[40:43], s17 offen sc1
    v_cvt_pk_bf16_f32 v75, v70, v71
    s_mov_b32 s17, 0x3d0000
    buffer_store_dword v75, v123, s[40:43], s17 offen sc1
    s_branch L_dd_7
L_dc_10:
    v_cvt_pk_bf16_f32 v48, v104, v105
    s_mov_b32 s17, 0x0
    buffer_store_dword v48, v123, s[40:43], s17 offen sc1
    v_cvt_pk_bf16_f32 v49, v96, v97
    s_mov_b32 s17, 0x10000
    buffer_store_dword v49, v123, s[40:43], s17 offen sc1
    v_cvt_pk_bf16_f32 v50, v106, v107
    s_mov_b32 s17, 0x40000
    buffer_store_dword v50, v123, s[40:43], s17 offen sc1
    v_cvt_pk_bf16_f32 v51, v98, v99
    s_mov_b32 s17, 0x50000
    buffer_store_dword v51, v123, s[40:43], s17 offen sc1
    v_pk_add_f32 v[56:57], v[112:113], v[90:91] neg_lo:[0,1] neg_hi:[0,1]
    v_pk_add_f32 v[58:59], v[116:117], v[82:83]
    v_cvt_pk_bf16_f32 v52, v56, v57
    s_mov_b32 s17, 0x100000
    buffer_store_dword v52, v123, s[40:43], s17 offen sc1
    v_cvt_pk_bf16_f32 v53, v58, v59
    s_mov_b32 s17, 0x110000
    buffer_store_dword v53, v123, s[40:43], s17 offen sc1
    v_pk_add_f32 v[56:57], v[112:113], v[90:91]
    v_pk_add_f32 v[58:59], v[116:117], v[82:83] neg_lo:[0,1] neg_hi:[0,1]
    v_cvt_pk_bf16_f32 v54, v56, v57
    s_mov_b32 s17, 0x140000
    buffer_store_dword v54, v123, s[40:43], s17 offen sc1
    v_cvt_pk_bf16_f32 v55, v58, v59
    s_mov_b32 s17, 0x150000
    buffer_store_dword v55, v123, s[40:43], s17 offen sc1
    v_pk_add_f32 v[56:57], v[100:101], v[92:93] neg_lo:[0,1] neg_hi:[0,1]
    v_pk_add_f32 v[58:59], v[102:103], v[88:89]
    v_cvt_pk_bf16_f32 v48, v56, v57
    s_mov_b32 s17, 0x200000
    buffer_store_dword v48, v123, s[40:43], s17 offen sc1
    v_cvt_pk_bf16_f32 v49, v58, v59
    s_mov_b32 s17, 0x210000
    buffer_store_dword v49, v123, s[40:43], s17 offen sc1
    v_pk_add_f32 v[56:57], v[100:101], v[92:93]
    v_pk_add_f32 v[58:59], v[102:103], v[88:89] neg_lo:[0,1] neg_hi:[0,1]
    v_cvt_pk_bf16_f32 v50, v56, v57
    s_mov_b32 s17, 0x240000
    buffer_store_dword v50, v123, s[40:43], s17 offen sc1
    v_cvt_pk_bf16_f32 v51, v58, v59
    s_mov_b32 s17, 0x250000
    buffer_store_dword v51, v123, s[40:43], s17 offen sc1
    v_pk_add_f32 v[56:57], v[114:115], v[94:95] neg_lo:[0,1] neg_hi:[0,1]
    v_pk_add_f32 v[58:59], v[118:119], v[86:87]
    v_cvt_pk_bf16_f32 v52, v56, v57
    s_mov_b32 s17, 0x300000
    buffer_store_dword v52, v123, s[40:43], s17 offen sc1
    v_cvt_pk_bf16_f32 v53, v58, v59
    s_mov_b32 s17, 0x310000
    buffer_store_dword v53, v123, s[40:43], s17 offen sc1
    v_pk_add_f32 v[56:57], v[114:115], v[94:95]
    v_pk_add_f32 v[58:59], v[118:119], v[86:87] neg_lo:[0,1] neg_hi:[0,1]
    v_cvt_pk_bf16_f32 v54, v56, v57
    s_mov_b32 s17, 0x340000
    buffer_store_dword v54, v123, s[40:43], s17 offen sc1
    v_cvt_pk_bf16_f32 v55, v58, v59
    s_mov_b32 s17, 0x350000
    buffer_store_dword v55, v123, s[40:43], s17 offen sc1
    s_branch L_dd_7
L_dc_11:
    v_pk_add_f32 v[66:67], v[104:105], v[52:53] neg_lo:[0,1] neg_hi:[0,1]
    v_pk_add_f32 v[70:71], v[36:37], v[116:117]
    v_cvt_pk_bf16_f32 v60, v66, v67
    s_mov_b32 s17, 0x80000
    buffer_store_dword v60, v123, s[40:43], s17 offen sc1
    v_cvt_pk_bf16_f32 v61, v70, v71
    s_mov_b32 s17, 0x90000
    buffer_store_dword v61, v123, s[40:43], s17 offen sc1
    v_pk_add_f32 v[66:67], v[104:105], v[52:53]
    v_pk_add_f32 v[70:71], v[36:37], v[116:117] neg_lo:[0,1] neg_hi:[0,1]
    v_cvt_pk_bf16_f32 v62, v66, v67
    s_mov_b32 s17, 0xc0000
    buffer_store_dword v62, v123, s[40:43], s17 offen sc1
    v_cvt_pk_bf16_f32 v63, v70, v71
    s_mov_b32 s17, 0xd0000
    buffer_store_dword v63, v123, s[40:43], s17 offen sc1
    v_pk_add_f32 v[66:67], v[108:109], v[56:57] neg_lo:[0,1] neg_hi:[0,1]
    v_pk_add_f32 v[70:71], v[40:41], v[82:83]
    v_cvt_pk_bf16_f32 v46, v66, v67
    s_mov_b32 s17, 0x180000
    buffer_store_dword v46, v123, s[40:43], s17 offen sc1
    v_cvt_pk_bf16_f32 v47, v70, v71
    s_mov_b32 s17, 0x190000
    buffer_store_dword v47, v123, s[40:43], s17 offen sc1
    v_pk_add_f32 v[66:67], v[108:109], v[56:57]
    v_pk_add_f32 v[70:71], v[40:41], v[82:83] neg_lo:[0,1] neg_hi:[0,1]
    v_cvt_pk_bf16_f32 v74, v66, v67
    s_mov_b32 s17, 0x1c0000
    buffer_store_dword v74, v123, s[40:43], s17 offen sc1
    v_cvt_pk_bf16_f32 v75, v70, v71
    s_mov_b32 s17, 0x1d0000
    buffer_store_dword v75, v123, s[40:43], s17 offen sc1
    v_pk_add_f32 v[66:67], v[110:111], v[58:59] neg_lo:[0,1] neg_hi:[0,1]
    v_pk_add_f32 v[70:71], v[42:43], v[90:91]
    v_cvt_pk_bf16_f32 v60, v66, v67
    s_mov_b32 s17, 0x280000
    buffer_store_dword v60, v123, s[40:43], s17 offen sc1
    v_cvt_pk_bf16_f32 v61, v70, v71
    s_mov_b32 s17, 0x290000
    buffer_store_dword v61, v123, s[40:43], s17 offen sc1
    v_pk_add_f32 v[66:67], v[110:111], v[58:59]
    v_pk_add_f32 v[70:71], v[42:43], v[90:91] neg_lo:[0,1] neg_hi:[0,1]
    v_cvt_pk_bf16_f32 v62, v66, v67
    s_mov_b32 s17, 0x2c0000
    buffer_store_dword v62, v123, s[40:43], s17 offen sc1
    v_cvt_pk_bf16_f32 v63, v70, v71
    s_mov_b32 s17, 0x2d0000
    buffer_store_dword v63, v123, s[40:43], s17 offen sc1
    v_pk_add_f32 v[66:67], v[106:107], v[54:55] neg_lo:[0,1] neg_hi:[0,1]
    v_pk_add_f32 v[70:71], v[38:39], v[32:33]
    v_cvt_pk_bf16_f32 v46, v66, v67
    s_mov_b32 s17, 0x380000
    buffer_store_dword v46, v123, s[40:43], s17 offen sc1
    v_cvt_pk_bf16_f32 v47, v70, v71
    s_mov_b32 s17, 0x390000
    buffer_store_dword v47, v123, s[40:43], s17 offen sc1
    v_pk_add_f32 v[66:67], v[106:107], v[54:55]
    v_pk_add_f32 v[70:71], v[38:39], v[32:33] neg_lo:[0,1] neg_hi:[0,1]
    v_cvt_pk_bf16_f32 v74, v66, v67
    s_mov_b32 s17, 0x3c0000
    buffer_store_dword v74, v123, s[40:43], s17 offen sc1
    v_cvt_pk_bf16_f32 v75, v70, v71
    s_mov_b32 s17, 0x3d0000
    buffer_store_dword v75, v123, s[40:43], s17 offen sc1
L_dd_7:
    v_lshrrev_b32 v31, 1, v18
    s_lshl_b32 s17, s13, 2
    v_add_u32 v31, s17, v31
    v_bfe_u32 v29, v3, 1, 3
    v_xor_b32 v31, v31, v29
    v_lshlrev_b32 v31, 4, v31
    v_and_b32 v29, 1, v18
    v_lshl_add_u32 v31, v29, 3, v31
    v_and_b32 v29, 15, v3
    v_lshl_add_u32 v31, v29, 7, v31
    s_lshl_b32 s17, s12, 13
    v_add_u32 v31, s17, v31
    s_mul_i32 s83, s11, 1
    s_add_u32 s83, s83, s39
    v_add_u32 v9, s14, v4
    v_add_u32 v10, s14, v5
    v_add_u32 v11, s14, v6
    v_add_u32 v12, s14, v7
    v_add_u32 v13, s14, v8
    s_barrier
    ds_read_b64_tr_b16 v[48:49], v11 offset:0
    ds_read_b64_tr_b16 v[50:51], v11 offset:1792
    ds_read_b128 v[32:35], v9 offset:0
    ds_read_b64_tr_b16 v[52:53], v12 offset:32
    ds_read_b64_tr_b16 v[54:55], v12 offset:1824
    ds_read_b128 v[36:39], v9 offset:2048
    ds_read_b64_tr_b16 v[56:57], v11 offset:128
    ds_read_b64_tr_b16 v[58:59], v11 offset:1920
    ds_read_b128 v[40:43], v9 offset:4096
    ds_read_b64_tr_b16 v[60:61], v12 offset:160
    ds_read_b64_tr_b16 v[62:63], v12 offset:1952
    ds_read_b128 v[44:47], v9 offset:6144
    ds_read_b64_tr_b16 v[64:65], v11 offset:256
    ds_read_b64_tr_b16 v[66:67], v11 offset:2048
    ds_read_b64_tr_b16 v[68:69], v12 offset:288
    ds_read_b64_tr_b16 v[70:71], v12 offset:2080
    ds_read_b64_tr_b16 v[72:73], v13 offset:0
    ds_read_b64_tr_b16 v[74:75], v13 offset:1792
    s_waitcnt lgkmcnt(0)
    s_mov_b32 s15, 0
.p2align 6
L_g1_loop_12:
    s_sub_u32 s83, s83, 1
    s_cbranch_scc0 L_nox_13
    v_add_u32 v29, s14, v31
    v_xor_b32 v30, 32, v29
    ds_read_b64 v[240:241], v29 offset:0
    ds_read_b64 v[242:243], v30 offset:0
    ds_read_b64 v[244:245], v29 offset:2048
    ds_read_b64 v[246:247], v30 offset:2048
    ds_read_b64 v[248:249], v29 offset:4096
    ds_read_b64 v[250:251], v30 offset:4096
    ds_read_b64 v[252:253], v29 offset:6144
    ds_read_b64 v[254:255], v30 offset:6144
L_nox_13:
    v_mfma_f32_16x16x32_bf16 v[128:131], v[48:51], v[32:35], v[128:131]
    ds_read_b64_tr_b16 v[92:93], v11 offset:14336
    v_mfma_f32_16x16x32_bf16 v[132:135], v[48:51], v[36:39], v[132:135]
    ds_read_b64_tr_b16 v[94:95], v11 offset:16128
    v_mfma_f32_16x16x32_bf16 v[136:139], v[48:51], v[40:43], v[136:139]
    ds_read_b128 v[76:79], v10 offset:0
    v_mfma_f32_16x16x32_bf16 v[140:143], v[48:51], v[44:47], v[140:143]
    ds_read_b64_tr_b16 v[96:97], v12 offset:14368
    v_mfma_f32_16x16x32_bf16 v[156:159], v[52:55], v[44:47], v[156:159]
    ds_read_b64_tr_b16 v[98:99], v12 offset:16160
    v_mfma_f32_16x16x32_bf16 v[152:155], v[52:55], v[40:43], v[152:155]
    ds_read_b128 v[80:83], v10 offset:2048
    v_mfma_f32_16x16x32_bf16 v[148:151], v[52:55], v[36:39], v[148:151]
    ds_read_b64_tr_b16 v[100:101], v11 offset:14464
    v_mfma_f32_16x16x32_bf16 v[144:147], v[52:55], v[32:35], v[144:147]
    ds_read_b64_tr_b16 v[102:103], v11 offset:16256
    v_mfma_f32_16x16x32_bf16 v[160:163], v[56:59], v[32:35], v[160:163]
    ds_read_b128 v[84:87], v10 offset:4096
    v_mfma_f32_16x16x32_bf16 v[164:167], v[56:59], v[36:39], v[164:167]
    ds_read_b64_tr_b16 v[104:105], v12 offset:14496
    v_mfma_f32_16x16x32_bf16 v[168:171], v[56:59], v[40:43], v[168:171]
    ds_read_b64_tr_b16 v[106:107], v12 offset:16288
    v_mfma_f32_16x16x32_bf16 v[172:175], v[56:59], v[44:47], v[172:175]
    ds_read_b128 v[88:91], v10 offset:6144
    v_mfma_f32_16x16x32_bf16 v[188:191], v[60:63], v[44:47], v[188:191]
    ds_read_b64_tr_b16 v[108:109], v11 offset:14592
    v_mfma_f32_16x16x32_bf16 v[184:187], v[60:63], v[40:43], v[184:187]
    ds_read_b64_tr_b16 v[110:111], v11 offset:16384
    v_mfma_f32_16x16x32_bf16 v[180:183], v[60:63], v[36:39], v[180:183]
    ds_read_b64_tr_b16 v[112:113], v12 offset:14624
    v_mfma_f32_16x16x32_bf16 v[176:179], v[60:63], v[32:35], v[176:179]
    ds_read_b64_tr_b16 v[114:115], v12 offset:16416
    v_mfma_f32_16x16x32_bf16 v[192:195], v[64:67], v[32:35], v[192:195]
    ds_read_b64_tr_b16 v[116:117], v13 offset:14336
    v_mfma_f32_16x16x32_bf16 v[196:199], v[64:67], v[36:39], v[196:199]
    ds_read_b64_tr_b16 v[118:119], v13 offset:16128
    v_mfma_f32_16x16x32_bf16 v[200:203], v[64:67], v[40:43], v[200:203]
    s_add_u32 s14, s14, 45056
    v_mfma_f32_16x16x32_bf16 v[204:207], v[64:67], v[44:47], v[204:207]
    s_cmp_eq_u32 s14, 135168
    v_mfma_f32_16x16x32_bf16 v[220:223], v[68:71], v[44:47], v[220:223]
    s_cselect_b32 s14, 0, s14
    v_mfma_f32_16x16x32_bf16 v[216:219], v[68:71], v[40:43], v[216:219]
    v_add_u32 v9, s14, v4
    v_mfma_f32_16x16x32_bf16 v[212:215], v[68:71], v[36:39], v[212:215]
    v_add_u32 v10, s14, v5
    v_mfma_f32_16x16x32_bf16 v[208:211], v[68:71], v[32:35], v[208:211]
    v_add_u32 v11, s14, v6
    v_mfma_f32_16x16x32_bf16 v[224:227], v[72:75], v[32:35], v[224:227]
    v_add_u32 v12, s14, v7
    v_mfma_f32_16x16x32_bf16 v[228:231], v[72:75], v[36:39], v[228:231]
    v_add_u32 v13, s14, v8
    v_mfma_f32_16x16x32_bf16 v[232:235], v[72:75], v[40:43], v[232:235]
    v_mfma_f32_16x16x32_bf16 v[236:239], v[72:75], v[44:47], v[236:239]
    s_waitcnt lgkmcnt(0)
    s_barrier
    v_mfma_f32_16x16x32_bf16 v[128:131], v[92:95], v[76:79], v[128:131]
    ds_read_b64_tr_b16 v[48:49], v11 offset:0
    v_mfma_f32_16x16x32_bf16 v[132:135], v[92:95], v[80:83], v[132:135]
    ds_read_b64_tr_b16 v[50:51], v11 offset:1792
    v_mfma_f32_16x16x32_bf16 v[136:139], v[92:95], v[84:87], v[136:139]
    ds_read_b128 v[32:35], v9 offset:0
    v_mfma_f32_16x16x32_bf16 v[140:143], v[92:95], v[88:91], v[140:143]
    ds_read_b64_tr_b16 v[52:53], v12 offset:32
    v_mfma_f32_16x16x32_bf16 v[156:159], v[96:99], v[88:91], v[156:159]
    ds_read_b64_tr_b16 v[54:55], v12 offset:1824
    v_mfma_f32_16x16x32_bf16 v[152:155], v[96:99], v[84:87], v[152:155]
    ds_read_b128 v[36:39], v9 offset:2048
    v_mfma_f32_16x16x32_bf16 v[148:151], v[96:99], v[80:83], v[148:151]
    ds_read_b64_tr_b16 v[56:57], v11 offset:128
    v_mfma_f32_16x16x32_bf16 v[144:147], v[96:99], v[76:79], v[144:147]
    ds_read_b64_tr_b16 v[58:59], v11 offset:1920
    v_mfma_f32_16x16x32_bf16 v[160:163], v[100:103], v[76:79], v[160:163]
    ds_read_b128 v[40:43], v9 offset:4096
    v_mfma_f32_16x16x32_bf16 v[164:167], v[100:103], v[80:83], v[164:167]
    ds_read_b64_tr_b16 v[60:61], v12 offset:160
    v_mfma_f32_16x16x32_bf16 v[168:171], v[100:103], v[84:87], v[168:171]
    ds_read_b64_tr_b16 v[62:63], v12 offset:1952
    v_mfma_f32_16x16x32_bf16 v[172:175], v[100:103], v[88:91], v[172:175]
    ds_read_b128 v[44:47], v9 offset:6144
    v_mfma_f32_16x16x32_bf16 v[188:191], v[104:107], v[88:91], v[188:191]
    ds_read_b64_tr_b16 v[64:65], v11 offset:256
    v_mfma_f32_16x16x32_bf16 v[184:187], v[104:107], v[84:87], v[184:187]
    ds_read_b64_tr_b16 v[66:67], v11 offset:2048
    v_mfma_f32_16x16x32_bf16 v[180:183], v[104:107], v[80:83], v[180:183]
    ds_read_b64_tr_b16 v[68:69], v12 offset:288
    v_mfma_f32_16x16x32_bf16 v[176:179], v[104:107], v[76:79], v[176:179]
    ds_read_b64_tr_b16 v[70:71], v12 offset:2080
    v_mfma_f32_16x16x32_bf16 v[192:195], v[108:111], v[76:79], v[192:195]
    ds_read_b64_tr_b16 v[72:73], v13 offset:0
    v_mfma_f32_16x16x32_bf16 v[196:199], v[108:111], v[80:83], v[196:199]
    ds_read_b64_tr_b16 v[74:75], v13 offset:1792
    v_mfma_f32_16x16x32_bf16 v[200:203], v[108:111], v[84:87], v[200:203]
    s_add_u32 s15, s15, 1
    v_mfma_f32_16x16x32_bf16 v[204:207], v[108:111], v[88:91], v[204:207]
    s_cmp_lt_u32 s15, 5
    v_mfma_f32_16x16x32_bf16 v[220:223], v[112:115], v[88:91], v[220:223]
    v_mfma_f32_16x16x32_bf16 v[216:219], v[112:115], v[84:87], v[216:219]
    v_mfma_f32_16x16x32_bf16 v[212:215], v[112:115], v[80:83], v[212:215]
    v_mfma_f32_16x16x32_bf16 v[208:211], v[112:115], v[76:79], v[208:211]
    v_mfma_f32_16x16x32_bf16 v[224:227], v[116:119], v[76:79], v[224:227]
    v_mfma_f32_16x16x32_bf16 v[228:231], v[116:119], v[80:83], v[228:231]
    v_mfma_f32_16x16x32_bf16 v[232:235], v[116:119], v[84:87], v[232:235]
    v_mfma_f32_16x16x32_bf16 v[236:239], v[116:119], v[88:91], v[236:239]
    s_waitcnt lgkmcnt(0)
    s_cbranch_scc1 L_g1_loop_12
    s_sub_u32 s83, s83, 1
    s_cbranch_scc0 L_nox_14
    v_add_u32 v29, s14, v31
    v_xor_b32 v30, 32, v29
    ds_read_b64 v[240:241], v29 offset:0
    ds_read_b64 v[242:243], v30 offset:0
    ds_read_b64 v[244:245], v29 offset:2048
    ds_read_b64 v[246:247], v30 offset:2048
    ds_read_b64 v[248:249], v29 offset:4096
    ds_read_b64 v[250:251], v30 offset:4096
    ds_read_b64 v[252:253], v29 offset:6144
    ds_read_b64 v[254:255], v30 offset:6144
L_nox_14:
    v_mfma_f32_16x16x32_bf16 v[128:131], v[48:51], v[32:35], v[128:131]
    ds_read_b64_tr_b16 v[92:93], v11 offset:14336
    v_mfma_f32_16x16x32_bf16 v[132:135], v[48:51], v[36:39], v[132:135]
    ds_read_b64_tr_b16 v[94:95], v11 offset:16128
    v_mfma_f32_16x16x32_bf16 v[136:139], v[48:51], v[40:43], v[136:139]
    ds_read_b128 v[76:79], v10 offset:0
    v_mfma_f32_16x16x32_bf16 v[140:143], v[48:51], v[44:47], v[140:143]
    ds_read_b64_tr_b16 v[96:97], v12 offset:14368
    v_mfma_f32_16x16x32_bf16 v[156:159], v[52:55], v[44:47], v[156:159]
    ds_read_b64_tr_b16 v[98:99], v12 offset:16160
    v_mfma_f32_16x16x32_bf16 v[152:155], v[52:55], v[40:43], v[152:155]
    ds_read_b128 v[80:83], v10 offset:2048
    v_mfma_f32_16x16x32_bf16 v[148:151], v[52:55], v[36:39], v[148:151]
    ds_read_b64_tr_b16 v[100:101], v11 offset:14464
    v_mfma_f32_16x16x32_bf16 v[144:147], v[52:55], v[32:35], v[144:147]
    ds_read_b64_tr_b16 v[102:103], v11 offset:16256
    v_mfma_f32_16x16x32_bf16 v[160:163], v[56:59], v[32:35], v[160:163]
    ds_read_b128 v[84:87], v10 offset:4096
    v_mfma_f32_16x16x32_bf16 v[164:167], v[56:59], v[36:39], v[164:167]
    ds_read_b64_tr_b16 v[104:105], v12 offset:14496
    v_mfma_f32_16x16x32_bf16 v[168:171], v[56:59], v[40:43], v[168:171]
    ds_read_b64_tr_b16 v[106:107], v12 offset:16288
    v_mfma_f32_16x16x32_bf16 v[172:175], v[56:59], v[44:47], v[172:175]
    ds_read_b128 v[88:91], v10 offset:6144
    v_mfma_f32_16x16x32_bf16 v[188:191], v[60:63], v[44:47], v[188:191]
    ds_read_b64_tr_b16 v[108:109], v11 offset:14592
    v_mfma_f32_16x16x32_bf16 v[184:187], v[60:63], v[40:43], v[184:187]
    ds_read_b64_tr_b16 v[110:111], v11 offset:16384
    v_mfma_f32_16x16x32_bf16 v[180:183], v[60:63], v[36:39], v[180:183]
    ds_read_b64_tr_b16 v[112:113], v12 offset:14624
    v_mfma_f32_16x16x32_bf16 v[176:179], v[60:63], v[32:35], v[176:179]
    ds_read_b64_tr_b16 v[114:115], v12 offset:16416
    v_mfma_f32_16x16x32_bf16 v[192:195], v[64:67], v[32:35], v[192:195]
    ds_read_b64_tr_b16 v[116:117], v13 offset:14336
    v_mfma_f32_16x16x32_bf16 v[196:199], v[64:67], v[36:39], v[196:199]
    ds_read_b64_tr_b16 v[118:119], v13 offset:16128
    v_mfma_f32_16x16x32_bf16 v[200:203], v[64:67], v[40:43], v[200:203]
    s_add_u32 s14, s14, 45056
    v_mfma_f32_16x16x32_bf16 v[204:207], v[64:67], v[44:47], v[204:207]
    s_cmp_eq_u32 s14, 135168
    v_mfma_f32_16x16x32_bf16 v[220:223], v[68:71], v[44:47], v[220:223]
    s_cselect_b32 s14, 0, s14
    v_mfma_f32_16x16x32_bf16 v[216:219], v[68:71], v[40:43], v[216:219]
    v_add_u32 v9, s14, v4
    v_mfma_f32_16x16x32_bf16 v[212:215], v[68:71], v[36:39], v[212:215]
    v_add_u32 v10, s14, v5
    v_mfma_f32_16x16x32_bf16 v[208:211], v[68:71], v[32:35], v[208:211]
    v_add_u32 v11, s14, v6
    v_mfma_f32_16x16x32_bf16 v[224:227], v[72:75], v[32:35], v[224:227]
    v_add_u32 v12, s14, v7
    v_mfma_f32_16x16x32_bf16 v[228:231], v[72:75], v[36:39], v[228:231]
    v_add_u32 v13, s14, v8
    v_mfma_f32_16x16x32_bf16 v[232:235], v[72:75], v[40:43], v[232:235]
    v_mfma_f32_16x16x32_bf16 v[236:239], v[72:75], v[44:47], v[236:239]
    s_waitcnt lgkmcnt(0)
    s_waitcnt vmcnt(0)
    s_barrier
    v_mfma_f32_16x16x32_bf16 v[128:131], v[92:95], v[76:79], v[128:131]
    ds_read_b64_tr_b16 v[48:49], v11 offset:0
    v_mfma_f32_16x16x32_bf16 v[132:135], v[92:95], v[80:83], v[132:135]
    ds_read_b64_tr_b16 v[50:51], v11 offset:1792
    v_mfma_f32_16x16x32_bf16 v[136:139], v[92:95], v[84:87], v[136:139]
    ds_read_b128 v[32:35], v9 offset:0
    v_mfma_f32_16x16x32_bf16 v[140:143], v[92:95], v[88:91], v[140:143]
    ds_read_b64_tr_b16 v[52:53], v12 offset:32
    v_mfma_f32_16x16x32_bf16 v[156:159], v[96:99], v[88:91], v[156:159]
    ds_read_b64_tr_b16 v[54:55], v12 offset:1824
    v_mfma_f32_16x16x32_bf16 v[152:155], v[96:99], v[84:87], v[152:155]
    ds_read_b128 v[36:39], v9 offset:2048
    v_mfma_f32_16x16x32_bf16 v[148:151], v[96:99], v[80:83], v[148:151]
    ds_read_b64_tr_b16 v[56:57], v11 offset:128
    v_mfma_f32_16x16x32_bf16 v[144:147], v[96:99], v[76:79], v[144:147]
    ds_read_b64_tr_b16 v[58:59], v11 offset:1920
    v_mfma_f32_16x16x32_bf16 v[160:163], v[100:103], v[76:79], v[160:163]
    ds_read_b128 v[40:43], v9 offset:4096
    v_mfma_f32_16x16x32_bf16 v[164:167], v[100:103], v[80:83], v[164:167]
    ds_read_b64_tr_b16 v[60:61], v12 offset:160
    v_mfma_f32_16x16x32_bf16 v[168:171], v[100:103], v[84:87], v[168:171]
    ds_read_b64_tr_b16 v[62:63], v12 offset:1952
    v_mfma_f32_16x16x32_bf16 v[172:175], v[100:103], v[88:91], v[172:175]
    ds_read_b128 v[44:47], v9 offset:6144
    v_mfma_f32_16x16x32_bf16 v[188:191], v[104:107], v[88:91], v[188:191]
    ds_read_b64_tr_b16 v[64:65], v11 offset:256
    v_mfma_f32_16x16x32_bf16 v[184:187], v[104:107], v[84:87], v[184:187]
    ds_read_b64_tr_b16 v[66:67], v11 offset:2048
    v_mfma_f32_16x16x32_bf16 v[180:183], v[104:107], v[80:83], v[180:183]
    ds_read_b64_tr_b16 v[68:69], v12 offset:288
    v_mfma_f32_16x16x32_bf16 v[176:179], v[104:107], v[76:79], v[176:179]
    ds_read_b64_tr_b16 v[70:71], v12 offset:2080
    v_mfma_f32_16x16x32_bf16 v[192:195], v[108:111], v[76:79], v[192:195]
    ds_read_b64_tr_b16 v[72:73], v13 offset:0
    v_mfma_f32_16x16x32_bf16 v[196:199], v[108:111], v[80:83], v[196:199]
    ds_read_b64_tr_b16 v[74:75], v13 offset:1792
    v_mfma_f32_16x16x32_bf16 v[200:203], v[108:111], v[84:87], v[200:203]
    v_mfma_f32_16x16x32_bf16 v[204:207], v[108:111], v[88:91], v[204:207]
    v_mfma_f32_16x16x32_bf16 v[220:223], v[112:115], v[88:91], v[220:223]
    v_mfma_f32_16x16x32_bf16 v[216:219], v[112:115], v[84:87], v[216:219]
    v_mfma_f32_16x16x32_bf16 v[212:215], v[112:115], v[80:83], v[212:215]
    v_mfma_f32_16x16x32_bf16 v[208:211], v[112:115], v[76:79], v[208:211]
    v_mfma_f32_16x16x32_bf16 v[224:227], v[116:119], v[76:79], v[224:227]
    v_mfma_f32_16x16x32_bf16 v[228:231], v[116:119], v[80:83], v[228:231]
    v_mfma_f32_16x16x32_bf16 v[232:235], v[116:119], v[84:87], v[232:235]
    v_mfma_f32_16x16x32_bf16 v[236:239], v[116:119], v[88:91], v[236:239]
    s_waitcnt lgkmcnt(0)
    s_mov_b32 s15, 0
.p2align 6
L_g1_loop_15:
    s_sub_u32 s83, s83, 1
    s_cbranch_scc0 L_nox_16
    v_add_u32 v29, s14, v31
    v_xor_b32 v30, 32, v29
    ds_read_b64 v[240:241], v29 offset:0
    ds_read_b64 v[242:243], v30 offset:0
    ds_read_b64 v[244:245], v29 offset:2048
    ds_read_b64 v[246:247], v30 offset:2048
    ds_read_b64 v[248:249], v29 offset:4096
    ds_read_b64 v[250:251], v30 offset:4096
    ds_read_b64 v[252:253], v29 offset:6144
    ds_read_b64 v[254:255], v30 offset:6144
L_nox_16:
    v_mfma_f32_16x16x32_bf16 v[128:131], v[48:51], v[32:35], v[128:131]
    ds_read_b64_tr_b16 v[92:93], v11 offset:14336
    v_mfma_f32_16x16x32_bf16 v[132:135], v[48:51], v[36:39], v[132:135]
    ds_read_b64_tr_b16 v[94:95], v11 offset:16128
    v_mfma_f32_16x16x32_bf16 v[136:139], v[48:51], v[40:43], v[136:139]
    ds_read_b128 v[76:79], v10 offset:0
    v_mfma_f32_16x16x32_bf16 v[140:143], v[48:51], v[44:47], v[140:143]
    ds_read_b64_tr_b16 v[96:97], v12 offset:14368
    v_mfma_f32_16x16x32_bf16 v[156:159], v[52:55], v[44:47], v[156:159]
    ds_read_b64_tr_b16 v[98:99], v12 offset:16160
    v_mfma_f32_16x16x32_bf16 v[152:155], v[52:55], v[40:43], v[152:155]
    ds_read_b128 v[80:83], v10 offset:2048
    v_mfma_f32_16x16x32_bf16 v[148:151], v[52:55], v[36:39], v[148:151]
    ds_read_b64_tr_b16 v[100:101], v11 offset:14464
    v_mfma_f32_16x16x32_bf16 v[144:147], v[52:55], v[32:35], v[144:147]
    ds_read_b64_tr_b16 v[102:103], v11 offset:16256
    v_mfma_f32_16x16x32_bf16 v[160:163], v[56:59], v[32:35], v[160:163]
    ds_read_b128 v[84:87], v10 offset:4096
    v_mfma_f32_16x16x32_bf16 v[164:167], v[56:59], v[36:39], v[164:167]
    ds_read_b64_tr_b16 v[104:105], v12 offset:14496
    v_mfma_f32_16x16x32_bf16 v[168:171], v[56:59], v[40:43], v[168:171]
    ds_read_b64_tr_b16 v[106:107], v12 offset:16288
    v_mfma_f32_16x16x32_bf16 v[172:175], v[56:59], v[44:47], v[172:175]
    ds_read_b128 v[88:91], v10 offset:6144
    v_mfma_f32_16x16x32_bf16 v[188:191], v[60:63], v[44:47], v[188:191]
    ds_read_b64_tr_b16 v[108:109], v11 offset:14592
    v_mfma_f32_16x16x32_bf16 v[184:187], v[60:63], v[40:43], v[184:187]
    ds_read_b64_tr_b16 v[110:111], v11 offset:16384
    v_mfma_f32_16x16x32_bf16 v[180:183], v[60:63], v[36:39], v[180:183]
    ds_read_b64_tr_b16 v[112:113], v12 offset:14624
    v_mfma_f32_16x16x32_bf16 v[176:179], v[60:63], v[32:35], v[176:179]
    ds_read_b64_tr_b16 v[114:115], v12 offset:16416
    v_mfma_f32_16x16x32_bf16 v[192:195], v[64:67], v[32:35], v[192:195]
    ds_read_b64_tr_b16 v[116:117], v13 offset:14336
    v_mfma_f32_16x16x32_bf16 v[196:199], v[64:67], v[36:39], v[196:199]
    ds_read_b64_tr_b16 v[118:119], v13 offset:16128
    v_mfma_f32_16x16x32_bf16 v[200:203], v[64:67], v[40:43], v[200:203]
    s_add_u32 s14, s14, 45056
    v_mfma_f32_16x16x32_bf16 v[204:207], v[64:67], v[44:47], v[204:207]
    s_cmp_eq_u32 s14, 135168
    v_mfma_f32_16x16x32_bf16 v[220:223], v[68:71], v[44:47], v[220:223]
    s_cselect_b32 s14, 0, s14
    v_mfma_f32_16x16x32_bf16 v[216:219], v[68:71], v[40:43], v[216:219]
    v_add_u32 v9, s14, v4
    v_mfma_f32_16x16x32_bf16 v[212:215], v[68:71], v[36:39], v[212:215]
    v_add_u32 v10, s14, v5
    v_mfma_f32_16x16x32_bf16 v[208:211], v[68:71], v[32:35], v[208:211]
    v_add_u32 v11, s14, v6
    v_mfma_f32_16x16x32_bf16 v[224:227], v[72:75], v[32:35], v[224:227]
    v_add_u32 v12, s14, v7
    v_mfma_f32_16x16x32_bf16 v[228:231], v[72:75], v[36:39], v[228:231]
    v_add_u32 v13, s14, v8
    v_mfma_f32_16x16x32_bf16 v[232:235], v[72:75], v[40:43], v[232:235]
    v_mfma_f32_16x16x32_bf16 v[236:239], v[72:75], v[44:47], v[236:239]
    s_waitcnt lgkmcnt(0)
    s_barrier
    v_mfma_f32_16x16x32_bf16 v[128:131], v[92:95], v[76:79], v[128:131]
    ds_read_b64_tr_b16 v[48:49], v11 offset:0
    v_mfma_f32_16x16x32_bf16 v[132:135], v[92:95], v[80:83], v[132:135]
    ds_read_b64_tr_b16 v[50:51], v11 offset:1792
    v_mfma_f32_16x16x32_bf16 v[136:139], v[92:95], v[84:87], v[136:139]
    ds_read_b128 v[32:35], v9 offset:0
    v_mfma_f32_16x16x32_bf16 v[140:143], v[92:95], v[88:91], v[140:143]
    ds_read_b64_tr_b16 v[52:53], v12 offset:32
    v_mfma_f32_16x16x32_bf16 v[156:159], v[96:99], v[88:91], v[156:159]
    ds_read_b64_tr_b16 v[54:55], v12 offset:1824
    v_mfma_f32_16x16x32_bf16 v[152:155], v[96:99], v[84:87], v[152:155]
    ds_read_b128 v[36:39], v9 offset:2048
    v_mfma_f32_16x16x32_bf16 v[148:151], v[96:99], v[80:83], v[148:151]
    ds_read_b64_tr_b16 v[56:57], v11 offset:128
    v_mfma_f32_16x16x32_bf16 v[144:147], v[96:99], v[76:79], v[144:147]
    ds_read_b64_tr_b16 v[58:59], v11 offset:1920
    v_mfma_f32_16x16x32_bf16 v[160:163], v[100:103], v[76:79], v[160:163]
    ds_read_b128 v[40:43], v9 offset:4096
    v_mfma_f32_16x16x32_bf16 v[164:167], v[100:103], v[80:83], v[164:167]
    ds_read_b64_tr_b16 v[60:61], v12 offset:160
    v_mfma_f32_16x16x32_bf16 v[168:171], v[100:103], v[84:87], v[168:171]
    ds_read_b64_tr_b16 v[62:63], v12 offset:1952
    v_mfma_f32_16x16x32_bf16 v[172:175], v[100:103], v[88:91], v[172:175]
    ds_read_b128 v[44:47], v9 offset:6144
    v_mfma_f32_16x16x32_bf16 v[188:191], v[104:107], v[88:91], v[188:191]
    ds_read_b64_tr_b16 v[64:65], v11 offset:256
    v_mfma_f32_16x16x32_bf16 v[184:187], v[104:107], v[84:87], v[184:187]
    ds_read_b64_tr_b16 v[66:67], v11 offset:2048
    v_mfma_f32_16x16x32_bf16 v[180:183], v[104:107], v[80:83], v[180:183]
    ds_read_b64_tr_b16 v[68:69], v12 offset:288
    v_mfma_f32_16x16x32_bf16 v[176:179], v[104:107], v[76:79], v[176:179]
    ds_read_b64_tr_b16 v[70:71], v12 offset:2080
    v_mfma_f32_16x16x32_bf16 v[192:195], v[108:111], v[76:79], v[192:195]
    ds_read_b64_tr_b16 v[72:73], v13 offset:0
    v_mfma_f32_16x16x32_bf16 v[196:199], v[108:111], v[80:83], v[196:199]
    ds_read_b64_tr_b16 v[74:75], v13 offset:1792
    v_mfma_f32_16x16x32_bf16 v[200:203], v[108:111], v[84:87], v[200:203]
    s_add_u32 s15, s15, 1
    v_mfma_f32_16x16x32_bf16 v[204:207], v[108:111], v[88:91], v[204:207]
    s_cmp_lt_u32 s15, 9
    v_mfma_f32_16x16x32_bf16 v[220:223], v[112:115], v[88:91], v[220:223]
    v_mfma_f32_16x16x32_bf16 v[216:219], v[112:115], v[84:87], v[216:219]
    v_mfma_f32_16x16x32_bf16 v[212:215], v[112:115], v[80:83], v[212:215]
    v_mfma_f32_16x16x32_bf16 v[208:211], v[112:115], v[76:79], v[208:211]
    v_mfma_f32_16x16x32_bf16 v[224:227], v[116:119], v[76:79], v[224:227]
    v_mfma_f32_16x16x32_bf16 v[228:231], v[116:119], v[80:83], v[228:231]
    v_mfma_f32_16x16x32_bf16 v[232:235], v[116:119], v[84:87], v[232:235]
    v_mfma_f32_16x16x32_bf16 v[236:239], v[116:119], v[88:91], v[236:239]
    s_waitcnt lgkmcnt(0)
    s_cbranch_scc1 L_g1_loop_15
    s_sub_u32 s83, s83, 1
    s_cbranch_scc0 L_nox_17
    v_add_u32 v29, s14, v31
    v_xor_b32 v30, 32, v29
    ds_read_b64 v[240:241], v29 offset:0
    ds_read_b64 v[242:243], v30 offset:0
    ds_read_b64 v[244:245], v29 offset:2048
    ds_read_b64 v[246:247], v30 offset:2048
    ds_read_b64 v[248:249], v29 offset:4096
    ds_read_b64 v[250:251], v30 offset:4096
    ds_read_b64 v[252:253], v29 offset:6144
    ds_read_b64 v[254:255], v30 offset:6144
L_nox_17:
    v_mfma_f32_16x16x32_bf16 v[128:131], v[48:51], v[32:35], v[128:131]
    ds_read_b64_tr_b16 v[92:93], v11 offset:14336
    v_mfma_f32_16x16x32_bf16 v[132:135], v[48:51], v[36:39], v[132:135]
    ds_read_b64_tr_b16 v[94:95], v11 offset:16128
    v_mfma_f32_16x16x32_bf16 v[136:139], v[48:51], v[40:43], v[136:139]
    ds_read_b128 v[76:79], v10 offset:0
    v_mfma_f32_16x16x32_bf16 v[140:143], v[48:51], v[44:47], v[140:143]
    ds_read_b64_tr_b16 v[96:97], v12 offset:14368
    v_mfma_f32_16x16x32_bf16 v[156:159], v[52:55], v[44:47], v[156:159]
    ds_read_b64_tr_b16 v[98:99], v12 offset:16160
    v_mfma_f32_16x16x32_bf16 v[152:155], v[52:55], v[40:43], v[152:155]
    ds_read_b128 v[80:83], v10 offset:2048
    v_mfma_f32_16x16x32_bf16 v[148:151], v[52:55], v[36:39], v[148:151]
    ds_read_b64_tr_b16 v[100:101], v11 offset:14464
    v_mfma_f32_16x16x32_bf16 v[144:147], v[52:55], v[32:35], v[144:147]
    ds_read_b64_tr_b16 v[102:103], v11 offset:16256
    v_mfma_f32_16x16x32_bf16 v[160:163], v[56:59], v[32:35], v[160:163]
    ds_read_b128 v[84:87], v10 offset:4096
    v_mfma_f32_16x16x32_bf16 v[164:167], v[56:59], v[36:39], v[164:167]
    ds_read_b64_tr_b16 v[104:105], v12 offset:14496
    v_mfma_f32_16x16x32_bf16 v[168:171], v[56:59], v[40:43], v[168:171]
    ds_read_b64_tr_b16 v[106:107], v12 offset:16288
    v_mfma_f32_16x16x32_bf16 v[172:175], v[56:59], v[44:47], v[172:175]
    ds_read_b128 v[88:91], v10 offset:6144
    v_mfma_f32_16x16x32_bf16 v[188:191], v[60:63], v[44:47], v[188:191]
    ds_read_b64_tr_b16 v[108:109], v11 offset:14592
    v_mfma_f32_16x16x32_bf16 v[184:187], v[60:63], v[40:43], v[184:187]
    ds_read_b64_tr_b16 v[110:111], v11 offset:16384
    v_mfma_f32_16x16x32_bf16 v[180:183], v[60:63], v[36:39], v[180:183]
    ds_read_b64_tr_b16 v[112:113], v12 offset:14624
    v_mfma_f32_16x16x32_bf16 v[176:179], v[60:63], v[32:35], v[176:179]
    ds_read_b64_tr_b16 v[114:115], v12 offset:16416
    v_mfma_f32_16x16x32_bf16 v[192:195], v[64:67], v[32:35], v[192:195]
    ds_read_b64_tr_b16 v[116:117], v13 offset:14336
    v_mfma_f32_16x16x32_bf16 v[196:199], v[64:67], v[36:39], v[196:199]
    ds_read_b64_tr_b16 v[118:119], v13 offset:16128
    v_mfma_f32_16x16x32_bf16 v[200:203], v[64:67], v[40:43], v[200:203]
    v_add_u32 v9, 0x0, v4
    v_mfma_f32_16x16x32_bf16 v[204:207], v[64:67], v[44:47], v[204:207]
    v_add_u32 v10, 0x0, v5
    v_mfma_f32_16x16x32_bf16 v[220:223], v[68:71], v[44:47], v[220:223]
    v_add_u32 v11, 0x0, v14
    v_mfma_f32_16x16x32_bf16 v[216:219], v[68:71], v[40:43], v[216:219]
    v_add_u32 v12, 0x0, v15
    v_mfma_f32_16x16x32_bf16 v[212:215], v[68:71], v[36:39], v[212:215]
    v_mfma_f32_16x16x32_bf16 v[208:211], v[68:71], v[32:35], v[208:211]
    v_mfma_f32_16x16x32_bf16 v[224:227], v[72:75], v[32:35], v[224:227]
    v_mfma_f32_16x16x32_bf16 v[228:231], v[72:75], v[36:39], v[228:231]
    v_mfma_f32_16x16x32_bf16 v[232:235], v[72:75], v[40:43], v[232:235]
    v_mfma_f32_16x16x32_bf16 v[236:239], v[72:75], v[44:47], v[236:239]
    s_waitcnt lgkmcnt(0)
    s_barrier
    v_mfma_f32_16x16x32_bf16 v[128:131], v[92:95], v[76:79], v[128:131]
    ds_read_b128 v[32:35], v26 offset:0
    v_mfma_f32_16x16x32_bf16 v[132:135], v[92:95], v[80:83], v[132:135]
    ds_read_b128 v[36:39], v26 offset:64
    v_mfma_f32_16x16x32_bf16 v[136:139], v[92:95], v[84:87], v[136:139]
    ds_read_b128 v[40:43], v26 offset:256
    v_mfma_f32_16x16x32_bf16 v[140:143], v[92:95], v[88:91], v[140:143]
    ds_read_b128 v[44:47], v26 offset:320
    v_mfma_f32_16x16x32_bf16 v[156:159], v[96:99], v[88:91], v[156:159]
    ds_read_b128 v[48:51], v26 offset:512
    v_mfma_f32_16x16x32_bf16 v[152:155], v[96:99], v[84:87], v[152:155]
    ds_read_b128 v[52:55], v26 offset:576
    v_mfma_f32_16x16x32_bf16 v[148:151], v[96:99], v[80:83], v[148:151]
    ds_read_b128 v[56:59], v27
    v_mfma_f32_16x16x32_bf16 v[144:147], v[96:99], v[76:79], v[144:147]
    ds_read_b64 v[60:61], v28 offset:0
    v_mfma_f32_16x16x32_bf16 v[160:163], v[100:103], v[76:79], v[160:163]
    ds_read_b64 v[62:63], v28 offset:128
    v_mfma_f32_16x16x32_bf16 v[164:167], v[100:103], v[80:83], v[164:167]
    ds_read_b64 v[64:65], v28 offset:256
    v_mfma_f32_16x16x32_bf16 v[168:171], v[100:103], v[84:87], v[168:171]
    ds_read_b64 v[66:67], v28 offset:384
    v_mfma_f32_16x16x32_bf16 v[172:175], v[100:103], v[88:91], v[172:175]
    v_mfma_f32_16x16x32_bf16 v[188:191], v[104:107], v[88:91], v[188:191]
    v_mfma_f32_16x16x32_bf16 v[184:187], v[104:107], v[84:87], v[184:187]
    v_mfma_f32_16x16x32_bf16 v[180:183], v[104:107], v[80:83], v[180:183]
    v_mfma_f32_16x16x32_bf16 v[176:179], v[104:107], v[76:79], v[176:179]
    v_mfma_f32_16x16x32_bf16 v[192:195], v[108:111], v[76:79], v[192:195]
    v_mfma_f32_16x16x32_bf16 v[196:199], v[108:111], v[80:83], v[196:199]
    v_mfma_f32_16x16x32_bf16 v[200:203], v[108:111], v[84:87], v[200:203]
    v_mfma_f32_16x16x32_bf16 v[204:207], v[108:111], v[88:91], v[204:207]
    v_mfma_f32_16x16x32_bf16 v[220:223], v[112:115], v[88:91], v[220:223]
    v_mfma_f32_16x16x32_bf16 v[216:219], v[112:115], v[84:87], v[216:219]
    v_mfma_f32_16x16x32_bf16 v[212:215], v[112:115], v[80:83], v[212:215]
    v_mfma_f32_16x16x32_bf16 v[208:211], v[112:115], v[76:79], v[208:211]
    v_mfma_f32_16x16x32_bf16 v[224:227], v[116:119], v[76:79], v[224:227]
    v_mfma_f32_16x16x32_bf16 v[228:231], v[116:119], v[80:83], v[228:231]
    v_mfma_f32_16x16x32_bf16 v[232:235], v[116:119], v[84:87], v[232:235]
    v_mfma_f32_16x16x32_bf16 v[236:239], v[116:119], v[88:91], v[236:239]
    s_waitcnt lgkmcnt(0)
    v_rcp_f32 v69, v61
    v_mul_f32 v68, s80, v61
    v_rcp_f32 v71, v63
    v_mul_f32 v70, s80, v63
    v_rcp_f32 v73, v65
    v_mul_f32 v72, s80, v65
    v_rcp_f32 v75, v67
    v_mul_f32 v74, s80, v67
    s_mov_b32 s16, 0
    s_mov_b32 s17, 16384
    s_mov_b32 s18, 32768
    v_pk_fma_f32 v[128:129], v[32:33], v[60:61], v[128:129] op_sel_hi:[1,0,1] neg_lo:[0,1,0] neg_hi:[0,1,0]
    v_pk_fma_f32 v[130:131], v[34:35], v[60:61], v[130:131] op_sel_hi:[1,0,1] neg_lo:[0,1,0] neg_hi:[0,1,0]
    v_pk_fma_f32 v[144:145], v[36:37], v[60:61], v[144:145] op_sel_hi:[1,0,1] neg_lo:[0,1,0] neg_hi:[0,1,0]
    v_pk_fma_f32 v[146:147], v[38:39], v[60:61], v[146:147] op_sel_hi:[1,0,1] neg_lo:[0,1,0] neg_hi:[0,1,0]
    v_pk_mul_f32 v[76:77], v[128:129], v[68:69] op_sel_hi:[1,0]
    v_pk_mul_f32 v[78:79], v[130:131], v[68:69] op_sel_hi:[1,0]
    v_pk_mul_f32 v[80:81], v[144:145], v[68:69] op_sel_hi:[1,0]
    v_pk_mul_f32 v[82:83], v[146:147], v[68:69] op_sel_hi:[1,0]
    v_exp_f32 v76, v76
    v_exp_f32 v77, v77
    v_exp_f32 v78, v78
    v_exp_f32 v79, v79
    v_exp_f32 v80, v80
    v_exp_f32 v81, v81
    v_exp_f32 v82, v82
    v_exp_f32 v83, v83
    v_pk_fma_f32 v[76:77], v[76:77], v[68:69], v[68:69] op_sel:[0,1,1]
    v_pk_fma_f32 v[78:79], v[78:79], v[68:69], v[68:69] op_sel:[0,1,1]
    v_pk_fma_f32 v[80:81], v[80:81], v[68:69], v[68:69] op_sel:[0,1,1]
    v_pk_fma_f32 v[82:83], v[82:83], v[68:69], v[68:69] op_sel:[0,1,1]
    v_rcp_f32 v76, v76
    v_rcp_f32 v77, v77
    v_rcp_f32 v78, v78
    v_rcp_f32 v79, v79
    v_rcp_f32 v80, v80
    v_rcp_f32 v81, v81
    v_rcp_f32 v82, v82
    v_rcp_f32 v83, v83
    v_pk_mul_f32 v[128:129], v[128:129], v[76:77]
    v_pk_mul_f32 v[130:131], v[130:131], v[78:79]
    v_pk_mul_f32 v[144:145], v[144:145], v[80:81]
    v_pk_mul_f32 v[146:147], v[146:147], v[82:83]
    v_cvt_pk_bf16_f32 v88, v128, v129
    v_cvt_pk_bf16_f32 v89, v130, v131
    v_cvt_pk_bf16_f32 v90, v144, v145
    v_cvt_pk_bf16_f32 v91, v146, v147
    s_nop 1
    v_permlane16_swap_b32 v88, v90
    v_permlane16_swap_b32 v89, v91
    buffer_store_dwordx4 v[88:91], v17, s[40:43], s16 offen offset:0 sc1
    v_pk_fma_f32 v[132:133], v[32:33], v[62:63], v[132:133] op_sel_hi:[1,0,1] neg_lo:[0,1,0] neg_hi:[0,1,0]
    v_pk_fma_f32 v[134:135], v[34:35], v[62:63], v[134:135] op_sel_hi:[1,0,1] neg_lo:[0,1,0] neg_hi:[0,1,0]
    v_pk_fma_f32 v[148:149], v[36:37], v[62:63], v[148:149] op_sel_hi:[1,0,1] neg_lo:[0,1,0] neg_hi:[0,1,0]
    v_pk_fma_f32 v[150:151], v[38:39], v[62:63], v[150:151] op_sel_hi:[1,0,1] neg_lo:[0,1,0] neg_hi:[0,1,0]
    v_pk_mul_f32 v[76:77], v[132:133], v[70:71] op_sel_hi:[1,0]
    v_pk_mul_f32 v[78:79], v[134:135], v[70:71] op_sel_hi:[1,0]
    v_pk_mul_f32 v[80:81], v[148:149], v[70:71] op_sel_hi:[1,0]
    v_pk_mul_f32 v[82:83], v[150:151], v[70:71] op_sel_hi:[1,0]
    v_exp_f32 v76, v76
    v_exp_f32 v77, v77
    v_exp_f32 v78, v78
    v_exp_f32 v79, v79
    v_exp_f32 v80, v80
    v_exp_f32 v81, v81
    v_exp_f32 v82, v82
    v_exp_f32 v83, v83
    v_pk_fma_f32 v[76:77], v[76:77], v[70:71], v[70:71] op_sel:[0,1,1]
    v_pk_fma_f32 v[78:79], v[78:79], v[70:71], v[70:71] op_sel:[0,1,1]
    v_pk_fma_f32 v[80:81], v[80:81], v[70:71], v[70:71] op_sel:[0,1,1]
    v_pk_fma_f32 v[82:83], v[82:83], v[70:71], v[70:71] op_sel:[0,1,1]
    v_rcp_f32 v76, v76
    v_rcp_f32 v77, v77
    v_rcp_f32 v78, v78
    v_rcp_f32 v79, v79
    v_rcp_f32 v80, v80
    v_rcp_f32 v81, v81
    v_rcp_f32 v82, v82
    v_rcp_f32 v83, v83
    v_pk_mul_f32 v[132:133], v[132:133], v[76:77]
    v_pk_mul_f32 v[134:135], v[134:135], v[78:79]
    v_pk_mul_f32 v[148:149], v[148:149], v[80:81]
    v_pk_mul_f32 v[150:151], v[150:151], v[82:83]
    v_cvt_pk_bf16_f32 v92, v132, v133
    v_cvt_pk_bf16_f32 v93, v134, v135
    v_cvt_pk_bf16_f32 v94, v148, v149
    v_cvt_pk_bf16_f32 v95, v150, v151
    s_nop 1
    v_permlane16_swap_b32 v92, v94
    v_permlane16_swap_b32 v93, v95
    buffer_store_dwordx4 v[92:95], v17, s[40:43], s16 offen offset:1024 sc1
    v_pk_fma_f32 v[136:137], v[32:33], v[64:65], v[136:137] op_sel_hi:[1,0,1] neg_lo:[0,1,0] neg_hi:[0,1,0]
    v_pk_fma_f32 v[138:139], v[34:35], v[64:65], v[138:139] op_sel_hi:[1,0,1] neg_lo:[0,1,0] neg_hi:[0,1,0]
    v_pk_fma_f32 v[152:153], v[36:37], v[64:65], v[152:153] op_sel_hi:[1,0,1] neg_lo:[0,1,0] neg_hi:[0,1,0]
    v_pk_fma_f32 v[154:155], v[38:39], v[64:65], v[154:155] op_sel_hi:[1,0,1] neg_lo:[0,1,0] neg_hi:[0,1,0]
    v_pk_mul_f32 v[76:77], v[136:137], v[72:73] op_sel_hi:[1,0]
    v_pk_mul_f32 v[78:79], v[138:139], v[72:73] op_sel_hi:[1,0]
    v_pk_mul_f32 v[80:81], v[152:153], v[72:73] op_sel_hi:[1,0]
    v_pk_mul_f32 v[82:83], v[154:155], v[72:73] op_sel_hi:[1,0]
    v_exp_f32 v76, v76
    v_exp_f32 v77, v77
    v_exp_f32 v78, v78
    v_exp_f32 v79, v79
    v_exp_f32 v80, v80
    v_exp_f32 v81, v81
    v_exp_f32 v82, v82
    v_exp_f32 v83, v83
    v_pk_fma_f32 v[76:77], v[76:77], v[72:73], v[72:73] op_sel:[0,1,1]
    v_pk_fma_f32 v[78:79], v[78:79], v[72:73], v[72:73] op_sel:[0,1,1]
    v_pk_fma_f32 v[80:81], v[80:81], v[72:73], v[72:73] op_sel:[0,1,1]
    v_pk_fma_f32 v[82:83], v[82:83], v[72:73], v[72:73] op_sel:[0,1,1]
    v_rcp_f32 v76, v76
    v_rcp_f32 v77, v77
    v_rcp_f32 v78, v78
    v_rcp_f32 v79, v79
    v_rcp_f32 v80, v80
    v_rcp_f32 v81, v81
    v_rcp_f32 v82, v82
    v_rcp_f32 v83, v83
    v_pk_mul_f32 v[136:137], v[136:137], v[76:77]
    v_pk_mul_f32 v[138:139], v[138:139], v[78:79]
    v_pk_mul_f32 v[152:153], v[152:153], v[80:81]
    v_pk_mul_f32 v[154:155], v[154:155], v[82:83]
    v_cvt_pk_bf16_f32 v96, v136, v137
    v_cvt_pk_bf16_f32 v97, v138, v139
    v_cvt_pk_bf16_f32 v98, v152, v153
    v_cvt_pk_bf16_f32 v99, v154, v155
    s_nop 1
    v_permlane16_swap_b32 v96, v98
    v_permlane16_swap_b32 v97, v99
    buffer_store_dwordx4 v[96:99], v17, s[40:43], s16 offen offset:2048 sc1
    v_pk_fma_f32 v[140:141], v[32:33], v[66:67], v[140:141] op_sel_hi:[1,0,1] neg_lo:[0,1,0] neg_hi:[0,1,0]
    v_pk_fma_f32 v[142:143], v[34:35], v[66:67], v[142:143] op_sel_hi:[1,0,1] neg_lo:[0,1,0] neg_hi:[0,1,0]
    v_pk_fma_f32 v[156:157], v[36:37], v[66:67], v[156:157] op_sel_hi:[1,0,1] neg_lo:[0,1,0] neg_hi:[0,1,0]
    v_pk_fma_f32 v[158:159], v[38:39], v[66:67], v[158:159] op_sel_hi:[1,0,1] neg_lo:[0,1,0] neg_hi:[0,1,0]
    v_pk_mul_f32 v[76:77], v[140:141], v[74:75] op_sel_hi:[1,0]
    v_pk_mul_f32 v[78:79], v[142:143], v[74:75] op_sel_hi:[1,0]
    v_pk_mul_f32 v[80:81], v[156:157], v[74:75] op_sel_hi:[1,0]
    v_pk_mul_f32 v[82:83], v[158:159], v[74:75] op_sel_hi:[1,0]
    v_exp_f32 v76, v76
    v_exp_f32 v77, v77
    v_exp_f32 v78, v78
    v_exp_f32 v79, v79
    v_exp_f32 v80, v80
    v_exp_f32 v81, v81
    v_exp_f32 v82, v82
    v_exp_f32 v83, v83
    v_pk_fma_f32 v[76:77], v[76:77], v[74:75], v[74:75] op_sel:[0,1,1]
    v_pk_fma_f32 v[78:79], v[78:79], v[74:75], v[74:75] op_sel:[0,1,1]
    v_pk_fma_f32 v[80:81], v[80:81], v[74:75], v[74:75] op_sel:[0,1,1]
    v_pk_fma_f32 v[82:83], v[82:83], v[74:75], v[74:75] op_sel:[0,1,1]
    v_rcp_f32 v76, v76
    v_rcp_f32 v77, v77
    v_rcp_f32 v78, v78
    v_rcp_f32 v79, v79
    v_rcp_f32 v80, v80
    v_rcp_f32 v81, v81
    v_rcp_f32 v82, v82
    v_rcp_f32 v83, v83
    v_pk_mul_f32 v[140:141], v[140:141], v[76:77]
    v_pk_mul_f32 v[142:143], v[142:143], v[78:79]
    v_pk_mul_f32 v[156:157], v[156:157], v[80:81]
    v_pk_mul_f32 v[158:159], v[158:159], v[82:83]
    v_cvt_pk_bf16_f32 v100, v140, v141
    v_cvt_pk_bf16_f32 v101, v142, v143
    v_cvt_pk_bf16_f32 v102, v156, v157
    v_cvt_pk_bf16_f32 v103, v158, v159
    s_nop 1
    v_permlane16_swap_b32 v100, v102
    v_permlane16_swap_b32 v101, v103
    buffer_store_dwordx4 v[100:103], v17, s[40:43], s16 offen offset:3072 sc1
    v_pk_fma_f32 v[160:161], v[40:41], v[60:61], v[160:161] op_sel_hi:[1,0,1] neg_lo:[0,1,0] neg_hi:[0,1,0]
    v_pk_fma_f32 v[162:163], v[42:43], v[60:61], v[162:163] op_sel_hi:[1,0,1] neg_lo:[0,1,0] neg_hi:[0,1,0]
    v_pk_fma_f32 v[176:177], v[44:45], v[60:61], v[176:177] op_sel_hi:[1,0,1] neg_lo:[0,1,0] neg_hi:[0,1,0]
    v_pk_fma_f32 v[178:179], v[46:47], v[60:61], v[178:179] op_sel_hi:[1,0,1] neg_lo:[0,1,0] neg_hi:[0,1,0]
    v_pk_mul_f32 v[76:77], v[160:161], v[68:69] op_sel_hi:[1,0]
    v_pk_mul_f32 v[78:79], v[162:163], v[68:69] op_sel_hi:[1,0]
    v_pk_mul_f32 v[80:81], v[176:177], v[68:69] op_sel_hi:[1,0]
    v_pk_mul_f32 v[82:83], v[178:179], v[68:69] op_sel_hi:[1,0]
    v_exp_f32 v76, v76
    v_exp_f32 v77, v77
    v_exp_f32 v78, v78
    v_exp_f32 v79, v79
    v_exp_f32 v80, v80
    v_exp_f32 v81, v81
    v_exp_f32 v82, v82
    v_exp_f32 v83, v83
    v_pk_fma_f32 v[76:77], v[76:77], v[68:69], v[68:69] op_sel:[0,1,1]
    v_pk_fma_f32 v[78:79], v[78:79], v[68:69], v[68:69] op_sel:[0,1,1]
    v_pk_fma_f32 v[80:81], v[80:81], v[68:69], v[68:69] op_sel:[0,1,1]
    v_pk_fma_f32 v[82:83], v[82:83], v[68:69], v[68:69] op_sel:[0,1,1]
    v_rcp_f32 v76, v76
    v_rcp_f32 v77, v77
    v_rcp_f32 v78, v78
    v_rcp_f32 v79, v79
    v_rcp_f32 v80, v80
    v_rcp_f32 v81, v81
    v_rcp_f32 v82, v82
    v_rcp_f32 v83, v83
    v_pk_mul_f32 v[160:161], v[160:161], v[76:77]
    v_pk_mul_f32 v[162:163], v[162:163], v[78:79]
    v_pk_mul_f32 v[176:177], v[176:177], v[80:81]
    v_pk_mul_f32 v[178:179], v[178:179], v[82:83]
    v_cvt_pk_bf16_f32 v104, v160, v161
    v_cvt_pk_bf16_f32 v105, v162, v163
    v_cvt_pk_bf16_f32 v106, v176, v177
    v_cvt_pk_bf16_f32 v107, v178, v179
    s_nop 1
    v_permlane16_swap_b32 v104, v106
    v_permlane16_swap_b32 v105, v107
    buffer_store_dwordx4 v[104:107], v17, s[40:43], s17 offen offset:0 sc1
    v_pk_fma_f32 v[164:165], v[40:41], v[62:63], v[164:165] op_sel_hi:[1,0,1] neg_lo:[0,1,0] neg_hi:[0,1,0]
    v_pk_fma_f32 v[166:167], v[42:43], v[62:63], v[166:167] op_sel_hi:[1,0,1] neg_lo:[0,1,0] neg_hi:[0,1,0]
    v_pk_fma_f32 v[180:181], v[44:45], v[62:63], v[180:181] op_sel_hi:[1,0,1] neg_lo:[0,1,0] neg_hi:[0,1,0]
    v_pk_fma_f32 v[182:183], v[46:47], v[62:63], v[182:183] op_sel_hi:[1,0,1] neg_lo:[0,1,0] neg_hi:[0,1,0]
    v_pk_mul_f32 v[76:77], v[164:165], v[70:71] op_sel_hi:[1,0]
    v_pk_mul_f32 v[78:79], v[166:167], v[70:71] op_sel_hi:[1,0]
    v_pk_mul_f32 v[80:81], v[180:181], v[70:71] op_sel_hi:[1,0]
    v_pk_mul_f32 v[82:83], v[182:183], v[70:71] op_sel_hi:[1,0]
    v_exp_f32 v76, v76
    v_exp_f32 v77, v77
    v_exp_f32 v78, v78
    v_exp_f32 v79, v79
    v_exp_f32 v80, v80
    v_exp_f32 v81, v81
    v_exp_f32 v82, v82
    v_exp_f32 v83, v83
    v_pk_fma_f32 v[76:77], v[76:77], v[70:71], v[70:71] op_sel:[0,1,1]
    v_pk_fma_f32 v[78:79], v[78:79], v[70:71], v[70:71] op_sel:[0,1,1]
    v_pk_fma_f32 v[80:81], v[80:81], v[70:71], v[70:71] op_sel:[0,1,1]
    v_pk_fma_f32 v[82:83], v[82:83], v[70:71], v[70:71] op_sel:[0,1,1]
    v_rcp_f32 v76, v76
    v_rcp_f32 v77, v77
    v_rcp_f32 v78, v78
    v_rcp_f32 v79, v79
    v_rcp_f32 v80, v80
    v_rcp_f32 v81, v81
    v_rcp_f32 v82, v82
    v_rcp_f32 v83, v83
    v_pk_mul_f32 v[164:165], v[164:165], v[76:77]
    v_pk_mul_f32 v[166:167], v[166:167], v[78:79]
    v_pk_mul_f32 v[180:181], v[180:181], v[80:81]
    v_pk_mul_f32 v[182:183], v[182:183], v[82:83]
    v_cvt_pk_bf16_f32 v108, v164, v165
    v_cvt_pk_bf16_f32 v109, v166, v167
    v_cvt_pk_bf16_f32 v110, v180, v181
    v_cvt_pk_bf16_f32 v111, v182, v183
    s_nop 1
    v_permlane16_swap_b32 v108, v110
    v_permlane16_swap_b32 v109, v111
    buffer_store_dwordx4 v[108:111], v17, s[40:43], s17 offen offset:1024 sc1
    v_pk_fma_f32 v[168:169], v[40:41], v[64:65], v[168:169] op_sel_hi:[1,0,1] neg_lo:[0,1,0] neg_hi:[0,1,0]
    v_pk_fma_f32 v[170:171], v[42:43], v[64:65], v[170:171] op_sel_hi:[1,0,1] neg_lo:[0,1,0] neg_hi:[0,1,0]
    v_pk_fma_f32 v[184:185], v[44:45], v[64:65], v[184:185] op_sel_hi:[1,0,1] neg_lo:[0,1,0] neg_hi:[0,1,0]
    v_pk_fma_f32 v[186:187], v[46:47], v[64:65], v[186:187] op_sel_hi:[1,0,1] neg_lo:[0,1,0] neg_hi:[0,1,0]
    v_pk_mul_f32 v[76:77], v[168:169], v[72:73] op_sel_hi:[1,0]
    v_pk_mul_f32 v[78:79], v[170:171], v[72:73] op_sel_hi:[1,0]
    v_pk_mul_f32 v[80:81], v[184:185], v[72:73] op_sel_hi:[1,0]
    v_pk_mul_f32 v[82:83], v[186:187], v[72:73] op_sel_hi:[1,0]
    v_exp_f32 v76, v76
    v_exp_f32 v77, v77
    v_exp_f32 v78, v78
    v_exp_f32 v79, v79
    v_exp_f32 v80, v80
    v_exp_f32 v81, v81
    v_exp_f32 v82, v82
    v_exp_f32 v83, v83
    v_pk_fma_f32 v[76:77], v[76:77], v[72:73], v[72:73] op_sel:[0,1,1]
    v_pk_fma_f32 v[78:79], v[78:79], v[72:73], v[72:73] op_sel:[0,1,1]
    v_pk_fma_f32 v[80:81], v[80:81], v[72:73], v[72:73] op_sel:[0,1,1]
    v_pk_fma_f32 v[82:83], v[82:83], v[72:73], v[72:73] op_sel:[0,1,1]
    v_rcp_f32 v76, v76
    v_rcp_f32 v77, v77
    v_rcp_f32 v78, v78
    v_rcp_f32 v79, v79
    v_rcp_f32 v80, v80
    v_rcp_f32 v81, v81
    v_rcp_f32 v82, v82
    v_rcp_f32 v83, v83
    v_pk_mul_f32 v[168:169], v[168:169], v[76:77]
    v_pk_mul_f32 v[170:171], v[170:171], v[78:79]
    v_pk_mul_f32 v[184:185], v[184:185], v[80:81]
    v_pk_mul_f32 v[186:187], v[186:187], v[82:83]
    v_cvt_pk_bf16_f32 v112, v168, v169
    v_cvt_pk_bf16_f32 v113, v170, v171
    v_cvt_pk_bf16_f32 v114, v184, v185
    v_cvt_pk_bf16_f32 v115, v186, v187
    s_nop 1
    v_permlane16_swap_b32 v112, v114
    v_permlane16_swap_b32 v113, v115
    buffer_store_dwordx4 v[112:115], v17, s[40:43], s17 offen offset:2048 sc1
    v_pk_fma_f32 v[172:173], v[40:41], v[66:67], v[172:173] op_sel_hi:[1,0,1] neg_lo:[0,1,0] neg_hi:[0,1,0]
    v_pk_fma_f32 v[174:175], v[42:43], v[66:67], v[174:175] op_sel_hi:[1,0,1] neg_lo:[0,1,0] neg_hi:[0,1,0]
    v_pk_fma_f32 v[188:189], v[44:45], v[66:67], v[188:189] op_sel_hi:[1,0,1] neg_lo:[0,1,0] neg_hi:[0,1,0]
    v_pk_fma_f32 v[190:191], v[46:47], v[66:67], v[190:191] op_sel_hi:[1,0,1] neg_lo:[0,1,0] neg_hi:[0,1,0]
    v_pk_mul_f32 v[76:77], v[172:173], v[74:75] op_sel_hi:[1,0]
    v_pk_mul_f32 v[78:79], v[174:175], v[74:75] op_sel_hi:[1,0]
    v_pk_mul_f32 v[80:81], v[188:189], v[74:75] op_sel_hi:[1,0]
    v_pk_mul_f32 v[82:83], v[190:191], v[74:75] op_sel_hi:[1,0]
    v_exp_f32 v76, v76
    v_exp_f32 v77, v77
    v_exp_f32 v78, v78
    v_exp_f32 v79, v79
    v_exp_f32 v80, v80
    v_exp_f32 v81, v81
    v_exp_f32 v82, v82
    v_exp_f32 v83, v83
    v_pk_fma_f32 v[76:77], v[76:77], v[74:75], v[74:75] op_sel:[0,1,1]
    v_pk_fma_f32 v[78:79], v[78:79], v[74:75], v[74:75] op_sel:[0,1,1]
    v_pk_fma_f32 v[80:81], v[80:81], v[74:75], v[74:75] op_sel:[0,1,1]
    v_pk_fma_f32 v[82:83], v[82:83], v[74:75], v[74:75] op_sel:[0,1,1]
    v_rcp_f32 v76, v76
    v_rcp_f32 v77, v77
    v_rcp_f32 v78, v78
    v_rcp_f32 v79, v79
    v_rcp_f32 v80, v80
    v_rcp_f32 v81, v81
    v_rcp_f32 v82, v82
    v_rcp_f32 v83, v83
    v_pk_mul_f32 v[172:173], v[172:173], v[76:77]
    v_pk_mul_f32 v[174:175], v[174:175], v[78:79]
    v_pk_mul_f32 v[188:189], v[188:189], v[80:81]
    v_pk_mul_f32 v[190:191], v[190:191], v[82:83]
    v_cvt_pk_bf16_f32 v116, v172, v173
    v_cvt_pk_bf16_f32 v117, v174, v175
    v_cvt_pk_bf16_f32 v118, v188, v189
    v_cvt_pk_bf16_f32 v119, v190, v191
    s_nop 1
    v_permlane16_swap_b32 v116, v118
    v_permlane16_swap_b32 v117, v119
    buffer_store_dwordx4 v[116:119], v17, s[40:43], s17 offen offset:3072 sc1
    v_mov_b32 v1, s38
    v_mov_b32 v2, s28
    s_waitcnt vmcnt(4)
    s_mov_b64 exec, 1
    buffer_store_dword v1, v2, s[40:43], 0 offen offset:0 sc1
    s_mov_b64 exec, -1
    v_pk_fma_f32 v[192:193], v[48:49], v[60:61], v[192:193] op_sel_hi:[1,0,1] neg_lo:[0,1,0] neg_hi:[0,1,0]
    v_pk_fma_f32 v[194:195], v[50:51], v[60:61], v[194:195] op_sel_hi:[1,0,1] neg_lo:[0,1,0] neg_hi:[0,1,0]
    v_pk_fma_f32 v[208:209], v[52:53], v[60:61], v[208:209] op_sel_hi:[1,0,1] neg_lo:[0,1,0] neg_hi:[0,1,0]
    v_pk_fma_f32 v[210:211], v[54:55], v[60:61], v[210:211] op_sel_hi:[1,0,1] neg_lo:[0,1,0] neg_hi:[0,1,0]
    v_pk_mul_f32 v[76:77], v[192:193], v[68:69] op_sel_hi:[1,0]
    v_pk_mul_f32 v[78:79], v[194:195], v[68:69] op_sel_hi:[1,0]
    v_pk_mul_f32 v[80:81], v[208:209], v[68:69] op_sel_hi:[1,0]
    v_pk_mul_f32 v[82:83], v[210:211], v[68:69] op_sel_hi:[1,0]
    v_exp_f32 v76, v76
    v_exp_f32 v77, v77
    v_exp_f32 v78, v78
    v_exp_f32 v79, v79
    v_exp_f32 v80, v80
    v_exp_f32 v81, v81
    v_exp_f32 v82, v82
    v_exp_f32 v83, v83
    v_pk_fma_f32 v[76:77], v[76:77], v[68:69], v[68:69] op_sel:[0,1,1]
    v_pk_fma_f32 v[78:79], v[78:79], v[68:69], v[68:69] op_sel:[0,1,1]
    v_pk_fma_f32 v[80:81], v[80:81], v[68:69], v[68:69] op_sel:[0,1,1]
    v_pk_fma_f32 v[82:83], v[82:83], v[68:69], v[68:69] op_sel:[0,1,1]
    v_rcp_f32 v76, v76
    v_rcp_f32 v77, v77
    v_rcp_f32 v78, v78
    v_rcp_f32 v79, v79
    v_rcp_f32 v80, v80
    v_rcp_f32 v81, v81
    v_rcp_f32 v82, v82
    v_rcp_f32 v83, v83
    v_pk_mul_f32 v[192:193], v[192:193], v[76:77]
    v_pk_mul_f32 v[194:195], v[194:195], v[78:79]
    v_pk_mul_f32 v[208:209], v[208:209], v[80:81]
    v_pk_mul_f32 v[210:211], v[210:211], v[82:83]
    v_cvt_pk_bf16_f32 v88, v192, v193
    v_cvt_pk_bf16_f32 v89, v194, v195
    v_cvt_pk_bf16_f32 v90, v208, v209
    v_cvt_pk_bf16_f32 v91, v210, v211
    s_nop 1
    v_permlane16_swap_b32 v88, v90
    v_permlane16_swap_b32 v89, v91
    buffer_store_dwordx4 v[88:91], v17, s[40:43], s18 offen offset:0 sc1
    v_pk_fma_f32 v[196:197], v[48:49], v[62:63], v[196:197] op_sel_hi:[1,0,1] neg_lo:[0,1,0] neg_hi:[0,1,0]
    v_pk_fma_f32 v[198:199], v[50:51], v[62:63], v[198:199] op_sel_hi:[1,0,1] neg_lo:[0,1,0] neg_hi:[0,1,0]
    v_pk_fma_f32 v[212:213], v[52:53], v[62:63], v[212:213] op_sel_hi:[1,0,1] neg_lo:[0,1,0] neg_hi:[0,1,0]
    v_pk_fma_f32 v[214:215], v[54:55], v[62:63], v[214:215] op_sel_hi:[1,0,1] neg_lo:[0,1,0] neg_hi:[0,1,0]
    v_pk_mul_f32 v[76:77], v[196:197], v[70:71] op_sel_hi:[1,0]
    v_pk_mul_f32 v[78:79], v[198:199], v[70:71] op_sel_hi:[1,0]
    v_pk_mul_f32 v[80:81], v[212:213], v[70:71] op_sel_hi:[1,0]
    v_pk_mul_f32 v[82:83], v[214:215], v[70:71] op_sel_hi:[1,0]
    v_exp_f32 v76, v76
    v_exp_f32 v77, v77
    v_exp_f32 v78, v78
    v_exp_f32 v79, v79
    v_exp_f32 v80, v80
    v_exp_f32 v81, v81
    v_exp_f32 v82, v82
    v_exp_f32 v83, v83
    v_pk_fma_f32 v[76:77], v[76:77], v[70:71], v[70:71] op_sel:[0,1,1]
    v_pk_fma_f32 v[78:79], v[78:79], v[70:71], v[70:71] op_sel:[0,1,1]
    v_pk_fma_f32 v[80:81], v[80:81], v[70:71], v[70:71] op_sel:[0,1,1]
    v_pk_fma_f32 v[82:83], v[82:83], v[70:71], v[70:71] op_sel:[0,1,1]
    v_rcp_f32 v76, v76
    v_rcp_f32 v77, v77
    v_rcp_f32 v78, v78
    v_rcp_f32 v79, v79
    v_rcp_f32 v80, v80
    v_rcp_f32 v81, v81
    v_rcp_f32 v82, v82
    v_rcp_f32 v83, v83
    v_pk_mul_f32 v[196:197], v[196:197], v[76:77]
    v_pk_mul_f32 v[198:199], v[198:199], v[78:79]
    v_pk_mul_f32 v[212:213], v[212:213], v[80:81]
    v_pk_mul_f32 v[214:215], v[214:215], v[82:83]
    v_cvt_pk_bf16_f32 v92, v196, v197
    v_cvt_pk_bf16_f32 v93, v198, v199
    v_cvt_pk_bf16_f32 v94, v212, v213
    v_cvt_pk_bf16_f32 v95, v214, v215
    s_nop 1
    v_permlane16_swap_b32 v92, v94
    v_permlane16_swap_b32 v93, v95
    buffer_store_dwordx4 v[92:95], v17, s[40:43], s18 offen offset:1024 sc1
    v_pk_fma_f32 v[200:201], v[48:49], v[64:65], v[200:201] op_sel_hi:[1,0,1] neg_lo:[0,1,0] neg_hi:[0,1,0]
    v_pk_fma_f32 v[202:203], v[50:51], v[64:65], v[202:203] op_sel_hi:[1,0,1] neg_lo:[0,1,0] neg_hi:[0,1,0]
    v_pk_fma_f32 v[216:217], v[52:53], v[64:65], v[216:217] op_sel_hi:[1,0,1] neg_lo:[0,1,0] neg_hi:[0,1,0]
    v_pk_fma_f32 v[218:219], v[54:55], v[64:65], v[218:219] op_sel_hi:[1,0,1] neg_lo:[0,1,0] neg_hi:[0,1,0]
    v_pk_mul_f32 v[76:77], v[200:201], v[72:73] op_sel_hi:[1,0]
    v_pk_mul_f32 v[78:79], v[202:203], v[72:73] op_sel_hi:[1,0]
    v_pk_mul_f32 v[80:81], v[216:217], v[72:73] op_sel_hi:[1,0]
    v_pk_mul_f32 v[82:83], v[218:219], v[72:73] op_sel_hi:[1,0]
    v_exp_f32 v76, v76
    v_exp_f32 v77, v77
    v_exp_f32 v78, v78
    v_exp_f32 v79, v79
    v_exp_f32 v80, v80
    v_exp_f32 v81, v81
    v_exp_f32 v82, v82
    v_exp_f32 v83, v83
    v_pk_fma_f32 v[76:77], v[76:77], v[72:73], v[72:73] op_sel:[0,1,1]
    v_pk_fma_f32 v[78:79], v[78:79], v[72:73], v[72:73] op_sel:[0,1,1]
    v_pk_fma_f32 v[80:81], v[80:81], v[72:73], v[72:73] op_sel:[0,1,1]
    v_pk_fma_f32 v[82:83], v[82:83], v[72:73], v[72:73] op_sel:[0,1,1]
    v_rcp_f32 v76, v76
    v_rcp_f32 v77, v77
    v_rcp_f32 v78, v78
    v_rcp_f32 v79, v79
    v_rcp_f32 v80, v80
    v_rcp_f32 v81, v81
    v_rcp_f32 v82, v82
    v_rcp_f32 v83, v83
    v_pk_mul_f32 v[200:201], v[200:201], v[76:77]
    v_pk_mul_f32 v[202:203], v[202:203], v[78:79]
    v_pk_mul_f32 v[216:217], v[216:217], v[80:81]
    v_pk_mul_f32 v[218:219], v[218:219], v[82:83]
    v_cvt_pk_bf16_f32 v96, v200, v201
    v_cvt_pk_bf16_f32 v97, v202, v203
    v_cvt_pk_bf16_f32 v98, v216, v217
    v_cvt_pk_bf16_f32 v99, v218, v219
    s_nop 1
    v_permlane16_swap_b32 v96, v98
    v_permlane16_swap_b32 v97, v99
    buffer_store_dwordx4 v[96:99], v17, s[40:43], s18 offen offset:2048 sc1
    v_pk_fma_f32 v[204:205], v[48:49], v[66:67], v[204:205] op_sel_hi:[1,0,1] neg_lo:[0,1,0] neg_hi:[0,1,0]
    v_pk_fma_f32 v[206:207], v[50:51], v[66:67], v[206:207] op_sel_hi:[1,0,1] neg_lo:[0,1,0] neg_hi:[0,1,0]
    v_pk_fma_f32 v[220:221], v[52:53], v[66:67], v[220:221] op_sel_hi:[1,0,1] neg_lo:[0,1,0] neg_hi:[0,1,0]
    v_pk_fma_f32 v[222:223], v[54:55], v[66:67], v[222:223] op_sel_hi:[1,0,1] neg_lo:[0,1,0] neg_hi:[0,1,0]
    v_pk_mul_f32 v[76:77], v[204:205], v[74:75] op_sel_hi:[1,0]
    v_pk_mul_f32 v[78:79], v[206:207], v[74:75] op_sel_hi:[1,0]
    v_pk_mul_f32 v[80:81], v[220:221], v[74:75] op_sel_hi:[1,0]
    v_pk_mul_f32 v[82:83], v[222:223], v[74:75] op_sel_hi:[1,0]
    v_exp_f32 v76, v76
    v_exp_f32 v77, v77
    v_exp_f32 v78, v78
    v_exp_f32 v79, v79
    v_exp_f32 v80, v80
    v_exp_f32 v81, v81
    v_exp_f32 v82, v82
    v_exp_f32 v83, v83
    v_pk_fma_f32 v[76:77], v[76:77], v[74:75], v[74:75] op_sel:[0,1,1]
    v_pk_fma_f32 v[78:79], v[78:79], v[74:75], v[74:75] op_sel:[0,1,1]
    v_pk_fma_f32 v[80:81], v[80:81], v[74:75], v[74:75] op_sel:[0,1,1]
    v_pk_fma_f32 v[82:83], v[82:83], v[74:75], v[74:75] op_sel:[0,1,1]
    v_rcp_f32 v76, v76
    v_rcp_f32 v77, v77
    v_rcp_f32 v78, v78
    v_rcp_f32 v79, v79
    v_rcp_f32 v80, v80
    v_rcp_f32 v81, v81
    v_rcp_f32 v82, v82
    v_rcp_f32 v83, v83
    v_pk_mul_f32 v[204:205], v[204:205], v[76:77]
    v_pk_mul_f32 v[206:207], v[206:207], v[78:79]
    v_pk_mul_f32 v[220:221], v[220:221], v[80:81]
    v_pk_mul_f32 v[222:223], v[222:223], v[82:83]
    v_cvt_pk_bf16_f32 v100, v204, v205
    v_cvt_pk_bf16_f32 v101, v206, v207
    v_cvt_pk_bf16_f32 v102, v220, v221
    v_cvt_pk_bf16_f32 v103, v222, v223
    s_nop 1
    v_permlane16_swap_b32 v100, v102
    v_permlane16_swap_b32 v101, v103
    buffer_store_dwordx4 v[100:103], v17, s[40:43], s18 offen offset:3072 sc1
    v_pk_fma_f32 v[224:225], v[56:57], v[60:61], v[224:225] op_sel_hi:[1,0,1] neg_lo:[0,1,0] neg_hi:[0,1,0]
    v_pk_fma_f32 v[226:227], v[58:59], v[60:61], v[226:227] op_sel_hi:[1,0,1] neg_lo:[0,1,0] neg_hi:[0,1,0]
    v_pk_fma_f32 v[228:229], v[56:57], v[62:63], v[228:229] op_sel_hi:[1,0,1] neg_lo:[0,1,0] neg_hi:[0,1,0]
    v_pk_fma_f32 v[230:231], v[58:59], v[62:63], v[230:231] op_sel_hi:[1,0,1] neg_lo:[0,1,0] neg_hi:[0,1,0]
    v_pk_mul_f32 v[76:77], v[224:225], v[68:69] op_sel_hi:[1,0]
    v_pk_mul_f32 v[78:79], v[226:227], v[68:69] op_sel_hi:[1,0]
    v_pk_mul_f32 v[80:81], v[228:229], v[70:71] op_sel_hi:[1,0]
    v_pk_mul_f32 v[82:83], v[230:231], v[70:71] op_sel_hi:[1,0]
    v_exp_f32 v76, v76
    v_exp_f32 v77, v77
    v_exp_f32 v78, v78
    v_exp_f32 v79, v79
    v_exp_f32 v80, v80
    v_exp_f32 v81, v81
    v_exp_f32 v82, v82
    v_exp_f32 v83, v83
    v_pk_fma_f32 v[76:77], v[76:77], v[68:69], v[68:69] op_sel:[0,1,1]
    v_pk_fma_f32 v[78:79], v[78:79], v[68:69], v[68:69] op_sel:[0,1,1]
    v_pk_fma_f32 v[80:81], v[80:81], v[70:71], v[70:71] op_sel:[0,1,1]
    v_pk_fma_f32 v[82:83], v[82:83], v[70:71], v[70:71] op_sel:[0,1,1]
    v_rcp_f32 v76, v76
    v_rcp_f32 v77, v77
    v_rcp_f32 v78, v78
    v_rcp_f32 v79, v79
    v_rcp_f32 v80, v80
    v_rcp_f32 v81, v81
    v_rcp_f32 v82, v82
    v_rcp_f32 v83, v83
    v_pk_mul_f32 v[224:225], v[224:225], v[76:77]
    v_pk_mul_f32 v[226:227], v[226:227], v[78:79]
    v_pk_mul_f32 v[228:229], v[228:229], v[80:81]
    v_pk_mul_f32 v[230:231], v[230:231], v[82:83]
    v_cvt_pk_bf16_f32 v104, v224, v225
    v_cvt_pk_bf16_f32 v105, v226, v227
    v_cvt_pk_bf16_f32 v106, v228, v229
    v_cvt_pk_bf16_f32 v107, v230, v231
    s_nop 1
    v_permlane16_swap_b32 v104, v106
    v_permlane16_swap_b32 v105, v107
    buffer_store_dwordx4 v[104:107], v20, s[40:43], 0 offen offset:0 sc1
    v_pk_fma_f32 v[232:233], v[56:57], v[64:65], v[232:233] op_sel_hi:[1,0,1] neg_lo:[0,1,0] neg_hi:[0,1,0]
    v_pk_fma_f32 v[234:235], v[58:59], v[64:65], v[234:235] op_sel_hi:[1,0,1] neg_lo:[0,1,0] neg_hi:[0,1,0]
    v_pk_fma_f32 v[236:237], v[56:57], v[66:67], v[236:237] op_sel_hi:[1,0,1] neg_lo:[0,1,0] neg_hi:[0,1,0]
    v_pk_fma_f32 v[238:239], v[58:59], v[66:67], v[238:239] op_sel_hi:[1,0,1] neg_lo:[0,1,0] neg_hi:[0,1,0]
    v_pk_mul_f32 v[76:77], v[232:233], v[72:73] op_sel_hi:[1,0]
    v_pk_mul_f32 v[78:79], v[234:235], v[72:73] op_sel_hi:[1,0]
    v_pk_mul_f32 v[80:81], v[236:237], v[74:75] op_sel_hi:[1,0]
    v_pk_mul_f32 v[82:83], v[238:239], v[74:75] op_sel_hi:[1,0]
    v_exp_f32 v76, v76
    v_exp_f32 v77, v77
    v_exp_f32 v78, v78
    v_exp_f32 v79, v79
    v_exp_f32 v80, v80
    v_exp_f32 v81, v81
    v_exp_f32 v82, v82
    v_exp_f32 v83, v83
    v_pk_fma_f32 v[76:77], v[76:77], v[72:73], v[72:73] op_sel:[0,1,1]
    v_pk_fma_f32 v[78:79], v[78:79], v[72:73], v[72:73] op_sel:[0,1,1]
    v_pk_fma_f32 v[80:81], v[80:81], v[74:75], v[74:75] op_sel:[0,1,1]
    v_pk_fma_f32 v[82:83], v[82:83], v[74:75], v[74:75] op_sel:[0,1,1]
    v_rcp_f32 v76, v76
    v_rcp_f32 v77, v77
    v_rcp_f32 v78, v78
    v_rcp_f32 v79, v79
    v_rcp_f32 v80, v80
    v_rcp_f32 v81, v81
    v_rcp_f32 v82, v82
    v_rcp_f32 v83, v83
    v_pk_mul_f32 v[232:233], v[232:233], v[76:77]
    v_pk_mul_f32 v[234:235], v[234:235], v[78:79]
    v_pk_mul_f32 v[236:237], v[236:237], v[80:81]
    v_pk_mul_f32 v[238:239], v[238:239], v[82:83]
    v_cvt_pk_bf16_f32 v108, v232, v233
    v_cvt_pk_bf16_f32 v109, v234, v235
    v_cvt_pk_bf16_f32 v110, v236, v237
    v_cvt_pk_bf16_f32 v111, v238, v239
    s_nop 1
    v_permlane16_swap_b32 v108, v110
    v_permlane16_swap_b32 v109, v111
    buffer_store_dwordx4 v[108:111], v20, s[40:43], 0 offen offset:1024 sc1
    v_mov_b32 v1, s38
    v_mov_b32 v2, s28
    s_waitcnt vmcnt(7)
    s_mov_b64 exec, 1
    buffer_store_dword v1, v2, s[40:43], 0 offen offset:128 sc1
    s_mov_b64 exec, -1
    v_and_b32 v16, 15, v3
    v_lshlrev_b32 v16, 15, v16
    s_lshl_b32 s16, s12, 21
    s_lshl_b32 s17, s9, 11
    s_add_u32 s16, s16, s17
    s_lshl_b32 s17, s39, 7
    s_add_u32 s16, s16, s17
    s_mul_i32 s17, s11, 128
    s_add_u32 s16, s16, s17
    s_lshl_b32 s17, s13, 6
    s_add_u32 s16, s16, s17
    v_add_u32 v16, s16, v16
    s_mov_b32 s84, 0
    s_mov_b32 s85, 524288
    s_mov_b32 s86, 1048576
    s_mov_b32 s87, 1572864
    v_add_u32 v16, v16, v21
    s_lshl_b32 s16, s13, 12
    s_add_u32 s16, s16, 16384
    v_and_b32 v7, 15, v3
    v_lshlrev_b32 v7, 7, v7
    v_lshrrev_b32 v8, 4, v3
    v_bfe_u32 v2, v3, 1, 3
    v_xor_b32 v8, v8, v2
    v_lshl_add_u32 v7, v8, 4, v7
    v_add_u32 v7, s16, v7
    v_xor_b32 v8, 64, v7
    v_bfe_u32 v20, v3, 2, 2
    v_lshl_add_u32 v23, v18, 3, v20
    v_lshlrev_b32 v23, 8, v23
    v_and_b32 v22, 3, v3
    v_lshl_add_u32 v23, v22, 3, v23
    v_and_b32 v22, 1, v18
    v_lshl_or_b32 v20, v22, 2, v20
    s_lshl_b32 s16, s13, 1
    s_lshl_b32 s17, s11, 2
    s_add_u32 s16, s16, s17
    v_xor_b32 v20, s16, v20
    v_lshl_add_u32 v23, v20, 5, v23
    v_add_u32 v6, 16384, v23
    v_mov_b32 v28, 0xff
    v_mov_b32 v31, s38
    v_xor_b32 v29, 0x20000, v24
    v_xor_b32 v30, 0x20000, v25
    v_mov_b32 v128, 0
    v_mov_b32 v129, 0
    v_mov_b32 v130, 0
    v_mov_b32 v131, 0
    v_mov_b32 v132, 0
    v_mov_b32 v133, 0
    v_mov_b32 v134, 0
    v_mov_b32 v135, 0
    v_mov_b32 v136, 0
    v_mov_b32 v137, 0
    v_mov_b32 v138, 0
    v_mov_b32 v139, 0
    v_mov_b32 v140, 0
    v_mov_b32 v141, 0
    v_mov_b32 v142, 0
    v_mov_b32 v143, 0
    v_mov_b32 v144, 0
    v_mov_b32 v145, 0
    v_mov_b32 v146, 0
    v_mov_b32 v147, 0
    v_mov_b32 v148, 0
    v_mov_b32 v149, 0
    v_mov_b32 v150, 0
    v_mov_b32 v151, 0
    v_mov_b32 v152, 0
    v_mov_b32 v153, 0
    v_mov_b32 v154, 0
    v_mov_b32 v155, 0
    v_mov_b32 v156, 0
    v_mov_b32 v157, 0
    v_mov_b32 v158, 0
    v_mov_b32 v159, 0
    v_mov_b32 v160, 0
    v_mov_b32 v161, 0
    v_mov_b32 v162, 0
    v_mov_b32 v163, 0
    v_mov_b32 v164, 0
    v_mov_b32 v165, 0
    v_mov_b32 v166, 0
    v_mov_b32 v167, 0
    v_mov_b32 v168, 0
    v_mov_b32 v169, 0
    v_mov_b32 v170, 0
    v_mov_b32 v171, 0
    v_mov_b32 v172, 0
    v_mov_b32 v173, 0
    v_mov_b32 v174, 0
    v_mov_b32 v175, 0
    v_mov_b32 v176, 0
    v_mov_b32 v177, 0
    v_mov_b32 v178, 0
    v_mov_b32 v179, 0
    v_mov_b32 v180, 0
    v_mov_b32 v181, 0
    v_mov_b32 v182, 0
    v_mov_b32 v183, 0
    v_mov_b32 v184, 0
    v_mov_b32 v185, 0
    v_mov_b32 v186, 0
    v_mov_b32 v187, 0
    v_mov_b32 v188, 0
    v_mov_b32 v189, 0
    v_mov_b32 v190, 0
    v_mov_b32 v191, 0
    s_barrier
    ds_read_b128 v[32:35], v9 offset:0
    ds_read_b128 v[48:51], v11 offset:0
    ds_read_b128 v[36:39], v9 offset:2048
    ds_read_b128 v[52:55], v11 offset:2048
    ds_read_b128 v[40:43], v9 offset:4096
    ds_read_b128 v[56:59], v11 offset:4096
    ds_read_b128 v[44:47], v9 offset:6144
    ds_read_b128 v[60:63], v11 offset:6144
    s_lshr_b32 s16, s8, 3
    s_and_b32 s17, s16, 3
    s_cmp_eq_u32 s16, 3
    s_cselect_b32 s17, 1, s17
    s_lshr_b32 s18, s16, 2
    s_cmp_eq_u32 s16, 3
    s_cselect_b32 s18, 8, s18
    s_lshl_b32 s18, s18, 19
    s_bfe_u32 s19, s8, 0x20001
    s_lshl_b32 s19, s19, 6
    s_lshl_b32 s20, s13, 5
    s_add_u32 s19, s19, s20
    v_and_b32 v17, 15, v3
    v_add_u32 v17, s19, v17
    v_sub_u32 v22, 1007, v17
    s_lshl_b32 s17, s17, 8
    v_add_u32 v17, s17, v17
    s_and_b32 s19, s8, 1
    s_lshl_b32 s19, s19, 1
    s_add_u32 s19, s19, s12
    s_lshl_b32 s19, s19, 16
    s_add_u32 s19, s19, 0x800000
    v_add_u32 v23, s19, v21
    v_lshl_add_u32 v17, v17, 6, v23
    v_lshl_add_u32 v22, v22, 6, v23
    s_waitcnt lgkmcnt(0)
    v_mfma_f32_16x16x32_bf16 v[192:195], v[32:35], v[48:51], 0
    ds_read_b128 v[76:79], v10 offset:0
    v_mfma_f32_16x16x32_bf16 v[196:199], v[32:35], v[52:55], 0
    ds_read_b128 v[92:95], v12 offset:0
    v_mfma_f32_16x16x32_bf16 v[200:203], v[32:35], v[56:59], 0
    ds_read_b128 v[80:83], v10 offset:2048
    v_mfma_f32_16x16x32_bf16 v[204:207], v[32:35], v[60:63], 0
    ds_read_b128 v[96:99], v12 offset:2048
    v_mfma_f32_16x16x32_bf16 v[220:223], v[36:39], v[60:63], 0
    ds_read_b128 v[84:87], v10 offset:4096
    v_mfma_f32_16x16x32_bf16 v[216:219], v[36:39], v[56:59], 0
    ds_read_b128 v[100:103], v12 offset:4096
    v_mfma_f32_16x16x32_bf16 v[212:215], v[36:39], v[52:55], 0
    ds_read_b128 v[88:91], v10 offset:6144
    v_mfma_f32_16x16x32_bf16 v[208:211], v[36:39], v[48:51], 0
    ds_read_b128 v[104:107], v12 offset:6144
    v_mfma_f32_16x16x32_bf16 v[224:227], v[40:43], v[48:51], 0
    v_add_u32 v9, 0x8000, v4
    v_mfma_f32_16x16x32_bf16 v[228:231], v[40:43], v[52:55], 0
    v_add_u32 v10, 0x8000, v5
    v_mfma_f32_16x16x32_bf16 v[232:235], v[40:43], v[56:59], 0
    v_add_u32 v11, 0x8000, v14
    v_mfma_f32_16x16x32_bf16 v[236:239], v[40:43], v[60:63], 0
    v_add_u32 v12, 0x8000, v15
    v_mfma_f32_16x16x32_bf16 v[120:123], v[44:47], v[60:63], 0
    v_mfma_f32_16x16x32_bf16 v[116:119], v[44:47], v[56:59], 0
    v_mfma_f32_16x16x32_bf16 v[112:115], v[44:47], v[52:55], 0
    v_mfma_f32_16x16x32_bf16 v[108:111], v[44:47], v[48:51], 0
    s_waitcnt lgkmcnt(0)
    v_mfma_f32_16x16x32_bf16 v[192:195], v[76:79], v[92:95], v[192:195]
    ds_read_b128 v[32:35], v9 offset:0
    v_mfma_f32_16x16x32_bf16 v[196:199], v[76:79], v[96:99], v[196:199]
    ds_read_b128 v[48:51], v11 offset:0
    v_mfma_f32_16x16x32_bf16 v[200:203], v[76:79], v[100:103], v[200:203]
    ds_read_b128 v[36:39], v9 offset:2048
    v_mfma_f32_16x16x32_bf16 v[204:207], v[76:79], v[104:107], v[204:207]
    ds_read_b128 v[52:55], v11 offset:2048
    v_mfma_f32_16x16x32_bf16 v[220:223], v[80:83], v[104:107], v[220:223]
    ds_read_b128 v[40:43], v9 offset:4096
    v_mfma_f32_16x16x32_bf16 v[216:219], v[80:83], v[100:103], v[216:219]
    ds_read_b128 v[56:59], v11 offset:4096
    v_mfma_f32_16x16x32_bf16 v[212:215], v[80:83], v[96:99], v[212:215]
    ds_read_b128 v[44:47], v9 offset:6144
    v_mfma_f32_16x16x32_bf16 v[208:211], v[80:83], v[92:95], v[208:211]
    ds_read_b128 v[60:63], v11 offset:6144
    v_mfma_f32_16x16x32_bf16 v[224:227], v[84:87], v[92:95], v[224:227]
    v_mfma_f32_16x16x32_bf16 v[228:231], v[84:87], v[96:99], v[228:231]
    v_mfma_f32_16x16x32_bf16 v[232:235], v[84:87], v[100:103], v[232:235]
    v_mfma_f32_16x16x32_bf16 v[236:239], v[84:87], v[104:107], v[236:239]
    v_mfma_f32_16x16x32_bf16 v[120:123], v[88:91], v[104:107], v[120:123]
    v_mfma_f32_16x16x32_bf16 v[116:119], v[88:91], v[100:103], v[116:119]
    v_mfma_f32_16x16x32_bf16 v[112:115], v[88:91], v[96:99], v[112:115]
    v_mfma_f32_16x16x32_bf16 v[108:111], v[88:91], v[92:95], v[108:111]
    s_waitcnt lgkmcnt(0)
    v_mfma_f32_16x16x32_bf16 v[192:195], v[32:35], v[48:51], v[192:195]
    ds_read_b128 v[76:79], v10 offset:0
    v_mfma_f32_16x16x32_bf16 v[196:199], v[32:35], v[52:55], v[196:199]
    ds_read_b128 v[92:95], v12 offset:0
    v_mfma_f32_16x16x32_bf16 v[200:203], v[32:35], v[56:59], v[200:203]
    ds_read_b128 v[80:83], v10 offset:2048
    v_mfma_f32_16x16x32_bf16 v[204:207], v[32:35], v[60:63], v[204:207]
    ds_read_b128 v[96:99], v12 offset:2048
    v_mfma_f32_16x16x32_bf16 v[220:223], v[36:39], v[60:63], v[220:223]
    ds_read_b128 v[84:87], v10 offset:4096
    v_mfma_f32_16x16x32_bf16 v[216:219], v[36:39], v[56:59], v[216:219]
    ds_read_b128 v[100:103], v12 offset:4096
    v_mfma_f32_16x16x32_bf16 v[212:215], v[36:39], v[52:55], v[212:215]
    ds_read_b128 v[88:91], v10 offset:6144
    v_mfma_f32_16x16x32_bf16 v[208:211], v[36:39], v[48:51], v[208:211]
    ds_read_b128 v[104:107], v12 offset:6144
    v_mfma_f32_16x16x32_bf16 v[224:227], v[40:43], v[48:51], v[224:227]
    v_add_u32 v9, 0x10000, v4
    v_mfma_f32_16x16x32_bf16 v[228:231], v[40:43], v[52:55], v[228:231]
    v_add_u32 v10, 0x10000, v5
    v_mfma_f32_16x16x32_bf16 v[232:235], v[40:43], v[56:59], v[232:235]
    v_add_u32 v11, 0x10000, v14
    v_mfma_f32_16x16x32_bf16 v[236:239], v[40:43], v[60:63], v[236:239]
    v_add_u32 v12, 0x10000, v15
    v_mfma_f32_16x16x32_bf16 v[120:123], v[44:47], v[60:63], v[120:123]
    v_mfma_f32_16x16x32_bf16 v[116:119], v[44:47], v[56:59], v[116:119]
    v_mfma_f32_16x16x32_bf16 v[112:115], v[44:47], v[52:55], v[112:115]
    v_mfma_f32_16x16x32_bf16 v[108:111], v[44:47], v[48:51], v[108:111]
    s_waitcnt lgkmcnt(0)
    v_mfma_f32_16x16x32_bf16 v[192:195], v[76:79], v[92:95], v[192:195]
    ds_read_b128 v[32:35], v9 offset:0
    v_mfma_f32_16x16x32_bf16 v[196:199], v[76:79], v[96:99], v[196:199]
    ds_read_b128 v[48:51], v11 offset:0
    v_mfma_f32_16x16x32_bf16 v[200:203], v[76:79], v[100:103], v[200:203]
    ds_read_b128 v[36:39], v9 offset:2048
    v_mfma_f32_16x16x32_bf16 v[204:207], v[76:79], v[104:107], v[204:207]
    ds_read_b128 v[52:55], v11 offset:2048
    v_mfma_f32_16x16x32_bf16 v[220:223], v[80:83], v[104:107], v[220:223]
    ds_read_b128 v[40:43], v9 offset:4096
    v_mfma_f32_16x16x32_bf16 v[216:219], v[80:83], v[100:103], v[216:219]
    ds_read_b128 v[56:59], v11 offset:4096
    v_mfma_f32_16x16x32_bf16 v[212:215], v[80:83], v[96:99], v[212:215]
    ds_read_b128 v[44:47], v9 offset:6144
    v_mfma_f32_16x16x32_bf16 v[208:211], v[80:83], v[92:95], v[208:211]
    ds_read_b128 v[60:63], v11 offset:6144
    v_mfma_f32_16x16x32_bf16 v[224:227], v[84:87], v[92:95], v[224:227]
    v_mfma_f32_16x16x32_bf16 v[228:231], v[84:87], v[96:99], v[228:231]
    v_mfma_f32_16x16x32_bf16 v[232:235], v[84:87], v[100:103], v[232:235]
    v_mfma_f32_16x16x32_bf16 v[236:239], v[84:87], v[104:107], v[236:239]
    v_mfma_f32_16x16x32_bf16 v[120:123], v[88:91], v[104:107], v[120:123]
    v_mfma_f32_16x16x32_bf16 v[116:119], v[88:91], v[100:103], v[116:119]
    v_mfma_f32_16x16x32_bf16 v[112:115], v[88:91], v[96:99], v[112:115]
    v_mfma_f32_16x16x32_bf16 v[108:111], v[88:91], v[92:95], v[108:111]
    s_waitcnt lgkmcnt(0)
    s_barrier
    v_mfma_f32_16x16x32_bf16 v[192:195], v[32:35], v[48:51], v[192:195]
    ds_read_b128 v[76:79], v10 offset:0
    v_mfma_f32_16x16x32_bf16 v[196:199], v[32:35], v[52:55], v[196:199]
    ds_read_b128 v[92:95], v12 offset:0
    v_mfma_f32_16x16x32_bf16 v[200:203], v[32:35], v[56:59], v[200:203]
    ds_read_b128 v[80:83], v10 offset:2048
    v_mfma_f32_16x16x32_bf16 v[204:207], v[32:35], v[60:63], v[204:207]
    ds_read_b128 v[96:99], v12 offset:2048
    v_mfma_f32_16x16x32_bf16 v[220:223], v[36:39], v[60:63], v[220:223]
    ds_read_b128 v[84:87], v10 offset:4096
    v_mfma_f32_16x16x32_bf16 v[216:219], v[36:39], v[56:59], v[216:219]
    ds_read_b128 v[100:103], v12 offset:4096
    v_mfma_f32_16x16x32_bf16 v[212:215], v[36:39], v[52:55], v[212:215]
    ds_read_b128 v[88:91], v10 offset:6144
    v_mfma_f32_16x16x32_bf16 v[208:211], v[36:39], v[48:51], v[208:211]
    ds_read_b128 v[104:107], v12 offset:6144
    v_mfma_f32_16x16x32_bf16 v[224:227], v[40:43], v[48:51], v[224:227]
    v_add_u32 v9, 0x18000, v4
    v_mfma_f32_16x16x32_bf16 v[228:231], v[40:43], v[52:55], v[228:231]
    v_add_u32 v10, 0x18000, v5
    v_mfma_f32_16x16x32_bf16 v[232:235], v[40:43], v[56:59], v[232:235]
    v_add_u32 v11, 0x18000, v14
    v_mfma_f32_16x16x32_bf16 v[236:239], v[40:43], v[60:63], v[236:239]
    v_add_u32 v12, 0x18000, v15
    v_mfma_f32_16x16x32_bf16 v[120:123], v[44:47], v[60:63], v[120:123]
    v_mfma_f32_16x16x32_bf16 v[116:119], v[44:47], v[56:59], v[116:119]
    v_mfma_f32_16x16x32_bf16 v[112:115], v[44:47], v[52:55], v[112:115]
    v_mfma_f32_16x16x32_bf16 v[108:111], v[44:47], v[48:51], v[108:111]
    s_waitcnt lgkmcnt(0)
    v_mfma_f32_16x16x32_bf16 v[192:195], v[76:79], v[92:95], v[192:195]
    ds_read_b128 v[32:35], v9 offset:0
    v_mfma_f32_16x16x32_bf16 v[196:199], v[76:79], v[96:99], v[196:199]
    ds_read_b128 v[48:51], v11 offset:0
    v_mfma_f32_16x16x32_bf16 v[200:203], v[76:79], v[100:103], v[200:203]
    ds_read_b128 v[36:39], v9 offset:2048
    v_mfma_f32_16x16x32_bf16 v[204:207], v[76:79], v[104:107], v[204:207]
    ds_read_b128 v[52:55], v11 offset:2048
    v_mfma_f32_16x16x32_bf16 v[220:223], v[80:83], v[104:107], v[220:223]
    ds_read_b128 v[40:43], v9 offset:4096
    v_mfma_f32_16x16x32_bf16 v[216:219], v[80:83], v[100:103], v[216:219]
    ds_read_b128 v[56:59], v11 offset:4096
    v_mfma_f32_16x16x32_bf16 v[212:215], v[80:83], v[96:99], v[212:215]
    ds_read_b128 v[44:47], v9 offset:6144
    v_mfma_f32_16x16x32_bf16 v[208:211], v[80:83], v[92:95], v[208:211]
    ds_read_b128 v[60:63], v11 offset:6144
    v_mfma_f32_16x16x32_bf16 v[224:227], v[84:87], v[92:95], v[224:227]
    v_mfma_f32_16x16x32_bf16 v[228:231], v[84:87], v[96:99], v[228:231]
    v_mfma_f32_16x16x32_bf16 v[232:235], v[84:87], v[100:103], v[232:235]
    v_mfma_f32_16x16x32_bf16 v[236:239], v[84:87], v[104:107], v[236:239]
    v_mfma_f32_16x16x32_bf16 v[120:123], v[88:91], v[104:107], v[120:123]
    v_mfma_f32_16x16x32_bf16 v[116:119], v[88:91], v[100:103], v[116:119]
    v_mfma_f32_16x16x32_bf16 v[112:115], v[88:91], v[96:99], v[112:115]
    v_mfma_f32_16x16x32_bf16 v[108:111], v[88:91], v[92:95], v[108:111]
    s_waitcnt lgkmcnt(0)
    v_mov_b32 v1, s38
    v_mov_b32 v2, s28
    s_waitcnt vmcnt(0)
    s_mov_b64 exec, 1
    buffer_store_dword v1, v2, s[40:43], 0 offen offset:256 sc1
    s_mov_b64 exec, -1
    s_nop 3
    v_mfma_f32_16x16x32_bf16 v[192:195], v[32:35], v[48:51], v[192:195]
    ds_read_b128 v[76:79], v10 offset:0
    v_mfma_f32_16x16x32_bf16 v[196:199], v[32:35], v[52:55], v[196:199]
    ds_read_b128 v[92:95], v12 offset:0
    v_mfma_f32_16x16x32_bf16 v[200:203], v[32:35], v[56:59], v[200:203]
    ds_read_b128 v[80:83], v10 offset:2048
    v_mfma_f32_16x16x32_bf16 v[204:207], v[32:35], v[60:63], v[204:207]
    ds_read_b128 v[96:99], v12 offset:2048
    v_mfma_f32_16x16x32_bf16 v[220:223], v[36:39], v[60:63], v[220:223]
    ds_read_b128 v[84:87], v10 offset:4096
    v_mfma_f32_16x16x32_bf16 v[216:219], v[36:39], v[56:59], v[216:219]
    ds_read_b128 v[100:103], v12 offset:4096
    v_mfma_f32_16x16x32_bf16 v[212:215], v[36:39], v[52:55], v[212:215]
    ds_read_b128 v[88:91], v10 offset:6144
    v_mfma_f32_16x16x32_bf16 v[208:211], v[36:39], v[48:51], v[208:211]
    ds_read_b128 v[104:107], v12 offset:6144
    v_mfma_f32_16x16x32_bf16 v[224:227], v[40:43], v[48:51], v[224:227]
    v_mfma_f32_16x16x32_bf16 v[228:231], v[40:43], v[52:55], v[228:231]
    v_mfma_f32_16x16x32_bf16 v[232:235], v[40:43], v[56:59], v[232:235]
    v_mfma_f32_16x16x32_bf16 v[236:239], v[40:43], v[60:63], v[236:239]
    v_mfma_f32_16x16x32_bf16 v[120:123], v[44:47], v[60:63], v[120:123]
    v_mfma_f32_16x16x32_bf16 v[116:119], v[44:47], v[56:59], v[116:119]
    v_mfma_f32_16x16x32_bf16 v[112:115], v[44:47], v[52:55], v[112:115]
    v_mfma_f32_16x16x32_bf16 v[108:111], v[44:47], v[48:51], v[108:111]
    s_waitcnt lgkmcnt(0)
    v_mfma_f32_16x16x32_bf16 v[192:195], v[76:79], v[92:95], v[192:195]
    v_mfma_f32_16x16x32_bf16 v[196:199], v[76:79], v[96:99], v[196:199]
    v_mfma_f32_16x16x32_bf16 v[200:203], v[76:79], v[100:103], v[200:203]
    v_mfma_f32_16x16x32_bf16 v[204:207], v[76:79], v[104:107], v[204:207]
    v_mfma_f32_16x16x32_bf16 v[220:223], v[80:83], v[104:107], v[220:223]
    v_mfma_f32_16x16x32_bf16 v[216:219], v[80:83], v[100:103], v[216:219]
    v_mfma_f32_16x16x32_bf16 v[212:215], v[80:83], v[96:99], v[212:215]
    v_mfma_f32_16x16x32_bf16 v[208:211], v[80:83], v[92:95], v[208:211]
    v_mfma_f32_16x16x32_bf16 v[224:227], v[84:87], v[92:95], v[224:227]
    v_mfma_f32_16x16x32_bf16 v[228:231], v[84:87], v[96:99], v[228:231]
    v_mfma_f32_16x16x32_bf16 v[232:235], v[84:87], v[100:103], v[232:235]
    v_mfma_f32_16x16x32_bf16 v[236:239], v[84:87], v[104:107], v[236:239]
    v_mfma_f32_16x16x32_bf16 v[120:123], v[88:91], v[104:107], v[120:123]
    v_mfma_f32_16x16x32_bf16 v[116:119], v[88:91], v[100:103], v[116:119]
    v_mfma_f32_16x16x32_bf16 v[112:115], v[88:91], v[96:99], v[112:115]
    v_mfma_f32_16x16x32_bf16 v[108:111], v[88:91], v[92:95], v[108:111]
    s_barrier
    s_nop 7
    s_and_b32 s19, s16, 29
    s_cmp_eq_u32 s19, 0
    s_cbranch_scc1 L_s1_typeB_18
    v_pk_add_f32 v[32:33], v[192:193], v[232:233]
    v_pk_add_f32 v[34:35], v[194:195], v[234:235]
    v_cvt_pk_bf16_f32 v56, v32, v33
    v_cvt_pk_bf16_f32 v57, v34, v35
    v_pk_add_f32 v[32:33], v[208:209], v[116:117]
    v_pk_add_f32 v[34:35], v[210:211], v[118:119]
    v_cvt_pk_bf16_f32 v58, v32, v33
    v_cvt_pk_bf16_f32 v59, v34, v35
    s_add_u32 s19, s18, 0
    s_nop 0
    v_permlane16_swap_b32 v56, v58
    v_permlane16_swap_b32 v57, v59
    buffer_store_dwordx4 v[56:59], v17, s[40:43], s19 offen sc1
    v_pk_add_f32 v[32:33], v[224:225], v[200:201] neg_lo:[0,1] neg_hi:[0,1]
    v_pk_add_f32 v[34:35], v[226:227], v[202:203] neg_lo:[0,1] neg_hi:[0,1]
    v_cvt_pk_bf16_f32 v60, v32, v33
    v_cvt_pk_bf16_f32 v61, v34, v35
    v_pk_add_f32 v[32:33], v[108:109], v[216:217] neg_lo:[0,1] neg_hi:[0,1]
    v_pk_add_f32 v[34:35], v[110:111], v[218:219] neg_lo:[0,1] neg_hi:[0,1]
    v_cvt_pk_bf16_f32 v62, v32, v33
    v_cvt_pk_bf16_f32 v63, v34, v35
    s_add_u32 s19, s18, 262144
    s_nop 0
    v_permlane16_swap_b32 v60, v62
    v_permlane16_swap_b32 v61, v63
    buffer_store_dwordx4 v[60:63], v17, s[40:43], s19 offen sc1
    v_pk_add_f32 v[32:33], v[196:197], v[236:237]
    v_pk_add_f32 v[34:35], v[198:199], v[238:239]
    v_cvt_pk_bf16_f32 v64, v32, v33
    v_cvt_pk_bf16_f32 v65, v34, v35
    v_pk_add_f32 v[32:33], v[212:213], v[120:121]
    v_pk_add_f32 v[34:35], v[214:215], v[122:123]
    v_cvt_pk_bf16_f32 v66, v32, v33
    v_cvt_pk_bf16_f32 v67, v34, v35
    s_add_u32 s19, s18, 1024
    s_nop 0
    v_permlane16_swap_b32 v64, v66
    v_permlane16_swap_b32 v65, v67
    buffer_store_dwordx4 v[64:67], v17, s[40:43], s19 offen sc1
    v_pk_add_f32 v[32:33], v[228:229], v[204:205] neg_lo:[0,1] neg_hi:[0,1]
    v_pk_add_f32 v[34:35], v[230:231], v[206:207] neg_lo:[0,1] neg_hi:[0,1]
    v_cvt_pk_bf16_f32 v68, v32, v33
    v_cvt_pk_bf16_f32 v69, v34, v35
    v_pk_add_f32 v[32:33], v[112:113], v[220:221] neg_lo:[0,1] neg_hi:[0,1]
    v_pk_add_f32 v[34:35], v[114:115], v[222:223] neg_lo:[0,1] neg_hi:[0,1]
    v_cvt_pk_bf16_f32 v70, v32, v33
    v_cvt_pk_bf16_f32 v71, v34, v35
    s_add_u32 s19, s18, 263168
    s_nop 0
    v_permlane16_swap_b32 v68, v70
    v_permlane16_swap_b32 v69, v71
    buffer_store_dwordx4 v[68:71], v17, s[40:43], s19 offen sc1
    s_cmp_ge_u32 s16, 4
    s_cbranch_scc1 L_s1_done_19
    s_mov_b32 s20, 0x80008000
    s_add_u32 s19, s18, 1024
    buffer_store_dwordx4 v[56:59], v22, s[40:43], s19 offen sc1
    s_add_u32 s19, s18, 263168
    v_xor_b32 v72, s20, v60
    v_xor_b32 v73, s20, v61
    v_xor_b32 v74, s20, v62
    v_xor_b32 v75, s20, v63
    buffer_store_dwordx4 v[72:75], v22, s[40:43], s19 offen sc1
    s_add_u32 s19, s18, 0
    buffer_store_dwordx4 v[64:67], v22, s[40:43], s19 offen sc1
    s_add_u32 s19, s18, 262144
    v_xor_b32 v76, s20, v68
    v_xor_b32 v77, s20, v69
    v_xor_b32 v78, s20, v70
    v_xor_b32 v79, s20, v71
    buffer_store_dwordx4 v[76:79], v22, s[40:43], s19 offen sc1
    s_branch L_s1_done_19
L_s1_typeB_18:
    v_cvt_pk_bf16_f32 v56, v192, v193
    v_cvt_pk_bf16_f32 v57, v194, v195
    v_cvt_pk_bf16_f32 v58, v208, v209
    v_cvt_pk_bf16_f32 v59, v210, v211
    s_mov_b32 s19, 0
    s_nop 0
    v_permlane16_swap_b32 v56, v58
    v_permlane16_swap_b32 v57, v59
    buffer_store_dwordx4 v[56:59], v17, s[40:43], s19 offen sc1
    v_cvt_pk_bf16_f32 v60, -v200, -v201
    v_cvt_pk_bf16_f32 v61, -v202, -v203
    v_cvt_pk_bf16_f32 v62, -v216, -v217
    v_cvt_pk_bf16_f32 v63, -v218, -v219
    s_mov_b32 s19, 262144
    s_nop 0
    v_permlane16_swap_b32 v60, v62
    v_permlane16_swap_b32 v61, v63
    buffer_store_dwordx4 v[60:63], v17, s[40:43], s19 offen sc1
    v_cvt_pk_bf16_f32 v64, v224, v225
    v_cvt_pk_bf16_f32 v65, v226, v227
    v_cvt_pk_bf16_f32 v66, v108, v109
    v_cvt_pk_bf16_f32 v67, v110, v111
    s_mov_b32 s19, 4194304
    s_nop 0
    v_permlane16_swap_b32 v64, v66
    v_permlane16_swap_b32 v65, v67
    buffer_store_dwordx4 v[64:67], v17, s[40:43], s19 offen sc1
    v_cvt_pk_bf16_f32 v68, -v232, -v233
    v_cvt_pk_bf16_f32 v69, -v234, -v235
    v_cvt_pk_bf16_f32 v70, -v116, -v117
    v_cvt_pk_bf16_f32 v71, -v118, -v119
    s_mov_b32 s19, 4456448
    s_nop 0
    v_permlane16_swap_b32 v68, v70
    v_permlane16_swap_b32 v69, v71
    buffer_store_dwordx4 v[68:71], v17, s[40:43], s19 offen sc1
    v_cvt_pk_bf16_f32 v72, v196, v197
    v_cvt_pk_bf16_f32 v73, v198, v199
    v_cvt_pk_bf16_f32 v74, v212, v213
    v_cvt_pk_bf16_f32 v75, v214, v215
    s_mov_b32 s19, 1024
    s_nop 0
    v_permlane16_swap_b32 v72, v74
    v_permlane16_swap_b32 v73, v75
    buffer_store_dwordx4 v[72:75], v17, s[40:43], s19 offen sc1
    v_cvt_pk_bf16_f32 v76, -v204, -v205
    v_cvt_pk_bf16_f32 v77, -v206, -v207
    v_cvt_pk_bf16_f32 v78, -v220, -v221
    v_cvt_pk_bf16_f32 v79, -v222, -v223
    s_mov_b32 s19, 263168
    s_nop 0
    v_permlane16_swap_b32 v76, v78
    v_permlane16_swap_b32 v77, v79
    buffer_store_dwordx4 v[76:79], v17, s[40:43], s19 offen sc1
    v_cvt_pk_bf16_f32 v80, v228, v229
    v_cvt_pk_bf16_f32 v81, v230, v231
    v_cvt_pk_bf16_f32 v82, v112, v113
    v_cvt_pk_bf16_f32 v83, v114, v115
    s_mov_b32 s19, 4195328
    s_nop 0
    v_permlane16_swap_b32 v80, v82
    v_permlane16_swap_b32 v81, v83
    buffer_store_dwordx4 v[80:83], v17, s[40:43], s19 offen sc1
    v_cvt_pk_bf16_f32 v84, -v236, -v237
    v_cvt_pk_bf16_f32 v85, -v238, -v239
    v_cvt_pk_bf16_f32 v86, -v120, -v121
    v_cvt_pk_bf16_f32 v87, -v122, -v123
    s_mov_b32 s19, 4457472
    s_nop 0
    v_permlane16_swap_b32 v84, v86
    v_permlane16_swap_b32 v85, v87
    buffer_store_dwordx4 v[84:87], v17, s[40:43], s19 offen sc1
L_s1_done_19:
    s_mov_b32 s14, 131072
    v_add_u32 v9, s14, v4
    v_add_u32 v10, s14, v5
    v_add_u32 v11, s14, v6
    v_xor_b32 v12, 32, v11
    v_xor_b32 v13, 128, v11
    v_xor_b32 v14, 160, v11
    s_barrier
    ds_read_b64_tr_b16 v[48:49], v11 offset:0
    ds_read_b64_tr_b16 v[50:51], v11 offset:1024
    ds_read_b128 v[32:35], v9 offset:0
    ds_read_b64_tr_b16 v[52:53], v12 offset:0
    ds_read_b64_tr_b16 v[54:55], v12 offset:1024
    ds_read_b128 v[36:39], v9 offset:2048
    ds_read_b64_tr_b16 v[56:57], v13 offset:0
    ds_read_b64_tr_b16 v[58:59], v13 offset:1024
    ds_read_b128 v[40:43], v9 offset:4096
    ds_read_b64_tr_b16 v[60:61], v14 offset:0
    ds_read_b64_tr_b16 v[62:63], v14 offset:1024
    ds_read_b128 v[44:47], v9 offset:6144
    s_mov_b32 s15, 0
    s_waitcnt lgkmcnt(0)
    s_mov_b32 s15, 0
.p2align 6
L_g2_loop_20:
    v_mfma_f32_16x16x32_bf16 v[128:131], v[48:51], v[32:35], v[128:131]
    ds_read_b64_tr_b16 v[80:81], v11 offset:8192
    ds_read_b64_tr_b16 v[82:83], v11 offset:9216
    v_mfma_f32_16x16x32_bf16 v[132:135], v[48:51], v[36:39], v[132:135]
    ds_read_b128 v[64:67], v10 offset:0
    ds_read_b64_tr_b16 v[84:85], v12 offset:8192
    v_mfma_f32_16x16x32_bf16 v[136:139], v[48:51], v[40:43], v[136:139]
    ds_read_b64_tr_b16 v[86:87], v12 offset:9216
    ds_read_b128 v[68:71], v10 offset:2048
    v_mfma_f32_16x16x32_bf16 v[140:143], v[48:51], v[44:47], v[140:143]
    ds_read_b64_tr_b16 v[88:89], v13 offset:8192
    ds_read_b64_tr_b16 v[90:91], v13 offset:9216
    v_mfma_f32_16x16x32_bf16 v[156:159], v[52:55], v[44:47], v[156:159]
    ds_read_b128 v[72:75], v10 offset:4096
    ds_read_b64_tr_b16 v[92:93], v14 offset:8192
    v_mfma_f32_16x16x32_bf16 v[152:155], v[52:55], v[40:43], v[152:155]
    ds_read_b64_tr_b16 v[94:95], v14 offset:9216
    ds_read_b128 v[76:79], v10 offset:6144
    v_mfma_f32_16x16x32_bf16 v[148:151], v[52:55], v[36:39], v[148:151]
    s_add_u32 s14, s14, 32768
    s_cmp_eq_u32 s14, 163840
    v_mfma_f32_16x16x32_bf16 v[144:147], v[52:55], v[32:35], v[144:147]
    s_cselect_b32 s14, 0, s14
    v_add_u32 v9, s14, v4
    v_mfma_f32_16x16x32_bf16 v[160:163], v[56:59], v[32:35], v[160:163]
    v_add_u32 v10, s14, v5
    v_add_u32 v11, s14, v6
    v_mfma_f32_16x16x32_bf16 v[164:167], v[56:59], v[36:39], v[164:167]
    v_xor_b32 v12, 32, v11
    v_xor_b32 v13, 128, v11
    v_mfma_f32_16x16x32_bf16 v[168:171], v[56:59], v[40:43], v[168:171]
    v_xor_b32 v14, 160, v11
    v_mfma_f32_16x16x32_bf16 v[172:175], v[56:59], v[44:47], v[172:175]
    v_mfma_f32_16x16x32_bf16 v[188:191], v[60:63], v[44:47], v[188:191]
    v_mfma_f32_16x16x32_bf16 v[184:187], v[60:63], v[40:43], v[184:187]
    v_mfma_f32_16x16x32_bf16 v[180:183], v[60:63], v[36:39], v[180:183]
    v_mfma_f32_16x16x32_bf16 v[176:179], v[60:63], v[32:35], v[176:179]
    s_waitcnt lgkmcnt(0)
    s_barrier
    v_mfma_f32_16x16x32_bf16 v[128:131], v[80:83], v[64:67], v[128:131]
    ds_read_b64_tr_b16 v[48:49], v11 offset:0
    v_mfma_f32_16x16x32_bf16 v[132:135], v[80:83], v[68:71], v[132:135]
    ds_read_b64_tr_b16 v[50:51], v11 offset:1024
    v_mfma_f32_16x16x32_bf16 v[136:139], v[80:83], v[72:75], v[136:139]
    ds_read_b128 v[32:35], v9 offset:0
    v_mfma_f32_16x16x32_bf16 v[140:143], v[80:83], v[76:79], v[140:143]
    ds_read_b64_tr_b16 v[52:53], v12 offset:0
    v_mfma_f32_16x16x32_bf16 v[156:159], v[84:87], v[76:79], v[156:159]
    ds_read_b64_tr_b16 v[54:55], v12 offset:1024
    v_mfma_f32_16x16x32_bf16 v[152:155], v[84:87], v[72:75], v[152:155]
    ds_read_b128 v[36:39], v9 offset:2048
    v_mfma_f32_16x16x32_bf16 v[148:151], v[84:87], v[68:71], v[148:151]
    ds_read_b64_tr_b16 v[56:57], v13 offset:0
    v_mfma_f32_16x16x32_bf16 v[144:147], v[84:87], v[64:67], v[144:147]
    ds_read_b64_tr_b16 v[58:59], v13 offset:1024
    v_mfma_f32_16x16x32_bf16 v[160:163], v[88:91], v[64:67], v[160:163]
    ds_read_b128 v[40:43], v9 offset:4096
    v_mfma_f32_16x16x32_bf16 v[164:167], v[88:91], v[68:71], v[164:167]
    ds_read_b64_tr_b16 v[60:61], v14 offset:0
    v_mfma_f32_16x16x32_bf16 v[168:171], v[88:91], v[72:75], v[168:171]
    ds_read_b64_tr_b16 v[62:63], v14 offset:1024
    v_mfma_f32_16x16x32_bf16 v[172:175], v[88:91], v[76:79], v[172:175]
    ds_read_b128 v[44:47], v9 offset:6144
    v_mfma_f32_16x16x32_bf16 v[188:191], v[92:95], v[76:79], v[188:191]
    s_add_u32 s15, s15, 1
    v_mfma_f32_16x16x32_bf16 v[184:187], v[92:95], v[72:75], v[184:187]
    s_cmp_lt_u32 s15, 6
    v_mfma_f32_16x16x32_bf16 v[180:183], v[92:95], v[68:71], v[180:183]
    v_mfma_f32_16x16x32_bf16 v[176:179], v[92:95], v[64:67], v[176:179]
    s_waitcnt lgkmcnt(0)
    s_cbranch_scc1 L_g2_loop_20
    v_mfma_f32_16x16x32_bf16 v[128:131], v[48:51], v[32:35], v[128:131]
    ds_read_b64_tr_b16 v[80:81], v11 offset:8192
    ds_read_b64_tr_b16 v[82:83], v11 offset:9216
    v_mfma_f32_16x16x32_bf16 v[132:135], v[48:51], v[36:39], v[132:135]
    ds_read_b128 v[64:67], v10 offset:0
    ds_read_b64_tr_b16 v[84:85], v12 offset:8192
    v_mfma_f32_16x16x32_bf16 v[136:139], v[48:51], v[40:43], v[136:139]
    ds_read_b64_tr_b16 v[86:87], v12 offset:9216
    ds_read_b128 v[68:71], v10 offset:2048
    v_mfma_f32_16x16x32_bf16 v[140:143], v[48:51], v[44:47], v[140:143]
    ds_read_b64_tr_b16 v[88:89], v13 offset:8192
    ds_read_b64_tr_b16 v[90:91], v13 offset:9216
    v_mfma_f32_16x16x32_bf16 v[156:159], v[52:55], v[44:47], v[156:159]
    ds_read_b128 v[72:75], v10 offset:4096
    ds_read_b64_tr_b16 v[92:93], v14 offset:8192
    v_mfma_f32_16x16x32_bf16 v[152:155], v[52:55], v[40:43], v[152:155]
    ds_read_b64_tr_b16 v[94:95], v14 offset:9216
    ds_read_b128 v[76:79], v10 offset:6144
    v_mfma_f32_16x16x32_bf16 v[148:151], v[52:55], v[36:39], v[148:151]
    s_add_u32 s14, s14, 32768
    s_cmp_eq_u32 s14, 163840
    v_mfma_f32_16x16x32_bf16 v[144:147], v[52:55], v[32:35], v[144:147]
    s_cselect_b32 s14, 0, s14
    v_add_u32 v9, s14, v4
    v_mfma_f32_16x16x32_bf16 v[160:163], v[56:59], v[32:35], v[160:163]
    v_add_u32 v10, s14, v5
    v_add_u32 v11, s14, v6
    v_mfma_f32_16x16x32_bf16 v[164:167], v[56:59], v[36:39], v[164:167]
    v_xor_b32 v12, 32, v11
    v_xor_b32 v13, 128, v11
    v_mfma_f32_16x16x32_bf16 v[168:171], v[56:59], v[40:43], v[168:171]
    v_xor_b32 v14, 160, v11
    v_mfma_f32_16x16x32_bf16 v[172:175], v[56:59], v[44:47], v[172:175]
    v_mfma_f32_16x16x32_bf16 v[188:191], v[60:63], v[44:47], v[188:191]
    v_mfma_f32_16x16x32_bf16 v[184:187], v[60:63], v[40:43], v[184:187]
    v_mfma_f32_16x16x32_bf16 v[180:183], v[60:63], v[36:39], v[180:183]
    v_mfma_f32_16x16x32_bf16 v[176:179], v[60:63], v[32:35], v[176:179]
    s_waitcnt lgkmcnt(0)
    s_waitcnt vmcnt(0)
    s_barrier
    v_mfma_f32_16x16x32_bf16 v[128:131], v[80:83], v[64:67], v[128:131]
    ds_read_b64_tr_b16 v[48:49], v11 offset:0
    v_mfma_f32_16x16x32_bf16 v[132:135], v[80:83], v[68:71], v[132:135]
    ds_read_b64_tr_b16 v[50:51], v11 offset:1024
    v_mfma_f32_16x16x32_bf16 v[136:139], v[80:83], v[72:75], v[136:139]
    ds_read_b128 v[32:35], v9 offset:0
    v_mfma_f32_16x16x32_bf16 v[140:143], v[80:83], v[76:79], v[140:143]
    ds_read_b64_tr_b16 v[52:53], v12 offset:0
    v_mfma_f32_16x16x32_bf16 v[156:159], v[84:87], v[76:79], v[156:159]
    ds_read_b64_tr_b16 v[54:55], v12 offset:1024
    v_mfma_f32_16x16x32_bf16 v[152:155], v[84:87], v[72:75], v[152:155]
    ds_read_b128 v[36:39], v9 offset:2048
    v_mfma_f32_16x16x32_bf16 v[148:151], v[84:87], v[68:71], v[148:151]
    ds_read_b64_tr_b16 v[56:57], v13 offset:0
    v_mfma_f32_16x16x32_bf16 v[144:147], v[84:87], v[64:67], v[144:147]
    ds_read_b64_tr_b16 v[58:59], v13 offset:1024
    v_mfma_f32_16x16x32_bf16 v[160:163], v[88:91], v[64:67], v[160:163]
    ds_read_b128 v[40:43], v9 offset:4096
    v_mfma_f32_16x16x32_bf16 v[164:167], v[88:91], v[68:71], v[164:167]
    ds_read_b64_tr_b16 v[60:61], v14 offset:0
    v_mfma_f32_16x16x32_bf16 v[168:171], v[88:91], v[72:75], v[168:171]
    ds_read_b64_tr_b16 v[62:63], v14 offset:1024
    v_mfma_f32_16x16x32_bf16 v[172:175], v[88:91], v[76:79], v[172:175]
    ds_read_b128 v[44:47], v9 offset:6144
    v_mfma_f32_16x16x32_bf16 v[188:191], v[92:95], v[76:79], v[188:191]
    v_mfma_f32_16x16x32_bf16 v[184:187], v[92:95], v[72:75], v[184:187]
    v_mfma_f32_16x16x32_bf16 v[180:183], v[92:95], v[68:71], v[180:183]
    v_mfma_f32_16x16x32_bf16 v[176:179], v[92:95], v[64:67], v[176:179]
    s_waitcnt lgkmcnt(0)
    s_mov_b32 s15, 0
.p2align 6
L_g2_loop_21:
    v_mfma_f32_16x16x32_bf16 v[128:131], v[48:51], v[32:35], v[128:131]
    ds_read_b64_tr_b16 v[80:81], v11 offset:8192
    ds_read_b64_tr_b16 v[82:83], v11 offset:9216
    v_mfma_f32_16x16x32_bf16 v[132:135], v[48:51], v[36:39], v[132:135]
    ds_read_b128 v[64:67], v10 offset:0
    ds_read_b64_tr_b16 v[84:85], v12 offset:8192
    v_mfma_f32_16x16x32_bf16 v[136:139], v[48:51], v[40:43], v[136:139]
    ds_read_b64_tr_b16 v[86:87], v12 offset:9216
    ds_read_b128 v[68:71], v10 offset:2048
    v_mfma_f32_16x16x32_bf16 v[140:143], v[48:51], v[44:47], v[140:143]
    ds_read_b64_tr_b16 v[88:89], v13 offset:8192
    ds_read_b64_tr_b16 v[90:91], v13 offset:9216
    v_mfma_f32_16x16x32_bf16 v[156:159], v[52:55], v[44:47], v[156:159]
    ds_read_b128 v[72:75], v10 offset:4096
    ds_read_b64_tr_b16 v[92:93], v14 offset:8192
    v_mfma_f32_16x16x32_bf16 v[152:155], v[52:55], v[40:43], v[152:155]
    ds_read_b64_tr_b16 v[94:95], v14 offset:9216
    ds_read_b128 v[76:79], v10 offset:6144
    v_mfma_f32_16x16x32_bf16 v[148:151], v[52:55], v[36:39], v[148:151]
    s_add_u32 s14, s14, 32768
    s_cmp_eq_u32 s14, 163840
    v_mfma_f32_16x16x32_bf16 v[144:147], v[52:55], v[32:35], v[144:147]
    s_cselect_b32 s14, 0, s14
    v_add_u32 v9, s14, v4
    v_mfma_f32_16x16x32_bf16 v[160:163], v[56:59], v[32:35], v[160:163]
    v_add_u32 v10, s14, v5
    v_add_u32 v11, s14, v6
    v_mfma_f32_16x16x32_bf16 v[164:167], v[56:59], v[36:39], v[164:167]
    v_xor_b32 v12, 32, v11
    v_xor_b32 v13, 128, v11
    v_mfma_f32_16x16x32_bf16 v[168:171], v[56:59], v[40:43], v[168:171]
    v_xor_b32 v14, 160, v11
    v_mfma_f32_16x16x32_bf16 v[172:175], v[56:59], v[44:47], v[172:175]
    v_mfma_f32_16x16x32_bf16 v[188:191], v[60:63], v[44:47], v[188:191]
    v_mfma_f32_16x16x32_bf16 v[184:187], v[60:63], v[40:43], v[184:187]
    v_mfma_f32_16x16x32_bf16 v[180:183], v[60:63], v[36:39], v[180:183]
    v_mfma_f32_16x16x32_bf16 v[176:179], v[60:63], v[32:35], v[176:179]
    s_waitcnt lgkmcnt(0)
    s_barrier
    v_mfma_f32_16x16x32_bf16 v[128:131], v[80:83], v[64:67], v[128:131]
    ds_read_b64_tr_b16 v[48:49], v11 offset:0
    v_mfma_f32_16x16x32_bf16 v[132:135], v[80:83], v[68:71], v[132:135]
    ds_read_b64_tr_b16 v[50:51], v11 offset:1024
    v_mfma_f32_16x16x32_bf16 v[136:139], v[80:83], v[72:75], v[136:139]
    ds_read_b128 v[32:35], v9 offset:0
    v_mfma_f32_16x16x32_bf16 v[140:143], v[80:83], v[76:79], v[140:143]
    ds_read_b64_tr_b16 v[52:53], v12 offset:0
    v_mfma_f32_16x16x32_bf16 v[156:159], v[84:87], v[76:79], v[156:159]
    ds_read_b64_tr_b16 v[54:55], v12 offset:1024
    v_mfma_f32_16x16x32_bf16 v[152:155], v[84:87], v[72:75], v[152:155]
    ds_read_b128 v[36:39], v9 offset:2048
    v_mfma_f32_16x16x32_bf16 v[148:151], v[84:87], v[68:71], v[148:151]
    ds_read_b64_tr_b16 v[56:57], v13 offset:0
    v_mfma_f32_16x16x32_bf16 v[144:147], v[84:87], v[64:67], v[144:147]
    ds_read_b64_tr_b16 v[58:59], v13 offset:1024
    v_mfma_f32_16x16x32_bf16 v[160:163], v[88:91], v[64:67], v[160:163]
    ds_read_b128 v[40:43], v9 offset:4096
    v_mfma_f32_16x16x32_bf16 v[164:167], v[88:91], v[68:71], v[164:167]
    ds_read_b64_tr_b16 v[60:61], v14 offset:0
    v_mfma_f32_16x16x32_bf16 v[168:171], v[88:91], v[72:75], v[168:171]
    ds_read_b64_tr_b16 v[62:63], v14 offset:1024
    v_mfma_f32_16x16x32_bf16 v[172:175], v[88:91], v[76:79], v[172:175]
    ds_read_b128 v[44:47], v9 offset:6144
    v_mfma_f32_16x16x32_bf16 v[188:191], v[92:95], v[76:79], v[188:191]
    s_add_u32 s15, s15, 1
    v_mfma_f32_16x16x32_bf16 v[184:187], v[92:95], v[72:75], v[184:187]
    s_cmp_lt_u32 s15, 20
    v_mfma_f32_16x16x32_bf16 v[180:183], v[92:95], v[68:71], v[180:183]
    v_mfma_f32_16x16x32_bf16 v[176:179], v[92:95], v[64:67], v[176:179]
    s_waitcnt lgkmcnt(0)
    s_cbranch_scc1 L_g2_loop_21
    v_mfma_f32_16x16x32_bf16 v[128:131], v[48:51], v[32:35], v[128:131]
    ds_read_b64_tr_b16 v[80:81], v11 offset:8192
    ds_read_b64_tr_b16 v[82:83], v11 offset:9216
    v_mfma_f32_16x16x32_bf16 v[132:135], v[48:51], v[36:39], v[132:135]
    ds_read_b128 v[64:67], v10 offset:0
    ds_read_b64_tr_b16 v[84:85], v12 offset:8192
    v_mfma_f32_16x16x32_bf16 v[136:139], v[48:51], v[40:43], v[136:139]
    ds_read_b64_tr_b16 v[86:87], v12 offset:9216
    ds_read_b128 v[68:71], v10 offset:2048
    v_mfma_f32_16x16x32_bf16 v[140:143], v[48:51], v[44:47], v[140:143]
    ds_read_b64_tr_b16 v[88:89], v13 offset:8192
    ds_read_b64_tr_b16 v[90:91], v13 offset:9216
    v_mfma_f32_16x16x32_bf16 v[156:159], v[52:55], v[44:47], v[156:159]
    ds_read_b128 v[72:75], v10 offset:4096
    ds_read_b64_tr_b16 v[92:93], v14 offset:8192
    v_mfma_f32_16x16x32_bf16 v[152:155], v[52:55], v[40:43], v[152:155]
    ds_read_b64_tr_b16 v[94:95], v14 offset:9216
    ds_read_b128 v[76:79], v10 offset:6144
    v_mfma_f32_16x16x32_bf16 v[148:151], v[52:55], v[36:39], v[148:151]
    v_add_u32 v9, 0x10000, v4
    v_add_u32 v10, 0x10000, v5
    v_mfma_f32_16x16x32_bf16 v[144:147], v[52:55], v[32:35], v[144:147]
    v_add_u32 v11, 0x10000, v7
    v_add_u32 v12, 0x10000, v8
    v_mfma_f32_16x16x32_bf16 v[160:163], v[56:59], v[32:35], v[160:163]
    v_mfma_f32_16x16x32_bf16 v[164:167], v[56:59], v[36:39], v[164:167]
    v_mfma_f32_16x16x32_bf16 v[168:171], v[56:59], v[40:43], v[168:171]
    v_mfma_f32_16x16x32_bf16 v[172:175], v[56:59], v[44:47], v[172:175]
    v_mfma_f32_16x16x32_bf16 v[188:191], v[60:63], v[44:47], v[188:191]
    v_mfma_f32_16x16x32_bf16 v[184:187], v[60:63], v[40:43], v[184:187]
    v_mfma_f32_16x16x32_bf16 v[180:183], v[60:63], v[36:39], v[180:183]
    v_mfma_f32_16x16x32_bf16 v[176:179], v[60:63], v[32:35], v[176:179]
    s_waitcnt lgkmcnt(0)
    s_barrier
    v_mfma_f32_16x16x32_bf16 v[160:163], v[88:91], v[64:67], v[160:163]
    ds_read_b128 v[96:99], v11 offset:0
    ds_read_b128 v[100:103], v11 offset:2048
    v_mfma_f32_16x16x32_bf16 v[164:167], v[88:91], v[68:71], v[164:167]
    ds_read_b128 v[32:35], v9 offset:0
    ds_read_b128 v[36:39], v9 offset:2048
    v_mfma_f32_16x16x32_bf16 v[168:171], v[88:91], v[72:75], v[168:171]
    ds_read_b128 v[40:43], v9 offset:4096
    ds_read_b128 v[44:47], v9 offset:6144
    v_mfma_f32_16x16x32_bf16 v[172:175], v[88:91], v[76:79], v[172:175]
    ds_read_b128 v[104:107], v12 offset:0
    ds_read_b128 v[108:111], v12 offset:2048
    v_mfma_f32_16x16x32_bf16 v[176:179], v[92:95], v[64:67], v[176:179]
    ds_read_b128 v[48:51], v10 offset:0
    ds_read_b128 v[52:55], v10 offset:2048
    v_mfma_f32_16x16x32_bf16 v[180:183], v[92:95], v[68:71], v[180:183]
    ds_read_b128 v[56:59], v10 offset:4096
    ds_read_b128 v[60:63], v10 offset:6144
    v_mfma_f32_16x16x32_bf16 v[184:187], v[92:95], v[72:75], v[184:187]
    v_add_u32 v9, 0x16000, v4
    v_add_u32 v10, 0x16000, v5
    v_mfma_f32_16x16x32_bf16 v[188:191], v[92:95], v[76:79], v[188:191]
    v_add_u32 v11, 0x16000, v7
    v_add_u32 v12, 0x16000, v8
    v_mfma_f32_16x16x32_bf16 v[128:131], v[80:83], v[64:67], v[128:131]
    v_bfi_b32 v160, v28, v31, v160
    v_bfi_b32 v161, v28, v31, v161
    v_bfi_b32 v162, v28, v31, v162
    v_bfi_b32 v163, v28, v31, v163
    buffer_store_dwordx4 v[160:163], v29, s[40:43], 0 offen offset:0 sc1
    v_mfma_f32_16x16x32_bf16 v[132:135], v[80:83], v[68:71], v[132:135]
    v_bfi_b32 v164, v28, v31, v164
    v_bfi_b32 v165, v28, v31, v165
    v_bfi_b32 v166, v28, v31, v166
    v_bfi_b32 v167, v28, v31, v167
    buffer_store_dwordx4 v[164:167], v29, s[40:43], 0 offen offset:1024 sc1
    v_mfma_f32_16x16x32_bf16 v[136:139], v[80:83], v[72:75], v[136:139]
    v_bfi_b32 v168, v28, v31, v168
    v_bfi_b32 v169, v28, v31, v169
    v_bfi_b32 v170, v28, v31, v170
    v_bfi_b32 v171, v28, v31, v171
    buffer_store_dwordx4 v[168:171], v29, s[40:43], 0 offen offset:2048 sc1
    v_mfma_f32_16x16x32_bf16 v[140:143], v[80:83], v[76:79], v[140:143]
    v_bfi_b32 v172, v28, v31, v172
    v_bfi_b32 v173, v28, v31, v173
    v_bfi_b32 v174, v28, v31, v174
    v_bfi_b32 v175, v28, v31, v175
    buffer_store_dwordx4 v[172:175], v29, s[40:43], 0 offen offset:3072 sc1
    v_mfma_f32_16x16x32_bf16 v[144:147], v[84:87], v[64:67], v[144:147]
    v_bfi_b32 v176, v28, v31, v176
    v_bfi_b32 v177, v28, v31, v177
    v_bfi_b32 v178, v28, v31, v178
    v_bfi_b32 v179, v28, v31, v179
    buffer_store_dwordx4 v[176:179], v30, s[40:43], 0 offen offset:0 sc1
    v_mfma_f32_16x16x32_bf16 v[148:151], v[84:87], v[68:71], v[148:151]
    v_bfi_b32 v180, v28, v31, v180
    v_bfi_b32 v181, v28, v31, v181
    v_bfi_b32 v182, v28, v31, v182
    v_bfi_b32 v183, v28, v31, v183
    buffer_store_dwordx4 v[180:183], v30, s[40:43], 0 offen offset:1024 sc1
    v_mfma_f32_16x16x32_bf16 v[152:155], v[84:87], v[72:75], v[152:155]
    v_bfi_b32 v184, v28, v31, v184
    v_bfi_b32 v185, v28, v31, v185
    v_bfi_b32 v186, v28, v31, v186
    v_bfi_b32 v187, v28, v31, v187
    buffer_store_dwordx4 v[184:187], v30, s[40:43], 0 offen offset:2048 sc1
    v_mfma_f32_16x16x32_bf16 v[156:159], v[84:87], v[76:79], v[156:159]
    v_bfi_b32 v188, v28, v31, v188
    v_bfi_b32 v189, v28, v31, v189
    v_bfi_b32 v190, v28, v31, v190
    v_bfi_b32 v191, v28, v31, v191
    buffer_store_dwordx4 v[188:191], v30, s[40:43], 0 offen offset:3072 sc1
    s_waitcnt lgkmcnt(0)
    v_mfma_f32_16x16x32_bf16 v[192:195], v[96:99], v[32:35], 0
    ds_read_b128 v[112:115], v11 offset:0
    ds_read_b128 v[116:119], v11 offset:2048
    v_mfma_f32_16x16x32_bf16 v[196:199], v[96:99], v[36:39], 0
    ds_read_b128 v[64:67], v9 offset:0
    ds_read_b128 v[68:71], v9 offset:2048
    v_mfma_f32_16x16x32_bf16 v[200:203], v[96:99], v[40:43], 0
    ds_read_b128 v[72:75], v9 offset:4096
    ds_read_b128 v[76:79], v9 offset:6144
    v_mfma_f32_16x16x32_bf16 v[204:207], v[96:99], v[44:47], 0
    ds_read_b128 v[120:123], v12 offset:0
    ds_read_b128 v[124:127], v12 offset:2048
    v_mfma_f32_16x16x32_bf16 v[208:211], v[100:103], v[32:35], 0
    ds_read_b128 v[80:83], v10 offset:0
    ds_read_b128 v[84:87], v10 offset:2048
    v_mfma_f32_16x16x32_bf16 v[212:215], v[100:103], v[36:39], 0
    ds_read_b128 v[88:91], v10 offset:4096
    ds_read_b128 v[92:95], v10 offset:6144
    v_mfma_f32_16x16x32_bf16 v[216:219], v[100:103], v[40:43], 0
    v_add_u32 v9, 0x1c000, v4
    v_add_u32 v10, 0x1c000, v5
    v_mfma_f32_16x16x32_bf16 v[220:223], v[100:103], v[44:47], 0
    v_add_u32 v11, 0x1c000, v7
    v_add_u32 v12, 0x1c000, v8
    v_mfma_f32_16x16x32_bf16 v[192:195], v[104:107], v[48:51], v[192:195]
    v_mfma_f32_16x16x32_bf16 v[196:199], v[104:107], v[52:55], v[196:199]
    v_mfma_f32_16x16x32_bf16 v[200:203], v[104:107], v[56:59], v[200:203]
    v_mfma_f32_16x16x32_bf16 v[204:207], v[104:107], v[60:63], v[204:207]
    v_mfma_f32_16x16x32_bf16 v[208:211], v[108:111], v[48:51], v[208:211]
    v_mfma_f32_16x16x32_bf16 v[212:215], v[108:111], v[52:55], v[212:215]
    v_mfma_f32_16x16x32_bf16 v[216:219], v[108:111], v[56:59], v[216:219]
    v_mfma_f32_16x16x32_bf16 v[220:223], v[108:111], v[60:63], v[220:223]
    s_waitcnt lgkmcnt(0)
    s_barrier
    v_mfma_f32_16x16x32_bf16 v[192:195], v[112:115], v[64:67], v[192:195]
    ds_read_b128 v[96:99], v11 offset:0
    ds_read_b128 v[100:103], v11 offset:2048
    v_mfma_f32_16x16x32_bf16 v[196:199], v[112:115], v[68:71], v[196:199]
    ds_read_b128 v[32:35], v9 offset:0
    ds_read_b128 v[36:39], v9 offset:2048
    v_mfma_f32_16x16x32_bf16 v[200:203], v[112:115], v[72:75], v[200:203]
    ds_read_b128 v[40:43], v9 offset:4096
    ds_read_b128 v[44:47], v9 offset:6144
    v_mfma_f32_16x16x32_bf16 v[204:207], v[112:115], v[76:79], v[204:207]
    ds_read_b128 v[104:107], v12 offset:0
    ds_read_b128 v[108:111], v12 offset:2048
    v_mfma_f32_16x16x32_bf16 v[208:211], v[116:119], v[64:67], v[208:211]
    ds_read_b128 v[48:51], v10 offset:0
    ds_read_b128 v[52:55], v10 offset:2048
    v_mfma_f32_16x16x32_bf16 v[212:215], v[116:119], v[68:71], v[212:215]
    ds_read_b128 v[56:59], v10 offset:4096
    ds_read_b128 v[60:63], v10 offset:6144
    v_mfma_f32_16x16x32_bf16 v[216:219], v[116:119], v[72:75], v[216:219]
    v_add_u32 v9, 0x22000, v4
    v_add_u32 v10, 0x22000, v5
    v_mfma_f32_16x16x32_bf16 v[220:223], v[116:119], v[76:79], v[220:223]
    v_add_u32 v11, 0x22000, v7
    v_add_u32 v12, 0x22000, v8
    v_mfma_f32_16x16x32_bf16 v[192:195], v[120:123], v[80:83], v[192:195]
    v_mfma_f32_16x16x32_bf16 v[196:199], v[120:123], v[84:87], v[196:199]
    v_mfma_f32_16x16x32_bf16 v[200:203], v[120:123], v[88:91], v[200:203]
    v_mfma_f32_16x16x32_bf16 v[204:207], v[120:123], v[92:95], v[204:207]
    v_mfma_f32_16x16x32_bf16 v[208:211], v[124:127], v[80:83], v[208:211]
    v_mfma_f32_16x16x32_bf16 v[212:215], v[124:127], v[84:87], v[212:215]
    v_mfma_f32_16x16x32_bf16 v[216:219], v[124:127], v[88:91], v[216:219]
    v_mfma_f32_16x16x32_bf16 v[220:223], v[124:127], v[92:95], v[220:223]
    s_waitcnt lgkmcnt(0)
    v_mfma_f32_16x16x32_bf16 v[192:195], v[96:99], v[32:35], v[192:195]
    ds_read_b128 v[112:115], v11 offset:0
    ds_read_b128 v[116:119], v11 offset:2048
    v_mfma_f32_16x16x32_bf16 v[196:199], v[96:99], v[36:39], v[196:199]
    ds_read_b128 v[64:67], v9 offset:0
    ds_read_b128 v[68:71], v9 offset:2048
    v_mfma_f32_16x16x32_bf16 v[200:203], v[96:99], v[40:43], v[200:203]
    ds_read_b128 v[72:75], v9 offset:4096
    ds_read_b128 v[76:79], v9 offset:6144
    v_mfma_f32_16x16x32_bf16 v[204:207], v[96:99], v[44:47], v[204:207]
    ds_read_b128 v[120:123], v12 offset:0
    ds_read_b128 v[124:127], v12 offset:2048
    v_mfma_f32_16x16x32_bf16 v[208:211], v[100:103], v[32:35], v[208:211]
    ds_read_b128 v[80:83], v10 offset:0
    ds_read_b128 v[84:87], v10 offset:2048
    v_mfma_f32_16x16x32_bf16 v[212:215], v[100:103], v[36:39], v[212:215]
    ds_read_b128 v[88:91], v10 offset:4096
    ds_read_b128 v[92:95], v10 offset:6144
    v_mfma_f32_16x16x32_bf16 v[216:219], v[100:103], v[40:43], v[216:219]
    v_mfma_f32_16x16x32_bf16 v[220:223], v[100:103], v[44:47], v[220:223]
    v_mfma_f32_16x16x32_bf16 v[192:195], v[104:107], v[48:51], v[192:195]
    v_mfma_f32_16x16x32_bf16 v[196:199], v[104:107], v[52:55], v[196:199]
    v_mfma_f32_16x16x32_bf16 v[200:203], v[104:107], v[56:59], v[200:203]
    v_mfma_f32_16x16x32_bf16 v[204:207], v[104:107], v[60:63], v[204:207]
    v_mfma_f32_16x16x32_bf16 v[208:211], v[108:111], v[48:51], v[208:211]
    v_mfma_f32_16x16x32_bf16 v[212:215], v[108:111], v[52:55], v[212:215]
    v_mfma_f32_16x16x32_bf16 v[216:219], v[108:111], v[56:59], v[216:219]
    v_mfma_f32_16x16x32_bf16 v[220:223], v[108:111], v[60:63], v[220:223]
    s_waitcnt lgkmcnt(0)
    s_barrier
    v_mfma_f32_16x16x32_bf16 v[192:195], v[112:115], v[64:67], v[192:195]
    v_mfma_f32_16x16x32_bf16 v[196:199], v[112:115], v[68:71], v[196:199]
    v_mfma_f32_16x16x32_bf16 v[200:203], v[112:115], v[72:75], v[200:203]
    v_mfma_f32_16x16x32_bf16 v[204:207], v[112:115], v[76:79], v[204:207]
    v_mfma_f32_16x16x32_bf16 v[208:211], v[116:119], v[64:67], v[208:211]
    v_mfma_f32_16x16x32_bf16 v[212:215], v[116:119], v[68:71], v[212:215]
    v_mfma_f32_16x16x32_bf16 v[216:219], v[116:119], v[72:75], v[216:219]
    v_mfma_f32_16x16x32_bf16 v[220:223], v[116:119], v[76:79], v[220:223]
    v_mfma_f32_16x16x32_bf16 v[192:195], v[120:123], v[80:83], v[192:195]
    v_mfma_f32_16x16x32_bf16 v[196:199], v[120:123], v[84:87], v[196:199]
    v_mfma_f32_16x16x32_bf16 v[200:203], v[120:123], v[88:91], v[200:203]
    v_mfma_f32_16x16x32_bf16 v[204:207], v[120:123], v[92:95], v[204:207]
    v_mfma_f32_16x16x32_bf16 v[208:211], v[124:127], v[80:83], v[208:211]
    v_mfma_f32_16x16x32_bf16 v[212:215], v[124:127], v[84:87], v[212:215]
    v_mfma_f32_16x16x32_bf16 v[216:219], v[124:127], v[88:91], v[216:219]
    v_mfma_f32_16x16x32_bf16 v[220:223], v[124:127], v[92:95], v[220:223]
    v_lshlrev_b32 v26, 4, v3
    s_lshl_b32 s16, s3, 13
    s_add_u32 s16, s16, 32768
    v_add_u32 v26, s16, v26
    v_lshlrev_b32 v32, 16, v240
    v_and_b32 v33, s82, v240
    v_lshlrev_b32 v34, 16, v241
    v_and_b32 v35, s82, v241
    v_lshlrev_b32 v36, 16, v242
    v_and_b32 v37, s82, v242
    v_lshlrev_b32 v38, 16, v243
    v_and_b32 v39, s82, v243
    v_lshlrev_b32 v40, 16, v244
    v_and_b32 v41, s82, v244
    v_lshlrev_b32 v42, 16, v245
    v_and_b32 v43, s82, v245
    v_lshlrev_b32 v44, 16, v246
    v_and_b32 v45, s82, v246
    v_lshlrev_b32 v46, 16, v247
    v_and_b32 v47, s82, v247
    v_lshlrev_b32 v48, 16, v248
    v_and_b32 v49, s82, v248
    v_lshlrev_b32 v50, 16, v249
    v_and_b32 v51, s82, v249
    v_lshlrev_b32 v52, 16, v250
    v_and_b32 v53, s82, v250
    v_lshlrev_b32 v54, 16, v251
    v_and_b32 v55, s82, v251
    v_lshlrev_b32 v56, 16, v252
    v_and_b32 v57, s82, v252
    v_lshlrev_b32 v58, 16, v253
    v_and_b32 v59, s82, v253
    v_lshlrev_b32 v60, 16, v254
    v_and_b32 v61, s82, v254
    v_lshlrev_b32 v62, 16, v255
    v_and_b32 v63, s82, v255
    s_barrier
    ds_read_b128 v[96:99], v26 offset:0
    ds_read_b128 v[100:103], v26 offset:1024
    ds_read_b128 v[104:107], v26 offset:2048
    ds_read_b128 v[108:111], v26 offset:3072
    ds_read_b128 v[112:115], v26 offset:4096
    ds_read_b128 v[116:119], v26 offset:5120
    ds_read_b128 v[120:123], v26 offset:6144
    ds_read_b128 v[124:127], v26 offset:7168
    s_waitcnt lgkmcnt(0)
    v_pk_add_f32 v[128:129], v[128:129], v[96:97]
    v_pk_add_f32 v[130:131], v[130:131], v[98:99]
    v_pk_add_f32 v[144:145], v[144:145], v[112:113]
    v_pk_add_f32 v[146:147], v[146:147], v[114:115]
    v_pk_mul_f32 v[80:81], v[128:129], s[80:81]
    v_pk_mul_f32 v[82:83], v[130:131], s[80:81]
    v_pk_mul_f32 v[84:85], v[144:145], s[80:81]
    v_pk_mul_f32 v[86:87], v[146:147], s[80:81]
    v_exp_f32 v80, v80
    v_exp_f32 v81, v81
    v_exp_f32 v82, v82
    v_exp_f32 v83, v83
    v_exp_f32 v84, v84
    v_exp_f32 v85, v85
    v_exp_f32 v86, v86
    v_exp_f32 v87, v87
    v_pk_add_f32 v[80:81], v[80:81], 1.0 op_sel_hi:[1,0]
    v_pk_add_f32 v[82:83], v[82:83], 1.0 op_sel_hi:[1,0]
    v_pk_add_f32 v[84:85], v[84:85], 1.0 op_sel_hi:[1,0]
    v_pk_add_f32 v[86:87], v[86:87], 1.0 op_sel_hi:[1,0]
    v_rcp_f32 v80, v80
    v_rcp_f32 v81, v81
    v_rcp_f32 v82, v82
    v_rcp_f32 v83, v83
    v_rcp_f32 v84, v84
    v_rcp_f32 v85, v85
    v_rcp_f32 v86, v86
    v_rcp_f32 v87, v87
    v_pk_mul_f32 v[128:129], v[128:129], v[80:81]
    v_pk_mul_f32 v[130:131], v[130:131], v[82:83]
    v_pk_mul_f32 v[144:145], v[144:145], v[84:85]
    v_pk_mul_f32 v[146:147], v[146:147], v[86:87]
    v_pk_fma_f32 v[128:129], v[128:129], v[192:193], v[32:33]
    v_pk_fma_f32 v[130:131], v[130:131], v[194:195], v[34:35]
    v_pk_fma_f32 v[144:145], v[144:145], v[208:209], v[36:37]
    v_pk_fma_f32 v[146:147], v[146:147], v[210:211], v[38:39]
    v_cvt_pk_bf16_f32 v64, v128, v129
    v_cvt_pk_bf16_f32 v65, v130, v131
    v_cvt_pk_bf16_f32 v66, v144, v145
    v_cvt_pk_bf16_f32 v67, v146, v147
    s_nop 1
    v_permlane16_swap_b32 v64, v66
    v_permlane16_swap_b32 v65, v67
    buffer_store_dwordx4 v[64:67], v16, s[72:75], s84 offen sc0 sc1
    v_pk_add_f32 v[132:133], v[132:133], v[100:101]
    v_pk_add_f32 v[134:135], v[134:135], v[102:103]
    v_pk_add_f32 v[148:149], v[148:149], v[116:117]
    v_pk_add_f32 v[150:151], v[150:151], v[118:119]
    v_pk_mul_f32 v[80:81], v[132:133], s[80:81]
    v_pk_mul_f32 v[82:83], v[134:135], s[80:81]
    v_pk_mul_f32 v[84:85], v[148:149], s[80:81]
    v_pk_mul_f32 v[86:87], v[150:151], s[80:81]
    v_exp_f32 v80, v80
    v_exp_f32 v81, v81
    v_exp_f32 v82, v82
    v_exp_f32 v83, v83
    v_exp_f32 v84, v84
    v_exp_f32 v85, v85
    v_exp_f32 v86, v86
    v_exp_f32 v87, v87
    v_pk_add_f32 v[80:81], v[80:81], 1.0 op_sel_hi:[1,0]
    v_pk_add_f32 v[82:83], v[82:83], 1.0 op_sel_hi:[1,0]
    v_pk_add_f32 v[84:85], v[84:85], 1.0 op_sel_hi:[1,0]
    v_pk_add_f32 v[86:87], v[86:87], 1.0 op_sel_hi:[1,0]
    v_rcp_f32 v80, v80
    v_rcp_f32 v81, v81
    v_rcp_f32 v82, v82
    v_rcp_f32 v83, v83
    v_rcp_f32 v84, v84
    v_rcp_f32 v85, v85
    v_rcp_f32 v86, v86
    v_rcp_f32 v87, v87
    v_pk_mul_f32 v[132:133], v[132:133], v[80:81]
    v_pk_mul_f32 v[134:135], v[134:135], v[82:83]
    v_pk_mul_f32 v[148:149], v[148:149], v[84:85]
    v_pk_mul_f32 v[150:151], v[150:151], v[86:87]
    v_pk_fma_f32 v[132:133], v[132:133], v[196:197], v[40:41]
    v_pk_fma_f32 v[134:135], v[134:135], v[198:199], v[42:43]
    v_pk_fma_f32 v[148:149], v[148:149], v[212:213], v[44:45]
    v_pk_fma_f32 v[150:151], v[150:151], v[214:215], v[46:47]
    v_cvt_pk_bf16_f32 v68, v132, v133
    v_cvt_pk_bf16_f32 v69, v134, v135
    v_cvt_pk_bf16_f32 v70, v148, v149
    v_cvt_pk_bf16_f32 v71, v150, v151
    s_nop 1
    v_permlane16_swap_b32 v68, v70
    v_permlane16_swap_b32 v69, v71
    buffer_store_dwordx4 v[68:71], v16, s[72:75], s85 offen sc0 sc1
    v_pk_add_f32 v[136:137], v[136:137], v[104:105]
    v_pk_add_f32 v[138:139], v[138:139], v[106:107]
    v_pk_add_f32 v[152:153], v[152:153], v[120:121]
    v_pk_add_f32 v[154:155], v[154:155], v[122:123]
    v_pk_mul_f32 v[80:81], v[136:137], s[80:81]
    v_pk_mul_f32 v[82:83], v[138:139], s[80:81]
    v_pk_mul_f32 v[84:85], v[152:153], s[80:81]
    v_pk_mul_f32 v[86:87], v[154:155], s[80:81]
    v_exp_f32 v80, v80
    v_exp_f32 v81, v81
    v_exp_f32 v82, v82
    v_exp_f32 v83, v83
    v_exp_f32 v84, v84
    v_exp_f32 v85, v85
    v_exp_f32 v86, v86
    v_exp_f32 v87, v87
    v_pk_add_f32 v[80:81], v[80:81], 1.0 op_sel_hi:[1,0]
    v_pk_add_f32 v[82:83], v[82:83], 1.0 op_sel_hi:[1,0]
    v_pk_add_f32 v[84:85], v[84:85], 1.0 op_sel_hi:[1,0]
    v_pk_add_f32 v[86:87], v[86:87], 1.0 op_sel_hi:[1,0]
    v_rcp_f32 v80, v80
    v_rcp_f32 v81, v81
    v_rcp_f32 v82, v82
    v_rcp_f32 v83, v83
    v_rcp_f32 v84, v84
    v_rcp_f32 v85, v85
    v_rcp_f32 v86, v86
    v_rcp_f32 v87, v87
    v_pk_mul_f32 v[136:137], v[136:137], v[80:81]
    v_pk_mul_f32 v[138:139], v[138:139], v[82:83]
    v_pk_mul_f32 v[152:153], v[152:153], v[84:85]
    v_pk_mul_f32 v[154:155], v[154:155], v[86:87]
    v_pk_fma_f32 v[136:137], v[136:137], v[200:201], v[48:49]
    v_pk_fma_f32 v[138:139], v[138:139], v[202:203], v[50:51]
    v_pk_fma_f32 v[152:153], v[152:153], v[216:217], v[52:53]
    v_pk_fma_f32 v[154:155], v[154:155], v[218:219], v[54:55]
    v_cvt_pk_bf16_f32 v72, v136, v137
    v_cvt_pk_bf16_f32 v73, v138, v139
    v_cvt_pk_bf16_f32 v74, v152, v153
    v_cvt_pk_bf16_f32 v75, v154, v155
    s_nop 1
    v_permlane16_swap_b32 v72, v74
    v_permlane16_swap_b32 v73, v75
    buffer_store_dwordx4 v[72:75], v16, s[72:75], s86 offen sc0 sc1
    v_pk_add_f32 v[140:141], v[140:141], v[108:109]
    v_pk_add_f32 v[142:143], v[142:143], v[110:111]
    v_pk_add_f32 v[156:157], v[156:157], v[124:125]
    v_pk_add_f32 v[158:159], v[158:159], v[126:127]
    v_pk_mul_f32 v[80:81], v[140:141], s[80:81]
    v_pk_mul_f32 v[82:83], v[142:143], s[80:81]
    v_pk_mul_f32 v[84:85], v[156:157], s[80:81]
    v_pk_mul_f32 v[86:87], v[158:159], s[80:81]
    v_exp_f32 v80, v80
    v_exp_f32 v81, v81
    v_exp_f32 v82, v82
    v_exp_f32 v83, v83
    v_exp_f32 v84, v84
    v_exp_f32 v85, v85
    v_exp_f32 v86, v86
    v_exp_f32 v87, v87
    v_pk_add_f32 v[80:81], v[80:81], 1.0 op_sel_hi:[1,0]
    v_pk_add_f32 v[82:83], v[82:83], 1.0 op_sel_hi:[1,0]
    v_pk_add_f32 v[84:85], v[84:85], 1.0 op_sel_hi:[1,0]
    v_pk_add_f32 v[86:87], v[86:87], 1.0 op_sel_hi:[1,0]
    v_rcp_f32 v80, v80
    v_rcp_f32 v81, v81
    v_rcp_f32 v82, v82
    v_rcp_f32 v83, v83
    v_rcp_f32 v84, v84
    v_rcp_f32 v85, v85
    v_rcp_f32 v86, v86
    v_rcp_f32 v87, v87
    v_pk_mul_f32 v[140:141], v[140:141], v[80:81]
    v_pk_mul_f32 v[142:143], v[142:143], v[82:83]
    v_pk_mul_f32 v[156:157], v[156:157], v[84:85]
    v_pk_mul_f32 v[158:159], v[158:159], v[86:87]
    v_pk_fma_f32 v[140:141], v[140:141], v[204:205], v[56:57]
    v_pk_fma_f32 v[142:143], v[142:143], v[206:207], v[58:59]
    v_pk_fma_f32 v[156:157], v[156:157], v[220:221], v[60:61]
    v_pk_fma_f32 v[158:159], v[158:159], v[222:223], v[62:63]
    v_cvt_pk_bf16_f32 v76, v140, v141
    v_cvt_pk_bf16_f32 v77, v142, v143
    v_cvt_pk_bf16_f32 v78, v156, v157
    v_cvt_pk_bf16_f32 v79, v158, v159
    s_nop 1
    v_permlane16_swap_b32 v76, v78
    v_permlane16_swap_b32 v77, v79
    buffer_store_dwordx4 v[76:79], v16, s[72:75], s87 offen sc0 sc1
    s_cmp_lg_u32 s3, 0
    s_cbranch_scc1 L_nf_22
    s_cmp_lg_u32 s2, 0
    s_cbranch_scc1 L_nf_22
    v_mov_b32 v2, 0x58000
    v_mov_b32 v1, s38
    s_mov_b64 exec, 1
    buffer_store_dword v1, v2, s[40:43], 0 offen sc1
    s_mov_b64 exec, -1
    s_nop 3
L_nf_22:
    s_endpgm
L_loader:
    s_sub_u32 s12, s3, 4
    s_and_b32 s16, s12, 1
    s_lshl_b32 s16, s16, 2
    v_lshrrev_b32 v4, 4, v3
    v_add_u32 v4, s16, v4
    v_and_b32 v5, 7, v3
    v_xor_b32 v4, v4, v5
    v_lshlrev_b32 v4, 4, v4
    v_lshrrev_b32 v5, 3, v3
    s_lshl_b32 s16, s12, 3
    v_add_u32 v5, s16, v5
    v_lshlrev_b32 v30, 2, v3
    s_lshl_b32 s93, s12, 10
    s_lshl_b32 s16, s6, 11
    v_lshl_add_u32 v6, v5, 15, v4
    v_add_u32 v6, s16, v6
    v_add_u32 v8, 0x0, v6
    v_add_u32 v9, 0x100000, v6
    v_add_u32 v10, 0x200000, v6
    v_add_u32 v11, 0x300000, v6
    s_lshl_b32 s16, s12, 6
    v_add_u32 v6, s16, v3
    s_mul_i32 s17, s7, 448
    v_add_u32 v7, 0, v6
    v_mul_u32_u24 v28, 2341, v7
    v_lshrrev_b32 v28, 16, v28
    v_mul_u32_u24 v29, 28, v28
    v_sub_u32 v29, v7, v29
    v_bfe_u32 v31, v28, 3, 1
    v_lshlrev_b32 v31, 1, v31
    v_xor_b32 v29, v29, v31
    v_mul_u32_u24 v28, 7168, v28
    v_lshl_add_u32 v28, v29, 4, v28
    v_add_u32 v12, s17, v28
    v_add_u32 v7, 256, v6
    v_mul_u32_u24 v28, 2341, v7
    v_lshrrev_b32 v28, 16, v28
    v_mul_u32_u24 v29, 28, v28
    v_sub_u32 v29, v7, v29
    v_bfe_u32 v31, v28, 3, 1
    v_lshlrev_b32 v31, 1, v31
    v_xor_b32 v29, v29, v31
    v_mul_u32_u24 v28, 7168, v28
    v_lshl_add_u32 v28, v29, 4, v28
    v_add_u32 v13, s17, v28
    v_add_u32 v7, 512, v6
    v_mul_u32_u24 v28, 2341, v7
    v_lshrrev_b32 v28, 16, v28
    v_mul_u32_u24 v29, 28, v28
    v_sub_u32 v29, v7, v29
    v_bfe_u32 v31, v28, 3, 1
    v_lshlrev_b32 v31, 1, v31
    v_xor_b32 v29, v29, v31
    v_mul_u32_u24 v28, 7168, v28
    v_lshl_add_u32 v28, v29, 4, v28
    v_add_u32 v14, s17, v28
    v_add_u32 v7, 768, v6
    v_mul_u32_u24 v28, 2341, v7
    v_lshrrev_b32 v28, 16, v28
    v_mul_u32_u24 v29, 28, v28
    v_sub_u32 v29, v7, v29
    v_bfe_u32 v31, v28, 3, 1
    v_lshlrev_b32 v31, 1, v31
    v_xor_b32 v29, v29, v31
    v_mul_u32_u24 v28, 7168, v28
    v_lshl_add_u32 v28, v29, 4, v28
    v_add_u32 v15, s17, v28
    v_add_u32 v7, 1024, v6
    v_mul_u32_u24 v28, 2341, v7
    v_lshrrev_b32 v28, 16, v28
    v_mul_u32_u24 v29, 28, v28
    v_sub_u32 v29, v7, v29
    v_bfe_u32 v31, v28, 3, 1
    v_lshlrev_b32 v31, 1, v31
    v_xor_b32 v29, v29, v31
    v_mul_u32_u24 v28, 7168, v28
    v_lshl_add_u32 v28, v29, 4, v28
    v_add_u32 v16, s17, v28
    v_add_u32 v7, 1280, v6
    v_mul_u32_u24 v28, 2341, v7
    v_lshrrev_b32 v28, 16, v28
    v_mul_u32_u24 v29, 28, v28
    v_sub_u32 v29, v7, v29
    v_bfe_u32 v31, v28, 3, 1
    v_lshlrev_b32 v31, 1, v31
    v_xor_b32 v29, v29, v31
    v_mul_u32_u24 v28, 7168, v28
    v_lshl_add_u32 v28, v29, 4, v28
    v_add_u32 v17, s17, v28
    v_add_u32 v7, 1536, v6
    v_mul_u32_u24 v28, 2341, v7
    v_lshrrev_b32 v28, 16, v28
    v_mul_u32_u24 v29, 28, v28
    v_sub_u32 v29, v7, v29
    v_bfe_u32 v31, v28, 3, 1
    v_lshlrev_b32 v31, 1, v31
    v_xor_b32 v29, v29, v31
    v_mul_u32_u24 v28, 7168, v28
    v_lshl_add_u32 v28, v29, 4, v28
    v_add_u32 v18, s17, v28
    s_mov_b32 s14, s93
    s_add_u32 s92, s93, 135168
    s_mov_b32 s90, 0
    s_mov_b32 s91, 0
    v_and_b32 v6, 31, v3
    v_lshrrev_b32 v7, 5, v3
    v_mul_u32_u24 v7, 7168, v7
    v_lshl_add_u32 v7, v6, 4, v7
    s_xor_b32 s16, s6, 0
    s_lshl_b32 s16, s16, 6
    s_lshl_b32 s18, s12, 4
    s_add_u32 s16, s16, s18
    s_mul_i32 s16, s16, 7168
    s_add_u32 s16, s16, s17
    v_add_u32 v7, s16, v7
    v_cmp_gt_u32 vcc, 28, v6
    v_mov_b32 v28, 0x7f000000
    s_nop 0
    v_cndmask_b32 v7, v28, v7, vcc
    s_mov_b32 s16, 0
    buffer_load_dwordx4 v[128:131], v7, s[44:47], s16 offen
    s_mov_b32 s16, 14336
    buffer_load_dwordx4 v[132:135], v7, s[44:47], s16 offen
    s_mov_b32 s16, 28672
    buffer_load_dwordx4 v[136:139], v7, s[44:47], s16 offen
    s_mov_b32 s16, 43008
    buffer_load_dwordx4 v[140:143], v7, s[44:47], s16 offen
    s_mov_b32 s16, 57344
    buffer_load_dwordx4 v[144:147], v7, s[44:47], s16 offen
    s_mov_b32 s16, 71680
    buffer_load_dwordx4 v[148:151], v7, s[44:47], s16 offen
    s_mov_b32 s16, 86016
    buffer_load_dwordx4 v[152:155], v7, s[44:47], s16 offen
    s_mov_b32 s16, 100352
    buffer_load_dwordx4 v[156:159], v7, s[44:47], s16 offen
    s_barrier
    s_add_u32 m0, s14, 0
    s_nop 0
    buffer_load_dwordx4 v8, s[68:71], s90 offen lds
    s_add_u32 m0, s14, 4096
    s_nop 0
    buffer_load_dwordx4 v9, s[68:71], s90 offen lds
    s_add_u32 m0, s14, 8192
    s_nop 0
    buffer_load_dwordx4 v10, s[68:71], s90 offen lds
    s_add_u32 m0, s14, 12288
    s_nop 0
    buffer_load_dwordx4 v11, s[68:71], s90 offen lds
    s_add_u32 m0, s14, 16384
    s_nop 0
    buffer_load_dwordx4 v12, s[44:47], s91 offen lds
    s_add_u32 m0, s14, 20480
    s_nop 0
    buffer_load_dwordx4 v13, s[44:47], s91 offen lds
    s_add_u32 m0, s14, 24576
    s_nop 0
    buffer_load_dwordx4 v14, s[44:47], s91 offen lds
    s_add_u32 m0, s14, 28672
    s_nop 0
    buffer_load_dwordx4 v15, s[44:47], s91 offen lds
    s_add_u32 m0, s14, 32768
    s_nop 0
    buffer_load_dwordx4 v16, s[44:47], s91 offen lds
    s_add_u32 m0, s14, 36864
    s_nop 0
    buffer_load_dwordx4 v17, s[44:47], s91 offen lds
    s_add_u32 m0, s14, 40960
    s_nop 0
    buffer_load_dwordx4 v18, s[44:47], s91 offen lds
    s_add_u32 s90, s90, 128
    s_add_u32 s91, s91, 458752
    s_add_u32 s14, s14, 45056
    s_cmp_eq_u32 s14, s92
    s_cselect_b32 s14, s93, s14
    s_add_u32 m0, s14, 0
    s_nop 0
    buffer_load_dwordx4 v8, s[68:71], s90 offen lds
    s_add_u32 m0, s14, 4096
    s_nop 0
    buffer_load_dwordx4 v9, s[68:71], s90 offen lds
    s_add_u32 m0, s14, 8192
    s_nop 0
    buffer_load_dwordx4 v10, s[68:71], s90 offen lds
    s_add_u32 m0, s14, 12288
    s_nop 0
    buffer_load_dwordx4 v11, s[68:71], s90 offen lds
    s_add_u32 m0, s14, 16384
    s_nop 0
    buffer_load_dwordx4 v12, s[44:47], s91 offen lds
    s_add_u32 m0, s14, 20480
    s_nop 0
    buffer_load_dwordx4 v13, s[44:47], s91 offen lds
    s_add_u32 m0, s14, 24576
    s_nop 0
    buffer_load_dwordx4 v14, s[44:47], s91 offen lds
    s_add_u32 m0, s14, 28672
    s_nop 0
    buffer_load_dwordx4 v15, s[44:47], s91 offen lds
    s_add_u32 m0, s14, 32768
    s_nop 0
    buffer_load_dwordx4 v16, s[44:47], s91 offen lds
    s_add_u32 m0, s14, 36864
    s_nop 0
    buffer_load_dwordx4 v17, s[44:47], s91 offen lds
    s_add_u32 m0, s14, 40960
    s_nop 0
    buffer_load_dwordx4 v18, s[44:47], s91 offen lds
    s_add_u32 s90, s90, 128
    s_add_u32 s91, s91, 458752
    s_add_u32 s14, s14, 45056
    s_cmp_eq_u32 s14, s92
    s_cselect_b32 s14, s93, s14
    s_lshl_b32 s16, s2, 2
    s_add_u32 s16, s16, s12
    s_mul_i32 s17, s16, 7168
    v_lshlrev_b32 v124, 4, v3
    v_add_u32 v124, s17, v124
    v_add_u32 v125, 4096, v124
    s_lshr_b32 s18, s16, 1
    v_lshrrev_b32 v126, 5, v3
    v_lshlrev_b32 v126, 11, v126
    v_and_b32 v127, 31, v3
    v_lshl_add_u32 v126, v127, 4, v126
    s_lshl_b32 s19, s18, 12
    v_add_u32 v126, s19, v126
    v_lshrrev_b32 v127, 4, v3
    v_lshlrev_b32 v127, 12, v127
    v_and_b32 v2, 15, v3
    v_lshl_add_u32 v127, v2, 4, v127
    s_lshl_b32 s19, s18, 14
    v_add_u32 v127, s19, v127
    s_and_b32 s19, s12, 1
    v_lshrrev_b32 v122, 5, v3
    s_lshl_b32 s20, s18, 1
    v_add_u32 v122, s20, v122
    v_and_b32 v2, 3, v122
    v_lshrrev_b32 v122, 2, v122
    v_lshlrev_b32 v122, 9, v122
    v_lshl_add_u32 v122, v2, 18, v122
    v_and_b32 v2, 31, v3
    v_lshl_add_u32 v122, v2, 4, v122
    s_lshl_b32 s20, s19, 17
    s_add_u32 s20, s20, 0x200000
    v_add_u32 v122, s20, v122
    v_lshrrev_b32 v123, 4, v3
    s_lshl_b32 s20, s18, 2
    v_add_u32 v123, s20, v123
    v_and_b32 v2, 15, v123
    v_lshrrev_b32 v123, 4, v123
    v_lshlrev_b32 v123, 8, v123
    v_lshl_add_u32 v123, v2, 16, v123
    v_and_b32 v2, 15, v3
    v_lshl_add_u32 v123, v2, 4, v123
    s_lshl_b32 s20, s19, 15
    s_add_u32 s20, s20, 0x100000
    v_add_u32 v123, s20, v123
    v_lshlrev_b32 v2, 21, v3
    s_lshl_b32 s16, s12, 27
    v_add_u32 v2, s16, v2
    v_cmp_gt_u32 vcc, 0x2400000, v2
    s_and_saveexec_b64 s[96:97], vcc
    s_cbranch_execz L_notlb
    buffer_load_dword v244, v2, s[40:43], 0 offen sc1
L_notlb:
    s_mov_b64 exec, -1
    buffer_load_dword v244, v2, s[56:59], 0 offen sc1
    buffer_load_dword v244, v2, s[60:63], 0 offen sc1
    buffer_load_dword v244, v2, s[64:67], 0 offen sc1
    buffer_load_dword v244, v2, s[72:75], 0 offen sc1
    buffer_load_dword v244, v2, s[48:51], 0 offen sc1
    buffer_load_dword v244, v2, s[52:55], 0 offen sc1
    s_lshr_b32 s16, s8, 3
    s_lshl_b32 s17, s16, 17
    s_and_b32 s18, s8, 1
    s_lshl_b32 s19, s18, 15
    s_add_u32 s17, s17, s19
    s_add_u32 s17, s17, 0x400000
    v_lshl_add_u32 v6, v5, 9, v4
    v_add_u32 v6, s17, v6
    v_add_u32 v20, 0x0, v6
    v_add_u32 v21, 0x10000, v6
    v_add_u32 v22, 0x4000, v6
    v_add_u32 v23, 0x14000, v6
    s_and_b32 s17, s16, 3
    s_cmp_eq_u32 s16, 3
    s_cselect_b32 s17, 1, s17
    s_lshl_b32 s17, s17, 18
    s_bfe_u32 s19, s8, 0x20001
    s_lshl_b32 s19, s19, 15
    s_add_u32 s17, s17, s19
    s_add_u32 s17, s17, 0x200000
    v_lshl_add_u32 v6, v5, 9, v4
    v_add_u32 v6, s17, v6
    v_add_u32 v24, 0x0, v6
    v_add_u32 v25, 0x20000, v6
    v_add_u32 v26, 0x4000, v6
    v_add_u32 v27, 0x24000, v6
    s_lshl_b32 s16, s2, 15
    s_lshl_b32 s17, s12, 13
    s_add_u32 s16, s16, s17
    s_add_u32 s16, s16, 0x1c00000
    v_lshlrev_b32 v6, 4, v3
    v_add_u32 v6, s16, v6
    v_add_u32 v7, 4096, v6
    v_mov_b32 v240, -1
    v_mov_b32 v241, -1
    v_mov_b32 v242, -1
    v_mov_b32 v243, -1
    s_bitcmp1_b32 s3, 0
    s_cbranch_scc1 L_pf2_23
    buffer_load_dwordx4 v[232:235], v126, s[48:51], 0 offen
    s_branch L_pf3_24
L_pf2_23:
    buffer_load_dwordx4 v[232:235], v126, s[52:55], 0 offen
L_pf3_24:
    s_bitcmp1_b32 s3, 0
    s_cbranch_scc1 L_pf2_25
    buffer_load_dwordx4 v[236:239], v127, s[60:63], 0 offen
    s_branch L_pf3_26
L_pf2_25:
    buffer_load_dwordx4 v[236:239], v127, s[64:67], 0 offen
L_pf3_26:
    s_lshl_b32 s16, s2, 2
    s_add_u32 s16, s16, s12
    s_mul_i32 s16, s16, 7168
    s_add_u32 s30, s56, s16
    s_addc_u32 s31, s57, 0
    s_waitcnt vmcnt(24)
    v_lshlrev_b32 v160, 16, v128
    v_and_b32 v161, s82, v128
    v_lshlrev_b32 v162, 16, v129
    v_and_b32 v163, s82, v129
    v_lshlrev_b32 v164, 16, v130
    v_and_b32 v165, s82, v130
    v_lshlrev_b32 v166, 16, v131
    v_and_b32 v167, s82, v131
    v_lshlrev_b32 v168, 16, v132
    v_and_b32 v169, s82, v132
    v_lshlrev_b32 v170, 16, v133
    v_and_b32 v171, s82, v133
    v_lshlrev_b32 v172, 16, v134
    v_and_b32 v173, s82, v134
    v_lshlrev_b32 v174, 16, v135
    v_and_b32 v175, s82, v135
    v_pk_add_f32 v[160:161], v[160:161], v[168:169]
    v_pk_add_f32 v[162:163], v[162:163], v[170:171]
    v_pk_add_f32 v[164:165], v[164:165], v[172:173]
    v_pk_add_f32 v[166:167], v[166:167], v[174:175]
    v_lshlrev_b32 v168, 16, v136
    v_and_b32 v169, s82, v136
    v_lshlrev_b32 v170, 16, v137
    v_and_b32 v171, s82, v137
    v_lshlrev_b32 v172, 16, v138
    v_and_b32 v173, s82, v138
    v_lshlrev_b32 v174, 16, v139
    v_and_b32 v175, s82, v139
    v_pk_add_f32 v[160:161], v[160:161], v[168:169]
    v_pk_add_f32 v[162:163], v[162:163], v[170:171]
    v_pk_add_f32 v[164:165], v[164:165], v[172:173]
    v_pk_add_f32 v[166:167], v[166:167], v[174:175]
    v_lshlrev_b32 v168, 16, v140
    v_and_b32 v169, s82, v140
    v_lshlrev_b32 v170, 16, v141
    v_and_b32 v171, s82, v141
    v_lshlrev_b32 v172, 16, v142
    v_and_b32 v173, s82, v142
    v_lshlrev_b32 v174, 16, v143
    v_and_b32 v175, s82, v143
    v_pk_add_f32 v[160:161], v[160:161], v[168:169]
    v_pk_add_f32 v[162:163], v[162:163], v[170:171]
    v_pk_add_f32 v[164:165], v[164:165], v[172:173]
    v_pk_add_f32 v[166:167], v[166:167], v[174:175]
    v_lshlrev_b32 v168, 16, v144
    v_and_b32 v169, s82, v144
    v_lshlrev_b32 v170, 16, v145
    v_and_b32 v171, s82, v145
    v_lshlrev_b32 v172, 16, v146
    v_and_b32 v173, s82, v146
    v_lshlrev_b32 v174, 16, v147
    v_and_b32 v175, s82, v147
    v_pk_add_f32 v[160:161], v[160:161], v[168:169]
    v_pk_add_f32 v[162:163], v[162:163], v[170:171]
    v_pk_add_f32 v[164:165], v[164:165], v[172:173]
    v_pk_add_f32 v[166:167], v[166:167], v[174:175]
    v_lshlrev_b32 v168, 16, v148
    v_and_b32 v169, s82, v148
    v_lshlrev_b32 v170, 16, v149
    v_and_b32 v171, s82, v149
    v_lshlrev_b32 v172, 16, v150
    v_and_b32 v173, s82, v150
    v_lshlrev_b32 v174, 16, v151
    v_and_b32 v175, s82, v151
    v_pk_add_f32 v[160:161], v[160:161], v[168:169]
    v_pk_add_f32 v[162:163], v[162:163], v[170:171]
    v_pk_add_f32 v[164:165], v[164:165], v[172:173]
    v_pk_add_f32 v[166:167], v[166:167], v[174:175]
    v_lshlrev_b32 v168, 16, v152
    v_and_b32 v169, s82, v152
    v_lshlrev_b32 v170, 16, v153
    v_and_b32 v171, s82, v153
    v_lshlrev_b32 v172, 16, v154
    v_and_b32 v173, s82, v154
    v_lshlrev_b32 v174, 16, v155
    v_and_b32 v175, s82, v155
    v_pk_add_f32 v[160:161], v[160:161], v[168:169]
    v_pk_add_f32 v[162:163], v[162:163], v[170:171]
    v_pk_add_f32 v[164:165], v[164:165], v[172:173]
    v_pk_add_f32 v[166:167], v[166:167], v[174:175]
    v_lshlrev_b32 v168, 16, v156
    v_and_b32 v169, s82, v156
    v_lshlrev_b32 v170, 16, v157
    v_and_b32 v171, s82, v157
    v_lshlrev_b32 v172, 16, v158
    v_and_b32 v173, s82, v158
    v_lshlrev_b32 v174, 16, v159
    v_and_b32 v175, s82, v159
    v_pk_add_f32 v[160:161], v[160:161], v[168:169]
    v_pk_add_f32 v[162:163], v[162:163], v[170:171]
    v_pk_add_f32 v[164:165], v[164:165], v[172:173]
    v_pk_add_f32 v[166:167], v[166:167], v[174:175]
    v_lshrrev_b32 v28, 5, v3
    s_lshl_b32 s16, s12, 1
    v_add_u32 v28, s16, v28
    v_lshlrev_b32 v28, 10, v28
    v_and_b32 v29, 31, v3
    v_lshl_add_u32 v28, v29, 5, v28
    v_add_u32 v28, 135168, v28
    ds_write_b128 v28, v[160:163]
    ds_write_b128 v28, v[164:167] offset:16
    s_waitcnt lgkmcnt(0)
    s_lshl_b32 s16, s12, 8
    v_add_u32 v19, s16, v30
    v_add_u32 v29, 135168, v19
    s_lshl_b32 s16, s7, 14
    s_lshl_b32 s21, s6, 10
    s_add_u32 s21, s21, s16
    s_add_u32 s21, s21, 0x0
    s_add_u32 s38, s38, 0x9e3779b9
    v_lshrrev_b32 v31, 3, v3
    v_lshlrev_b32 v31, 7, v31
    v_and_b32 v28, 7, v3
    v_lshl_add_u32 v31, v28, 2, v31
    v_add_u32 v31, 0x52000, v31
    s_waitcnt vmcnt(13)
    s_barrier
    s_add_u32 m0, s14, 0
    s_nop 0
    buffer_load_dwordx4 v8, s[68:71], s90 offen lds
    s_add_u32 m0, s14, 4096
    s_nop 0
    buffer_load_dwordx4 v9, s[68:71], s90 offen lds
    s_add_u32 m0, s14, 8192
    s_nop 0
    buffer_load_dwordx4 v10, s[68:71], s90 offen lds
    s_add_u32 m0, s14, 12288
    s_nop 0
    buffer_load_dwordx4 v11, s[68:71], s90 offen lds
    s_add_u32 m0, s14, 16384
    s_nop 0
    buffer_load_dwordx4 v12, s[44:47], s91 offen lds
    s_add_u32 m0, s14, 20480
    s_nop 0
    buffer_load_dwordx4 v13, s[44:47], s91 offen lds
    s_add_u32 m0, s14, 24576
    s_nop 0
    buffer_load_dwordx4 v14, s[44:47], s91 offen lds
    s_add_u32 m0, s14, 28672
    s_nop 0
    buffer_load_dwordx4 v15, s[44:47], s91 offen lds
    s_add_u32 m0, s14, 32768
    s_nop 0
    buffer_load_dwordx4 v16, s[44:47], s91 offen lds
    s_add_u32 m0, s14, 36864
    s_nop 0
    buffer_load_dwordx4 v17, s[44:47], s91 offen lds
    s_add_u32 m0, s14, 40960
    s_nop 0
    buffer_load_dwordx4 v18, s[44:47], s91 offen lds
    s_add_u32 s90, s90, 128
    s_add_u32 s91, s91, 458752
    s_add_u32 s14, s14, 45056
    s_cmp_eq_u32 s14, s92
    s_cselect_b32 s14, s93, s14
    s_waitcnt vmcnt(13)
    s_barrier
    s_add_u32 m0, s14, 0
    s_nop 0
    buffer_load_dwordx4 v8, s[68:71], s90 offen lds
    s_add_u32 m0, s14, 4096
    s_nop 0
    buffer_load_dwordx4 v9, s[68:71], s90 offen lds
    s_add_u32 m0, s14, 8192
    s_nop 0
    buffer_load_dwordx4 v10, s[68:71], s90 offen lds
    s_add_u32 m0, s14, 12288
    s_nop 0
    buffer_load_dwordx4 v11, s[68:71], s90 offen lds
    s_add_u32 m0, s14, 16384
    s_nop 0
    buffer_load_dwordx4 v12, s[44:47], s91 offen lds
    s_add_u32 m0, s14, 20480
    s_nop 0
    buffer_load_dwordx4 v13, s[44:47], s91 offen lds
    s_add_u32 m0, s14, 24576
    s_nop 0
    buffer_load_dwordx4 v14, s[44:47], s91 offen lds
    s_add_u32 m0, s14, 28672
    s_nop 0
    buffer_load_dwordx4 v15, s[44:47], s91 offen lds
    s_add_u32 m0, s14, 32768
    s_nop 0
    buffer_load_dwordx4 v16, s[44:47], s91 offen lds
    s_add_u32 m0, s14, 36864
    s_nop 0
    buffer_load_dwordx4 v17, s[44:47], s91 offen lds
    s_add_u32 m0, s14, 40960
    s_nop 0
    buffer_load_dwordx4 v18, s[44:47], s91 offen lds
    s_add_u32 s90, s90, 128
    s_add_u32 s91, s91, 458752
    s_add_u32 s14, s14, 45056
    s_cmp_eq_u32 s14, s92
    s_cselect_b32 s14, s93, s14
    ds_read2st64_b32 v[128:129], v29 offset0:0 offset1:4
    ds_read2st64_b32 v[130:131], v29 offset0:8 offset1:12
    ds_read2st64_b32 v[132:133], v29 offset0:16 offset1:20
    ds_read2st64_b32 v[134:135], v29 offset0:24 offset1:28
    s_waitcnt lgkmcnt(0)
    v_pk_add_f32 v[128:129], v[128:129], v[130:131]
    v_pk_add_f32 v[132:133], v[132:133], v[134:135]
    v_pk_add_f32 v[128:129], v[128:129], v[132:133]
    v_add_f32 v128, v128, v129
    buffer_store_dword v128, v19, s[40:43], s21 offen sc1
    s_waitcnt vmcnt(12)
    s_barrier
    s_add_u32 m0, s14, 0
    s_nop 0
    buffer_load_dwordx4 v8, s[68:71], s90 offen lds
    s_add_u32 m0, s14, 4096
    s_nop 0
    buffer_load_dwordx4 v9, s[68:71], s90 offen lds
    s_add_u32 m0, s14, 8192
    s_nop 0
    buffer_load_dwordx4 v10, s[68:71], s90 offen lds
    s_add_u32 m0, s14, 12288
    s_nop 0
    buffer_load_dwordx4 v11, s[68:71], s90 offen lds
    s_add_u32 m0, s14, 16384
    s_nop 0
    buffer_load_dwordx4 v12, s[44:47], s91 offen lds
    s_add_u32 m0, s14, 20480
    s_nop 0
    buffer_load_dwordx4 v13, s[44:47], s91 offen lds
    s_add_u32 m0, s14, 24576
    s_nop 0
    buffer_load_dwordx4 v14, s[44:47], s91 offen lds
    s_add_u32 m0, s14, 28672
    s_nop 0
    buffer_load_dwordx4 v15, s[44:47], s91 offen lds
    s_add_u32 m0, s14, 32768
    s_nop 0
    buffer_load_dwordx4 v16, s[44:47], s91 offen lds
    s_add_u32 m0, s14, 36864
    s_nop 0
    buffer_load_dwordx4 v17, s[44:47], s91 offen lds
    s_add_u32 m0, s14, 40960
    s_nop 0
    buffer_load_dwordx4 v18, s[44:47], s91 offen lds
    s_add_u32 s90, s90, 128
    s_add_u32 s91, s91, 458752
    s_add_u32 s14, s14, 45056
    s_cmp_eq_u32 s14, s92
    s_cselect_b32 s14, s93, s14
    s_load_dword s29, s[30:31], 0
    s_load_dword s29, s[30:31], 64
    s_load_dword s29, s[30:31], 128
    s_load_dword s29, s[30:31], 192
    s_load_dword s29, s[30:31], 256
    s_load_dword s29, s[30:31], 320
    s_load_dword s29, s[30:31], 384
    s_load_dword s29, s[30:31], 448
    s_load_dword s29, s[30:31], 512
    s_load_dword s29, s[30:31], 576
    s_load_dword s29, s[30:31], 640
    s_waitcnt vmcnt(12)
    s_barrier
    s_add_u32 m0, s14, 0
    s_nop 0
    buffer_load_dwordx4 v8, s[68:71], s90 offen lds
    s_add_u32 m0, s14, 4096
    s_nop 0
    buffer_load_dwordx4 v9, s[68:71], s90 offen lds
    s_add_u32 m0, s14, 8192
    s_nop 0
    buffer_load_dwordx4 v10, s[68:71], s90 offen lds
    s_add_u32 m0, s14, 12288
    s_nop 0
    buffer_load_dwordx4 v11, s[68:71], s90 offen lds
    s_add_u32 m0, s14, 16384
    s_nop 0
    buffer_load_dwordx4 v12, s[44:47], s91 offen lds
    s_add_u32 m0, s14, 20480
    s_nop 0
    buffer_load_dwordx4 v13, s[44:47], s91 offen lds
    s_add_u32 m0, s14, 24576
    s_nop 0
    buffer_load_dwordx4 v14, s[44:47], s91 offen lds
    s_add_u32 m0, s14, 28672
    s_nop 0
    buffer_load_dwordx4 v15, s[44:47], s91 offen lds
    s_add_u32 m0, s14, 32768
    s_nop 0
    buffer_load_dwordx4 v16, s[44:47], s91 offen lds
    s_add_u32 m0, s14, 36864
    s_nop 0
    buffer_load_dwordx4 v17, s[44:47], s91 offen lds
    s_add_u32 m0, s14, 40960
    s_nop 0
    buffer_load_dwordx4 v18, s[44:47], s91 offen lds
    s_add_u32 s90, s90, 128
    s_add_u32 s91, s91, 458752
    s_add_u32 s14, s14, 45056
    s_cmp_eq_u32 s14, s92
    s_cselect_b32 s14, s93, s14
    buffer_store_dwordx4 v[232:235], v122, s[40:43], 0 offen sc1
    buffer_store_dwordx4 v[236:239], v123, s[40:43], 0 offen sc1
    s_load_dword s29, s[30:31], 704
    s_load_dword s29, s[30:31], 768
    s_load_dword s29, s[30:31], 832
    s_load_dword s29, s[30:31], 896
    s_load_dword s29, s[30:31], 960
    s_load_dword s29, s[30:31], 1024
    s_load_dword s29, s[30:31], 1088
    s_load_dword s29, s[30:31], 1152
    s_load_dword s29, s[30:31], 1216
    s_load_dword s29, s[30:31], 1280
    s_load_dword s29, s[30:31], 1344
    s_waitcnt vmcnt(13)
    s_barrier
    s_add_u32 m0, s14, 0
    s_nop 0
    buffer_load_dwordx4 v8, s[68:71], s90 offen lds
    s_add_u32 m0, s14, 4096
    s_nop 0
    buffer_load_dwordx4 v9, s[68:71], s90 offen lds
    s_add_u32 m0, s14, 8192
    s_nop 0
    buffer_load_dwordx4 v10, s[68:71], s90 offen lds
    s_add_u32 m0, s14, 12288
    s_nop 0
    buffer_load_dwordx4 v11, s[68:71], s90 offen lds
    s_add_u32 m0, s14, 16384
    s_nop 0
    buffer_load_dwordx4 v12, s[44:47], s91 offen lds
    s_add_u32 m0, s14, 20480
    s_nop 0
    buffer_load_dwordx4 v13, s[44:47], s91 offen lds
    s_add_u32 m0, s14, 24576
    s_nop 0
    buffer_load_dwordx4 v14, s[44:47], s91 offen lds
    s_add_u32 m0, s14, 28672
    s_nop 0
    buffer_load_dwordx4 v15, s[44:47], s91 offen lds
    s_add_u32 m0, s14, 32768
    s_nop 0
    buffer_load_dwordx4 v16, s[44:47], s91 offen lds
    s_add_u32 m0, s14, 36864
    s_nop 0
    buffer_load_dwordx4 v17, s[44:47], s91 offen lds
    s_add_u32 m0, s14, 40960
    s_nop 0
    buffer_load_dwordx4 v18, s[44:47], s91 offen lds
    s_add_u32 s90, s90, 128
    s_add_u32 s91, s91, 458752
    s_add_u32 s14, s14, 45056
    s_cmp_eq_u32 s14, s92
    s_cselect_b32 s14, s93, s14
    s_load_dword s29, s[30:31], 1408
    s_load_dword s29, s[30:31], 1472
    s_load_dword s29, s[30:31], 1536
    s_load_dword s29, s[30:31], 1600
    s_load_dword s29, s[30:31], 1664
    s_load_dword s29, s[30:31], 1728
    s_load_dword s29, s[30:31], 1792
    s_load_dword s29, s[30:31], 1856
    s_load_dword s29, s[30:31], 1920
    s_load_dword s29, s[30:31], 1984
    s_load_dword s29, s[30:31], 2048
    s_waitcnt vmcnt(13)
    s_barrier
    s_add_u32 m0, s14, 0
    s_nop 0
    buffer_load_dwordx4 v8, s[68:71], s90 offen lds
    s_add_u32 m0, s14, 4096
    s_nop 0
    buffer_load_dwordx4 v9, s[68:71], s90 offen lds
    s_add_u32 m0, s14, 8192
    s_nop 0
    buffer_load_dwordx4 v10, s[68:71], s90 offen lds
    s_add_u32 m0, s14, 12288
    s_nop 0
    buffer_load_dwordx4 v11, s[68:71], s90 offen lds
    s_add_u32 m0, s14, 16384
    s_nop 0
    buffer_load_dwordx4 v12, s[44:47], s91 offen lds
    s_add_u32 m0, s14, 20480
    s_nop 0
    buffer_load_dwordx4 v13, s[44:47], s91 offen lds
    s_add_u32 m0, s14, 24576
    s_nop 0
    buffer_load_dwordx4 v14, s[44:47], s91 offen lds
    s_add_u32 m0, s14, 28672
    s_nop 0
    buffer_load_dwordx4 v15, s[44:47], s91 offen lds
    s_add_u32 m0, s14, 32768
    s_nop 0
    buffer_load_dwordx4 v16, s[44:47], s91 offen lds
    s_add_u32 m0, s14, 36864
    s_nop 0
    buffer_load_dwordx4 v17, s[44:47], s91 offen lds
    s_add_u32 m0, s14, 40960
    s_nop 0
    buffer_load_dwordx4 v18, s[44:47], s91 offen lds
    s_add_u32 s90, s90, 128
    s_add_u32 s91, s91, 458752
    s_add_u32 s14, s14, 45056
    s_cmp_eq_u32 s14, s92
    s_cselect_b32 s14, s93, s14
    s_load_dword s29, s[30:31], 2112
    s_load_dword s29, s[30:31], 2176
    s_load_dword s29, s[30:31], 2240
    s_load_dword s29, s[30:31], 2304
    s_load_dword s29, s[30:31], 2368
    s_load_dword s29, s[30:31], 2432
    s_load_dword s29, s[30:31], 2496
    s_load_dword s29, s[30:31], 2560
    s_load_dword s29, s[30:31], 2624
    s_load_dword s29, s[30:31], 2688
    s_load_dword s29, s[30:31], 2752
    s_waitcnt vmcnt(11)
    s_barrier
    s_add_u32 m0, s14, 0
    s_nop 0
    buffer_load_dwordx4 v8, s[68:71], s90 offen lds
    s_add_u32 m0, s14, 4096
    s_nop 0
    buffer_load_dwordx4 v9, s[68:71], s90 offen lds
    s_add_u32 m0, s14, 8192
    s_nop 0
    buffer_load_dwordx4 v10, s[68:71], s90 offen lds
    s_add_u32 m0, s14, 12288
    s_nop 0
    buffer_load_dwordx4 v11, s[68:71], s90 offen lds
    s_add_u32 m0, s14, 16384
    s_nop 0
    buffer_load_dwordx4 v12, s[44:47], s91 offen lds
    s_add_u32 m0, s14, 20480
    s_nop 0
    buffer_load_dwordx4 v13, s[44:47], s91 offen lds
    s_add_u32 m0, s14, 24576
    s_nop 0
    buffer_load_dwordx4 v14, s[44:47], s91 offen lds
    s_add_u32 m0, s14, 28672
    s_nop 0
    buffer_load_dwordx4 v15, s[44:47], s91 offen lds
    s_add_u32 m0, s14, 32768
    s_nop 0
    buffer_load_dwordx4 v16, s[44:47], s91 offen lds
    s_add_u32 m0, s14, 36864
    s_nop 0
    buffer_load_dwordx4 v17, s[44:47], s91 offen lds
    s_add_u32 m0, s14, 40960
    s_nop 0
    buffer_load_dwordx4 v18, s[44:47], s91 offen lds
    s_add_u32 s90, s90, 128
    s_add_u32 s91, s91, 458752
    s_add_u32 s14, s14, 45056
    s_cmp_eq_u32 s14, s92
    s_cselect_b32 s14, s93, s14
    s_cmp_lg_u32 s3, 4
    s_cbranch_scc1 L_nf_27
    s_lshr_b32 s96, s2, 3
    s_lshl_b32 s96, s96, 7
    s_and_b32 s97, s2, 7
    s_lshl_b32 s97, s97, 2
    s_add_u32 s96, s96, s97
    s_add_u32 s96, s96, 0x52000
    v_mov_b32 v2, s96
    v_mov_b32 v1, s38
    s_mov_b64 exec, 1
    buffer_store_dword v1, v2, s[40:43], 0 offen sc1
    s_mov_b64 exec, -1
    s_nop 3
L_nf_27:
    s_load_dword s29, s[30:31], 2816
    s_load_dword s29, s[30:31], 2880
    s_load_dword s29, s[30:31], 2944
    s_load_dword s29, s[30:31], 3008
    s_load_dword s29, s[30:31], 3072
    s_load_dword s29, s[30:31], 3136
    s_load_dword s29, s[30:31], 3200
    s_load_dword s29, s[30:31], 3264
    s_load_dword s29, s[30:31], 3328
    s_load_dword s29, s[30:31], 3392
    s_load_dword s29, s[30:31], 3456
    s_waitcnt vmcnt(11)
    s_barrier
    s_add_u32 m0, s14, 0
    s_nop 0
    buffer_load_dwordx4 v8, s[68:71], s90 offen lds
    s_add_u32 m0, s14, 4096
    s_nop 0
    buffer_load_dwordx4 v9, s[68:71], s90 offen lds
    s_add_u32 m0, s14, 8192
    s_nop 0
    buffer_load_dwordx4 v10, s[68:71], s90 offen lds
    s_add_u32 m0, s14, 12288
    s_nop 0
    buffer_load_dwordx4 v11, s[68:71], s90 offen lds
    s_add_u32 m0, s14, 16384
    s_nop 0
    buffer_load_dwordx4 v12, s[44:47], s91 offen lds
    s_add_u32 m0, s14, 20480
    s_nop 0
    buffer_load_dwordx4 v13, s[44:47], s91 offen lds
    s_add_u32 m0, s14, 24576
    s_nop 0
    buffer_load_dwordx4 v14, s[44:47], s91 offen lds
    s_add_u32 m0, s14, 28672
    s_nop 0
    buffer_load_dwordx4 v15, s[44:47], s91 offen lds
    s_add_u32 m0, s14, 32768
    s_nop 0
    buffer_load_dwordx4 v16, s[44:47], s91 offen lds
    s_add_u32 m0, s14, 36864
    s_nop 0
    buffer_load_dwordx4 v17, s[44:47], s91 offen lds
    s_add_u32 m0, s14, 40960
    s_nop 0
    buffer_load_dwordx4 v18, s[44:47], s91 offen lds
    s_add_u32 s90, s90, 128
    s_add_u32 s91, s91, 458752
    s_add_u32 s14, s14, 45056
    s_cmp_eq_u32 s14, s92
    s_cselect_b32 s14, s93, s14
    s_load_dword s29, s[30:31], 3520
    s_load_dword s29, s[30:31], 3584
    s_load_dword s29, s[30:31], 3648
    s_load_dword s29, s[30:31], 3712
    s_load_dword s29, s[30:31], 3776
    s_load_dword s29, s[30:31], 3840
    s_load_dword s29, s[30:31], 3904
    s_load_dword s29, s[30:31], 3968
    s_load_dword s29, s[30:31], 4032
    s_load_dword s29, s[30:31], 4096
    s_load_dword s29, s[30:31], 4160
    s_waitcnt vmcnt(11)
    s_barrier
    s_add_u32 m0, s14, 0
    s_nop 0
    buffer_load_dwordx4 v8, s[68:71], s90 offen lds
    s_add_u32 m0, s14, 4096
    s_nop 0
    buffer_load_dwordx4 v9, s[68:71], s90 offen lds
    s_add_u32 m0, s14, 8192
    s_nop 0
    buffer_load_dwordx4 v10, s[68:71], s90 offen lds
    s_add_u32 m0, s14, 12288
    s_nop 0
    buffer_load_dwordx4 v11, s[68:71], s90 offen lds
    s_add_u32 m0, s14, 16384
    s_nop 0
    buffer_load_dwordx4 v12, s[44:47], s91 offen lds
    s_add_u32 m0, s14, 20480
    s_nop 0
    buffer_load_dwordx4 v13, s[44:47], s91 offen lds
    s_add_u32 m0, s14, 24576
    s_nop 0
    buffer_load_dwordx4 v14, s[44:47], s91 offen lds
    s_add_u32 m0, s14, 28672
    s_nop 0
    buffer_load_dwordx4 v15, s[44:47], s91 offen lds
    s_add_u32 m0, s14, 32768
    s_nop 0
    buffer_load_dwordx4 v16, s[44:47], s91 offen lds
    s_add_u32 m0, s14, 36864
    s_nop 0
    buffer_load_dwordx4 v17, s[44:47], s91 offen lds
    s_add_u32 m0, s14, 40960
    s_nop 0
    buffer_load_dwordx4 v18, s[44:47], s91 offen lds
    s_add_u32 s90, s90, 128
    s_add_u32 s91, s91, 458752
    s_add_u32 s14, s14, 45056
    s_cmp_eq_u32 s14, s92
    s_cselect_b32 s14, s93, s14
    s_load_dword s29, s[30:31], 4224
    s_load_dword s29, s[30:31], 4288
    s_load_dword s29, s[30:31], 4352
    s_load_dword s29, s[30:31], 4416
    s_load_dword s29, s[30:31], 4480
    s_load_dword s29, s[30:31], 4544
    s_load_dword s29, s[30:31], 4608
    s_load_dword s29, s[30:31], 4672
    s_load_dword s29, s[30:31], 4736
    s_load_dword s29, s[30:31], 4800
    s_load_dword s29, s[30:31], 4864
    s_waitcnt vmcnt(11)
    s_barrier
    s_add_u32 m0, s14, 0
    s_nop 0
    buffer_load_dwordx4 v8, s[68:71], s90 offen lds
    s_add_u32 m0, s14, 4096
    s_nop 0
    buffer_load_dwordx4 v9, s[68:71], s90 offen lds
    s_add_u32 m0, s14, 8192
    s_nop 0
    buffer_load_dwordx4 v10, s[68:71], s90 offen lds
    s_add_u32 m0, s14, 12288
    s_nop 0
    buffer_load_dwordx4 v11, s[68:71], s90 offen lds
    s_add_u32 m0, s14, 16384
    s_nop 0
    buffer_load_dwordx4 v12, s[44:47], s91 offen lds
    s_add_u32 m0, s14, 20480
    s_nop 0
    buffer_load_dwordx4 v13, s[44:47], s91 offen lds
    s_add_u32 m0, s14, 24576
    s_nop 0
    buffer_load_dwordx4 v14, s[44:47], s91 offen lds
    s_add_u32 m0, s14, 28672
    s_nop 0
    buffer_load_dwordx4 v15, s[44:47], s91 offen lds
    s_add_u32 m0, s14, 32768
    s_nop 0
    buffer_load_dwordx4 v16, s[44:47], s91 offen lds
    s_add_u32 m0, s14, 36864
    s_nop 0
    buffer_load_dwordx4 v17, s[44:47], s91 offen lds
    s_add_u32 m0, s14, 40960
    s_nop 0
    buffer_load_dwordx4 v18, s[44:47], s91 offen lds
    s_add_u32 s90, s90, 128
    s_add_u32 s91, s91, 458752
    s_add_u32 s14, s14, 45056
    s_cmp_eq_u32 s14, s92
    s_cselect_b32 s14, s93, s14
    s_load_dword s29, s[30:31], 4928
    s_load_dword s29, s[30:31], 4992
    s_load_dword s29, s[30:31], 5056
    s_load_dword s29, s[30:31], 5120
    s_load_dword s29, s[30:31], 5184
    s_load_dword s29, s[30:31], 5248
    s_load_dword s29, s[30:31], 5312
    s_load_dword s29, s[30:31], 5376
    s_load_dword s29, s[30:31], 5440
    s_load_dword s29, s[30:31], 5504
    s_load_dword s29, s[30:31], 5568
    s_waitcnt vmcnt(11)
    s_barrier
    s_add_u32 m0, s14, 0
    s_nop 0
    buffer_load_dwordx4 v8, s[68:71], s90 offen lds
    s_add_u32 m0, s14, 4096
    s_nop 0
    buffer_load_dwordx4 v9, s[68:71], s90 offen lds
    s_add_u32 m0, s14, 8192
    s_nop 0
    buffer_load_dwordx4 v10, s[68:71], s90 offen lds
    s_add_u32 m0, s14, 12288
    s_nop 0
    buffer_load_dwordx4 v11, s[68:71], s90 offen lds
    s_add_u32 m0, s14, 16384
    s_nop 0
    buffer_load_dwordx4 v12, s[44:47], s91 offen lds
    s_add_u32 m0, s14, 20480
    s_nop 0
    buffer_load_dwordx4 v13, s[44:47], s91 offen lds
    s_add_u32 m0, s14, 24576
    s_nop 0
    buffer_load_dwordx4 v14, s[44:47], s91 offen lds
    s_add_u32 m0, s14, 28672
    s_nop 0
    buffer_load_dwordx4 v15, s[44:47], s91 offen lds
    s_add_u32 m0, s14, 32768
    s_nop 0
    buffer_load_dwordx4 v16, s[44:47], s91 offen lds
    s_add_u32 m0, s14, 36864
    s_nop 0
    buffer_load_dwordx4 v17, s[44:47], s91 offen lds
    s_add_u32 m0, s14, 40960
    s_nop 0
    buffer_load_dwordx4 v18, s[44:47], s91 offen lds
    s_add_u32 s90, s90, 128
    s_add_u32 s91, s91, 458752
    s_add_u32 s14, s14, 45056
    s_cmp_eq_u32 s14, s92
    s_cselect_b32 s14, s93, s14
    buffer_load_dword v148, v31, s[40:43], 0 offen offset:0 sc1
    buffer_load_dword v149, v31, s[40:43], 0 offen offset:1024 sc1
    buffer_load_dword v150, v31, s[40:43], 0 offen offset:2048 sc1
    buffer_load_dword v151, v31, s[40:43], 0 offen offset:3072 sc1
    s_load_dword s29, s[30:31], 5632
    s_load_dword s29, s[30:31], 5696
    s_load_dword s29, s[30:31], 5760
    s_load_dword s29, s[30:31], 5824
    s_load_dword s29, s[30:31], 5888
    s_load_dword s29, s[30:31], 5952
    s_load_dword s29, s[30:31], 6016
    s_load_dword s29, s[30:31], 6080
    s_load_dword s29, s[30:31], 6144
    s_load_dword s29, s[30:31], 6208
    s_load_dword s29, s[30:31], 6272
    s_waitcnt vmcnt(15)
    s_barrier
    s_add_u32 m0, s14, 0
    s_nop 0
    buffer_load_dwordx4 v8, s[68:71], s90 offen lds
    s_add_u32 m0, s14, 4096
    s_nop 0
    buffer_load_dwordx4 v9, s[68:71], s90 offen lds
    s_add_u32 m0, s14, 8192
    s_nop 0
    buffer_load_dwordx4 v10, s[68:71], s90 offen lds
    s_add_u32 m0, s14, 12288
    s_nop 0
    buffer_load_dwordx4 v11, s[68:71], s90 offen lds
    s_add_u32 m0, s14, 16384
    s_nop 0
    buffer_load_dwordx4 v12, s[44:47], s91 offen lds
    s_add_u32 m0, s14, 20480
    s_nop 0
    buffer_load_dwordx4 v13, s[44:47], s91 offen lds
    s_add_u32 m0, s14, 24576
    s_nop 0
    buffer_load_dwordx4 v14, s[44:47], s91 offen lds
    s_add_u32 m0, s14, 28672
    s_nop 0
    buffer_load_dwordx4 v15, s[44:47], s91 offen lds
    s_add_u32 m0, s14, 32768
    s_nop 0
    buffer_load_dwordx4 v16, s[44:47], s91 offen lds
    s_add_u32 m0, s14, 36864
    s_nop 0
    buffer_load_dwordx4 v17, s[44:47], s91 offen lds
    s_add_u32 m0, s14, 40960
    s_nop 0
    buffer_load_dwordx4 v18, s[44:47], s91 offen lds
    s_add_u32 s90, s90, 128
    s_add_u32 s91, s91, 458752
    s_add_u32 s14, s14, 45056
    s_cmp_eq_u32 s14, s92
    s_cselect_b32 s14, s93, s14
    s_load_dword s29, s[30:31], 6336
    s_load_dword s29, s[30:31], 6400
    s_load_dword s29, s[30:31], 6464
    s_load_dword s29, s[30:31], 6528
    s_load_dword s29, s[30:31], 6592
    s_load_dword s29, s[30:31], 6656
    s_load_dword s29, s[30:31], 6720
    s_load_dword s29, s[30:31], 6784
    s_load_dword s29, s[30:31], 6848
    s_load_dword s29, s[30:31], 6912
    s_load_dword s29, s[30:31], 6976
    s_waitcnt vmcnt(11)
    s_mov_b32 s23, 0
    s_branch L_pchk_30
L_poll_28:
    buffer_load_dword v148, v31, s[40:43], 0 offen offset:0 sc1
    buffer_load_dword v149, v31, s[40:43], 0 offen offset:1024 sc1
    buffer_load_dword v150, v31, s[40:43], 0 offen offset:2048 sc1
    buffer_load_dword v151, v31, s[40:43], 0 offen offset:3072 sc1
    s_waitcnt vmcnt(0)
L_pchk_30:
    s_add_u32 s23, s23, 1
    v_cmp_ne_u32 vcc, s38, v148
    v_cmp_ne_u32 s[96:97], s38, v149
    s_or_b64 vcc, vcc, s[96:97]
    v_cmp_ne_u32 s[96:97], s38, v150
    s_or_b64 vcc, vcc, s[96:97]
    v_cmp_ne_u32 s[96:97], s38, v151
    s_or_b64 vcc, vcc, s[96:97]
    s_nop 0
    s_and_b64 vcc, vcc, exec
    s_cbranch_scc0 L_pdone_29
    s_sleep 4
    s_cmp_lt_u32 s23, 200000
    s_cbranch_scc1 L_poll_28
L_pdone_29:
    s_barrier
    s_add_u32 m0, s14, 0
    s_nop 0
    buffer_load_dwordx4 v8, s[68:71], s90 offen lds
    s_add_u32 m0, s14, 4096
    s_nop 0
    buffer_load_dwordx4 v9, s[68:71], s90 offen lds
    s_add_u32 m0, s14, 8192
    s_nop 0
    buffer_load_dwordx4 v10, s[68:71], s90 offen lds
    s_add_u32 m0, s14, 12288
    s_nop 0
    buffer_load_dwordx4 v11, s[68:71], s90 offen lds
    s_add_u32 m0, s14, 16384
    s_nop 0
    buffer_load_dwordx4 v12, s[44:47], s91 offen lds
    s_add_u32 m0, s14, 20480
    s_nop 0
    buffer_load_dwordx4 v13, s[44:47], s91 offen lds
    s_add_u32 m0, s14, 24576
    s_nop 0
    buffer_load_dwordx4 v14, s[44:47], s91 offen lds
    s_add_u32 m0, s14, 28672
    s_nop 0
    buffer_load_dwordx4 v15, s[44:47], s91 offen lds
    s_add_u32 m0, s14, 32768
    s_nop 0
    buffer_load_dwordx4 v16, s[44:47], s91 offen lds
    s_add_u32 m0, s14, 36864
    s_nop 0
    buffer_load_dwordx4 v17, s[44:47], s91 offen lds
    s_add_u32 m0, s14, 40960
    s_nop 0
    buffer_load_dwordx4 v18, s[44:47], s91 offen lds
    s_add_u32 s90, s90, 128
    s_add_u32 s91, s91, 458752
    s_add_u32 s14, s14, 45056
    s_cmp_eq_u32 s14, s92
    s_cselect_b32 s14, s93, s14
    s_lshl_b32 s16, s7, 14
    s_lshl_b32 s17, s12, 12
    s_add_u32 s16, s16, s17
    s_add_u32 s16, s16, 0x0
    v_lshlrev_b32 v28, 4, v3
    buffer_load_dwordx4 v[128:131], v28, s[40:43], s16 offen offset:0 sc1
    buffer_load_dwordx4 v[132:135], v28, s[40:43], s16 offen offset:1024 sc1
    buffer_load_dwordx4 v[136:139], v28, s[40:43], s16 offen offset:2048 sc1
    buffer_load_dwordx4 v[140:143], v28, s[40:43], s16 offen offset:3072 sc1
    s_lshl_b32 s16, s6, 10
    s_add_u32 s16, s16, 0x40000
    buffer_load_dword v144, v19, s[40:43], s16 offen sc1
    s_load_dword s29, s[30:31], 7040
    s_load_dword s29, s[30:31], 7104
    s_waitcnt vmcnt(16)
    s_barrier
    s_add_u32 m0, s14, 0
    s_nop 0
    buffer_load_dwordx4 v8, s[68:71], s90 offen lds
    s_add_u32 m0, s14, 4096
    s_nop 0
    buffer_load_dwordx4 v9, s[68:71], s90 offen lds
    s_add_u32 m0, s14, 8192
    s_nop 0
    buffer_load_dwordx4 v10, s[68:71], s90 offen lds
    s_add_u32 m0, s14, 12288
    s_nop 0
    buffer_load_dwordx4 v11, s[68:71], s90 offen lds
    s_add_u32 m0, s14, 16384
    s_nop 0
    buffer_load_dwordx4 v12, s[44:47], s91 offen lds
    s_add_u32 m0, s14, 20480
    s_nop 0
    buffer_load_dwordx4 v13, s[44:47], s91 offen lds
    s_add_u32 m0, s14, 24576
    s_nop 0
    buffer_load_dwordx4 v14, s[44:47], s91 offen lds
    s_add_u32 m0, s14, 28672
    s_nop 0
    buffer_load_dwordx4 v15, s[44:47], s91 offen lds
    s_add_u32 m0, s14, 32768
    s_nop 0
    buffer_load_dwordx4 v16, s[44:47], s91 offen lds
    s_add_u32 m0, s14, 36864
    s_nop 0
    buffer_load_dwordx4 v17, s[44:47], s91 offen lds
    s_add_u32 m0, s14, 40960
    s_nop 0
    buffer_load_dwordx4 v18, s[44:47], s91 offen lds
    s_add_u32 s90, s90, 128
    s_add_u32 s91, s91, 458752
    s_add_u32 s14, s14, 45056
    s_cmp_eq_u32 s14, s92
    s_cselect_b32 s14, s93, s14
    s_waitcnt vmcnt(16)
    s_barrier
    s_waitcnt vmcnt(11)
    v_pk_add_f32 v[128:129], v[128:129], v[132:133]
    v_pk_add_f32 v[130:131], v[130:131], v[134:135]
    v_pk_add_f32 v[136:137], v[136:137], v[140:141]
    v_pk_add_f32 v[138:139], v[138:139], v[142:143]
    v_pk_add_f32 v[128:129], v[128:129], v[136:137]
    v_pk_add_f32 v[130:131], v[130:131], v[138:139]
    s_lshl_b32 s16, s12, 10
    s_add_u32 s16, s16, 135168
    v_add_u32 v28, s16, v28
    ds_write_b128 v28, v[128:131]
    v_add_u32 v28, 162816, v19
    ds_write_b32 v28, v144
    s_waitcnt lgkmcnt(0)
    s_waitcnt vmcnt(0)
    s_barrier
    v_add_u32 v28, 135168, v19
    ds_read_b32 v128, v28 offset:0
    ds_read_b32 v129, v28 offset:1024
    ds_read_b32 v130, v28 offset:2048
    ds_read_b32 v131, v28 offset:3072
    v_add_u32 v28, 161792, v19
    s_waitcnt lgkmcnt(0)
    v_add_f32 v128, v128, v129
    v_add_f32 v130, v130, v131
    v_add_f32 v128, v128, v130
    ds_write_b32 v28, v128
    s_add_u32 s14, s93, 65536
    s_mov_b32 s90, 256
    s_add_u32 m0, s14, 0
    s_nop 0
    buffer_load_dwordx4 v20, s[40:43], s90 offen sc1 lds
    s_add_u32 m0, s14, 4096
    s_nop 0
    buffer_load_dwordx4 v21, s[40:43], s90 offen sc1 lds
    s_add_u32 m0, s14, 8192
    s_nop 0
    buffer_load_dwordx4 v22, s[40:43], s90 offen sc1 lds
    s_add_u32 m0, s14, 12288
    s_nop 0
    buffer_load_dwordx4 v23, s[40:43], s90 offen sc1 lds
    s_add_u32 m0, s14, 16384
    s_nop 0
    buffer_load_dwordx4 v24, s[40:43], s90 offen sc1 lds
    s_add_u32 m0, s14, 20480
    s_nop 0
    buffer_load_dwordx4 v25, s[40:43], s90 offen sc1 lds
    s_add_u32 m0, s14, 24576
    s_nop 0
    buffer_load_dwordx4 v26, s[40:43], s90 offen sc1 lds
    s_add_u32 m0, s14, 28672
    s_nop 0
    buffer_load_dwordx4 v27, s[40:43], s90 offen sc1 lds
    s_waitcnt lgkmcnt(0)
    s_barrier
    s_add_u32 s14, s93, 0
    s_mov_b32 s90, 0
    s_add_u32 m0, s14, 0
    s_nop 0
    buffer_load_dwordx4 v20, s[40:43], s90 offen sc1 lds
    s_add_u32 m0, s14, 4096
    s_nop 0
    buffer_load_dwordx4 v21, s[40:43], s90 offen sc1 lds
    s_add_u32 m0, s14, 8192
    s_nop 0
    buffer_load_dwordx4 v22, s[40:43], s90 offen sc1 lds
    s_add_u32 m0, s14, 12288
    s_nop 0
    buffer_load_dwordx4 v23, s[40:43], s90 offen sc1 lds
    s_add_u32 m0, s14, 16384
    s_nop 0
    buffer_load_dwordx4 v24, s[40:43], s90 offen sc1 lds
    s_add_u32 m0, s14, 20480
    s_nop 0
    buffer_load_dwordx4 v25, s[40:43], s90 offen sc1 lds
    s_add_u32 m0, s14, 24576
    s_nop 0
    buffer_load_dwordx4 v26, s[40:43], s90 offen sc1 lds
    s_add_u32 m0, s14, 28672
    s_nop 0
    buffer_load_dwordx4 v27, s[40:43], s90 offen sc1 lds
    s_add_u32 s14, s93, 32768
    s_mov_b32 s90, 128
    s_add_u32 m0, s14, 0
    s_nop 0
    buffer_load_dwordx4 v20, s[40:43], s90 offen sc1 lds
    s_add_u32 m0, s14, 4096
    s_nop 0
    buffer_load_dwordx4 v21, s[40:43], s90 offen sc1 lds
    s_add_u32 m0, s14, 8192
    s_nop 0
    buffer_load_dwordx4 v22, s[40:43], s90 offen sc1 lds
    s_add_u32 m0, s14, 12288
    s_nop 0
    buffer_load_dwordx4 v23, s[40:43], s90 offen sc1 lds
    s_add_u32 m0, s14, 16384
    s_nop 0
    buffer_load_dwordx4 v24, s[40:43], s90 offen sc1 lds
    s_add_u32 m0, s14, 20480
    s_nop 0
    buffer_load_dwordx4 v25, s[40:43], s90 offen sc1 lds
    s_add_u32 m0, s14, 24576
    s_nop 0
    buffer_load_dwordx4 v26, s[40:43], s90 offen sc1 lds
    s_add_u32 m0, s14, 28672
    s_nop 0
    buffer_load_dwordx4 v27, s[40:43], s90 offen sc1 lds
    s_add_u32 s14, s93, 98304
    s_mov_b32 s90, 384
    s_add_u32 m0, s14, 0
    s_nop 0
    buffer_load_dwordx4 v20, s[40:43], s90 offen sc1 lds
    s_add_u32 m0, s14, 4096
    s_nop 0
    buffer_load_dwordx4 v21, s[40:43], s90 offen sc1 lds
    s_add_u32 m0, s14, 8192
    s_nop 0
    buffer_load_dwordx4 v22, s[40:43], s90 offen sc1 lds
    s_add_u32 m0, s14, 12288
    s_nop 0
    buffer_load_dwordx4 v23, s[40:43], s90 offen sc1 lds
    s_add_u32 m0, s14, 16384
    s_nop 0
    buffer_load_dwordx4 v24, s[40:43], s90 offen sc1 lds
    s_add_u32 m0, s14, 20480
    s_nop 0
    buffer_load_dwordx4 v25, s[40:43], s90 offen sc1 lds
    s_add_u32 m0, s14, 24576
    s_nop 0
    buffer_load_dwordx4 v26, s[40:43], s90 offen sc1 lds
    s_add_u32 m0, s14, 28672
    s_nop 0
    buffer_load_dwordx4 v27, s[40:43], s90 offen sc1 lds
    v_lshrrev_b32 v6, 4, v3
    s_lshr_b32 s16, s12, 1
    s_lshl_b32 s16, s16, 2
    v_or_b32 v7, s16, v6
    v_lshlrev_b32 v7, 1, v7
    v_and_b32 v28, 15, v3
    v_xor_b32 v7, v7, v28
    v_lshlrev_b32 v7, 4, v7
    v_lshl_add_u32 v6, v6, 11, v7
    s_mul_i32 s16, s11, 3670016
    s_lshl_b32 s17, s12, 13
    s_add_u32 s16, s16, s17
    s_lshl_b32 s17, s39, 7
    s_add_u32 s16, s16, s17
    v_add_u32 v6, s16, v6
    v_and_b32 v7, 128, v7
    v_mul_u32_u24 v7, 0, v7
    v_add_u32 v6, v6, v7
    v_add_u32 v36, 0x0, v6
    v_add_u32 v37, 0x8000, v6
    v_add_u32 v38, 0x10000, v6
    v_add_u32 v39, 0x18000, v6
    v_add_u32 v44, 0x70000, v6
    v_add_u32 v45, 0x78000, v6
    s_lshl_b32 s16, s9, 4
    s_lshl_b32 s17, s11, 3
    s_add_u32 s16, s16, s17
    s_mul_i32 s17, s16, 49152
    s_add_u32 s17, s17, 0xd00000
    s_lshl_b32 s18, s16, 13
    s_add_u32 s18, s18, 0x1900000
    v_and_b32 v6, 64, v4
    v_lshlrev_b32 v6, 7, v6
    v_and_b32 v7, 48, v4
    v_add_u32 v7, v7, v6
    v_lshl_add_u32 v7, v5, 6, v7
    v_add_u32 v7, s17, v7
    v_add_u32 v32, 0, v7
    v_add_u32 v33, 2048, v7
    v_add_u32 v34, 4096, v7
    v_add_u32 v35, 6144, v7
    v_and_b32 v7, 32, v4
    v_lshl_add_u32 v6, v7, 7, v6
    v_and_b32 v7, 16, v4
    v_add_u32 v6, v6, v7
    v_lshl_add_u32 v6, v5, 5, v6
    v_add_u32 v6, s18, v6
    v_add_u32 v40, 0, v6
    v_add_u32 v41, 1024, v6
    v_add_u32 v42, 2048, v6
    v_add_u32 v43, 3072, v6
    s_cmp_gt_u32 s9, 8
    s_cselect_b32 s16, -1, 0
    s_sub_u32 s18, 16, s9
    s_cmp_gt_u32 s9, 8
    s_cselect_b32 s17, s18, s9
    s_lshl_b32 s18, s17, 19
    s_add_u32 s18, s18, 0x800000
    s_lshl_b32 s19, s17, 16
    s_add_u32 s19, s19, 0x100000
    s_and_b32 s20, s16, 127
    v_add_u32 v6, 0, v5
    v_xor_b32 v6, s20, v6
    v_lshl_add_u32 v6, v6, 8, v4
    v_add_u32 v48, s19, v6
    v_add_u32 v6, 32, v5
    v_xor_b32 v6, s20, v6
    v_lshl_add_u32 v6, v6, 8, v4
    v_add_u32 v49, s19, v6
    v_add_u32 v6, 64, v5
    v_xor_b32 v6, s20, v6
    v_lshl_add_u32 v6, v6, 8, v4
    v_add_u32 v50, s19, v6
    v_add_u32 v6, 96, v5
    v_xor_b32 v6, s20, v6
    v_lshl_add_u32 v6, v6, 8, v4
    v_add_u32 v51, s19, v6
    s_lshl_b32 s19, s39, 6
    s_mul_i32 s20, s11, 64
    s_add_u32 s19, s19, s20
    v_add_u32 v6, 0, v5
    v_add_u32 v6, s19, v6
    v_xor_b32 v6, s16, v6
    v_subrev_u32 v6, s16, v6
    v_and_b32 v7, 3, v6
    v_bfe_u32 v6, v6, 2, 8
    v_lshl_add_u32 v6, v7, 8, v6
    v_and_b32 v7, 48, v4
    v_lshl_add_u32 v6, v6, 6, v7
    v_and_b32 v7, 64, v4
    v_lshl_add_u32 v6, v7, 10, v6
    v_add_u32 v52, s18, v6
    v_add_u32 v6, 32, v5
    v_add_u32 v6, s19, v6
    v_xor_b32 v6, s16, v6
    v_subrev_u32 v6, s16, v6
    v_and_b32 v7, 3, v6
    v_bfe_u32 v6, v6, 2, 8
    v_lshl_add_u32 v6, v7, 8, v6
    v_and_b32 v7, 48, v4
    v_lshl_add_u32 v6, v6, 6, v7
    v_and_b32 v7, 64, v4
    v_lshl_add_u32 v6, v7, 10, v6
    v_add_u32 v53, s18, v6
    s_and_b32 s19, s17, 7
    s_lshl_b32 s19, s19, 9
    s_add_u32 s19, s19, 0x2000
    v_add_u32 v58, s19, v31
    s_andn2_b32 s18, s28, 127
    v_and_b32 v6, 31, v3
    v_lshlrev_b32 v6, 2, v6
    v_add_u32 v59, s18, v6
    s_and_b32 s18, s10, 4
    s_lshl_b32 s18, s18, 2
    s_lshl_b32 s76, 0xffff, s18
    s_not_b32 s78, s76
    s_mov_b32 s77, 0
    s_mov_b32 s79, 0
    s_mul_i32 s16, s11, 3670016
    s_lshl_b32 s17, s39, 7
    s_add_u32 s16, s16, s17
    s_and_b32 s17, s5, 7
    s_cmp_ge_u32 s17, 4
    s_cselect_b32 s95, 393216, 0
    s_lshl_b32 s17, s17, 2
    s_add_u32 s17, s17, s12
    s_lshl_b32 s17, s17, 12
    s_add_u32 s16, s16, s17
    s_add_u32 s30, s56, s16
    s_addc_u32 s31, s57, 0
    s_and_b32 s94, s10, 4
    s_and_b32 s94, s10, 4
    v_lshlrev_b32 v60, 4, v3
    v_add_u32 v60, s93, v60
    s_waitcnt vmcnt(0)
    s_barrier
    s_add_u32 s92, s93, 163840
    s_mov_b32 s22, 0
    s_mov_b32 s23, 0
    s_add_u32 s14, s93, 131072
    s_xor_b32 s16, s94, 0
    s_mul_i32 s91, s16, 458752
    s_add_u32 m0, s14, 16384
    s_nop 0
    buffer_load_dwordx4 v36, s[56:59], s91 offen lds
    s_add_u32 m0, s14, 20480
    s_nop 0
    buffer_load_dwordx4 v37, s[56:59], s91 offen lds
    s_add_u32 m0, s14, 24576
    s_nop 0
    buffer_load_dwordx4 v38, s[56:59], s91 offen lds
    s_add_u32 m0, s14, 28672
    s_nop 0
    buffer_load_dwordx4 v39, s[56:59], s91 offen lds
    s_barrier
    s_add_u32 s14, s93, 0
    s_xor_b32 s16, s94, 1
    s_mul_i32 s91, s16, 458752
    s_add_u32 m0, s14, 16384
    s_nop 0
    buffer_load_dwordx4 v36, s[56:59], s91 offen lds
    s_add_u32 m0, s14, 20480
    s_nop 0
    buffer_load_dwordx4 v37, s[56:59], s91 offen lds
    s_add_u32 m0, s14, 24576
    s_nop 0
    buffer_load_dwordx4 v38, s[56:59], s91 offen lds
    s_add_u32 m0, s14, 28672
    s_nop 0
    buffer_load_dwordx4 v39, s[56:59], s91 offen lds
    s_add_u32 s14, s93, 32768
    s_xor_b32 s16, s94, 2
    s_mul_i32 s91, s16, 458752
    s_add_u32 m0, s14, 16384
    s_nop 0
    buffer_load_dwordx4 v36, s[56:59], s91 offen lds
    s_add_u32 m0, s14, 20480
    s_nop 0
    buffer_load_dwordx4 v37, s[56:59], s91 offen lds
    s_add_u32 m0, s14, 24576
    s_nop 0
    buffer_load_dwordx4 v38, s[56:59], s91 offen lds
    s_add_u32 m0, s14, 28672
    s_nop 0
    buffer_load_dwordx4 v39, s[56:59], s91 offen lds
L_pre_31:
    buffer_load_dword v29, v59, s[40:43], 0 offen offset:0 sc1
    s_waitcnt vmcnt(0)
    s_add_u32 s23, s23, 1
    v_cmp_ne_u32 vcc, s38, v29
    s_nop 0
    s_and_b64 vcc, vcc, s[76:77]
    s_cbranch_scc0 L_got_32
    s_sleep 2
    s_cmp_lt_u32 s23, 2
    s_cbranch_scc1 L_pre_31
    s_branch L_nogot_33
L_got_32:
    s_add_u32 s14, s93, 131072
    s_xor_b32 s16, s94, 0
    s_mul_i32 s90, s16, 49152
    s_add_u32 m0, s14, 0
    s_nop 0
    buffer_load_dwordx4 v32, s[40:43], s90 offen sc1 lds
    s_add_u32 m0, s14, 4096
    s_nop 0
    buffer_load_dwordx4 v33, s[40:43], s90 offen sc1 lds
    s_add_u32 m0, s14, 8192
    s_nop 0
    buffer_load_dwordx4 v34, s[40:43], s90 offen sc1 lds
    s_add_u32 m0, s14, 12288
    s_nop 0
    buffer_load_dwordx4 v35, s[40:43], s90 offen sc1 lds
L_got2_35:
    s_add_u32 s14, s93, 0
    s_xor_b32 s16, s94, 1
    s_mul_i32 s90, s16, 49152
    s_add_u32 m0, s14, 0
    s_nop 0
    buffer_load_dwordx4 v32, s[40:43], s90 offen sc1 lds
    s_add_u32 m0, s14, 4096
    s_nop 0
    buffer_load_dwordx4 v33, s[40:43], s90 offen sc1 lds
    s_add_u32 m0, s14, 8192
    s_nop 0
    buffer_load_dwordx4 v34, s[40:43], s90 offen sc1 lds
    s_add_u32 m0, s14, 12288
    s_nop 0
    buffer_load_dwordx4 v35, s[40:43], s90 offen sc1 lds
    s_add_u32 s14, s93, 32768
    s_xor_b32 s16, s94, 2
    s_mul_i32 s90, s16, 49152
    s_add_u32 m0, s14, 0
    s_nop 0
    buffer_load_dwordx4 v32, s[40:43], s90 offen sc1 lds
    s_add_u32 m0, s14, 4096
    s_nop 0
    buffer_load_dwordx4 v33, s[40:43], s90 offen sc1 lds
    s_add_u32 m0, s14, 8192
    s_nop 0
    buffer_load_dwordx4 v34, s[40:43], s90 offen sc1 lds
    s_add_u32 m0, s14, 12288
    s_nop 0
    buffer_load_dwordx4 v35, s[40:43], s90 offen sc1 lds
    buffer_load_dword v30, v59, s[40:43], 0 offen offset:128 sc1
    s_mov_b32 s22, 1
L_nogot_33:
    s_barrier
    s_cmp_eq_u32 s22, 0
    s_cbranch_scc1 L_late_36
    s_add_u32 s14, s93, 65536
    s_xor_b32 s16, s94, 3
    s_mul_i32 s90, s16, 49152
    s_mul_i32 s91, s16, 458752
    s_add_u32 m0, s14, 0
    s_nop 0
    buffer_load_dwordx4 v32, s[40:43], s90 offen sc1 lds
    s_add_u32 m0, s14, 4096
    s_nop 0
    buffer_load_dwordx4 v33, s[40:43], s90 offen sc1 lds
    s_add_u32 m0, s14, 8192
    s_nop 0
    buffer_load_dwordx4 v34, s[40:43], s90 offen sc1 lds
    s_add_u32 m0, s14, 12288
    s_nop 0
    buffer_load_dwordx4 v35, s[40:43], s90 offen sc1 lds
    s_add_u32 m0, s14, 16384
    s_nop 0
    buffer_load_dwordx4 v36, s[56:59], s91 offen lds
    s_add_u32 m0, s14, 20480
    s_nop 0
    buffer_load_dwordx4 v37, s[56:59], s91 offen lds
    s_add_u32 m0, s14, 24576
    s_nop 0
    buffer_load_dwordx4 v38, s[56:59], s91 offen lds
    s_add_u32 m0, s14, 28672
    s_nop 0
    buffer_load_dwordx4 v39, s[56:59], s91 offen lds
    s_waitcnt vmcnt(17)
    s_barrier
    s_waitcnt vmcnt(8)
    s_mov_b32 s23, 0
    s_branch L_pchk_40
L_poll_38:
    buffer_load_dword v30, v59, s[40:43], 0 offen offset:128 sc1
    s_waitcnt vmcnt(0)
L_pchk_40:
    s_add_u32 s23, s23, 1
    v_cmp_ne_u32 vcc, s38, v30
    s_nop 0
    s_and_b64 vcc, vcc, s[76:77]
    s_cbranch_scc0 L_pdone_39
    s_sleep 4
    s_cmp_lt_u32 s23, 200000
    s_cbranch_scc1 L_poll_38
L_pdone_39:
    s_add_u32 s14, s93, 98304
    s_xor_b32 s16, s94, 0
    s_mul_i32 s90, s16, 49152
    s_add_u32 s90, s90, 16384
    s_mul_i32 s91, s16, 458752
    s_add_u32 s91, s91, 131072
    s_add_u32 m0, s14, 0
    s_nop 0
    buffer_load_dwordx4 v32, s[40:43], s90 offen sc1 lds
    s_add_u32 m0, s14, 4096
    s_nop 0
    buffer_load_dwordx4 v33, s[40:43], s90 offen sc1 lds
    s_add_u32 m0, s14, 8192
    s_nop 0
    buffer_load_dwordx4 v34, s[40:43], s90 offen sc1 lds
    s_add_u32 m0, s14, 12288
    s_nop 0
    buffer_load_dwordx4 v35, s[40:43], s90 offen sc1 lds
    s_add_u32 m0, s14, 16384
    s_nop 0
    buffer_load_dwordx4 v36, s[56:59], s91 offen lds
    s_add_u32 m0, s14, 20480
    s_nop 0
    buffer_load_dwordx4 v37, s[56:59], s91 offen lds
    s_add_u32 m0, s14, 24576
    s_nop 0
    buffer_load_dwordx4 v38, s[56:59], s91 offen lds
    s_add_u32 m0, s14, 28672
    s_nop 0
    buffer_load_dwordx4 v39, s[56:59], s91 offen lds
    s_branch L_go_37
L_late_36:
    s_add_u32 s14, s93, 65536
    s_xor_b32 s16, s94, 3
    s_mul_i32 s91, s16, 458752
    s_add_u32 m0, s14, 16384
    s_nop 0
    buffer_load_dwordx4 v36, s[56:59], s91 offen lds
    s_add_u32 m0, s14, 20480
    s_nop 0
    buffer_load_dwordx4 v37, s[56:59], s91 offen lds
    s_add_u32 m0, s14, 24576
    s_nop 0
    buffer_load_dwordx4 v38, s[56:59], s91 offen lds
    s_add_u32 m0, s14, 28672
    s_nop 0
    buffer_load_dwordx4 v39, s[56:59], s91 offen lds
    s_add_u32 s14, s93, 98304
    s_xor_b32 s16, s94, 0
    s_mul_i32 s91, s16, 458752
    s_add_u32 s91, s91, 131072
    s_add_u32 m0, s14, 16384
    s_nop 0
    buffer_load_dwordx4 v36, s[56:59], s91 offen lds
    s_add_u32 m0, s14, 20480
    s_nop 0
    buffer_load_dwordx4 v37, s[56:59], s91 offen lds
    s_add_u32 m0, s14, 24576
    s_nop 0
    buffer_load_dwordx4 v38, s[56:59], s91 offen lds
    s_add_u32 m0, s14, 28672
    s_nop 0
    buffer_load_dwordx4 v39, s[56:59], s91 offen lds
    s_mov_b32 s23, 0
L_poll_41:
    buffer_load_dword v29, v59, s[40:43], 0 offen offset:0 sc1
    buffer_load_dword v30, v59, s[40:43], 0 offen offset:128 sc1
    s_waitcnt vmcnt(0)
L_pchk_43:
    s_add_u32 s23, s23, 1
    v_cmp_ne_u32 vcc, s38, v29
    v_cmp_ne_u32 s[96:97], s38, v30
    s_or_b64 vcc, vcc, s[96:97]
    s_nop 0
    s_and_b64 vcc, vcc, s[76:77]
    s_cbranch_scc0 L_pdone_42
    s_sleep 4
    s_cmp_lt_u32 s23, 200000
    s_cbranch_scc1 L_poll_41
L_pdone_42:
    s_add_u32 s14, s93, 131072
    s_xor_b32 s16, s94, 0
    s_mul_i32 s90, s16, 49152
    s_add_u32 m0, s14, 0
    s_nop 0
    buffer_load_dwordx4 v32, s[40:43], s90 offen sc1 lds
    s_add_u32 m0, s14, 4096
    s_nop 0
    buffer_load_dwordx4 v33, s[40:43], s90 offen sc1 lds
    s_add_u32 m0, s14, 8192
    s_nop 0
    buffer_load_dwordx4 v34, s[40:43], s90 offen sc1 lds
    s_add_u32 m0, s14, 12288
    s_nop 0
    buffer_load_dwordx4 v35, s[40:43], s90 offen sc1 lds
    s_add_u32 s14, s93, 0
    s_xor_b32 s16, s94, 1
    s_mul_i32 s90, s16, 49152
    s_add_u32 m0, s14, 0
    s_nop 0
    buffer_load_dwordx4 v32, s[40:43], s90 offen sc1 lds
    s_add_u32 m0, s14, 4096
    s_nop 0
    buffer_load_dwordx4 v33, s[40:43], s90 offen sc1 lds
    s_add_u32 m0, s14, 8192
    s_nop 0
    buffer_load_dwordx4 v34, s[40:43], s90 offen sc1 lds
    s_add_u32 m0, s14, 12288
    s_nop 0
    buffer_load_dwordx4 v35, s[40:43], s90 offen sc1 lds
    s_waitcnt vmcnt(4)
    s_barrier
    s_add_u32 s14, s93, 32768
    s_xor_b32 s16, s94, 2
    s_mul_i32 s90, s16, 49152
    s_add_u32 m0, s14, 0
    s_nop 0
    buffer_load_dwordx4 v32, s[40:43], s90 offen sc1 lds
    s_add_u32 m0, s14, 4096
    s_nop 0
    buffer_load_dwordx4 v33, s[40:43], s90 offen sc1 lds
    s_add_u32 m0, s14, 8192
    s_nop 0
    buffer_load_dwordx4 v34, s[40:43], s90 offen sc1 lds
    s_add_u32 m0, s14, 12288
    s_nop 0
    buffer_load_dwordx4 v35, s[40:43], s90 offen sc1 lds
    s_add_u32 s14, s93, 65536
    s_xor_b32 s16, s94, 3
    s_mul_i32 s90, s16, 49152
    s_add_u32 m0, s14, 0
    s_nop 0
    buffer_load_dwordx4 v32, s[40:43], s90 offen sc1 lds
    s_add_u32 m0, s14, 4096
    s_nop 0
    buffer_load_dwordx4 v33, s[40:43], s90 offen sc1 lds
    s_add_u32 m0, s14, 8192
    s_nop 0
    buffer_load_dwordx4 v34, s[40:43], s90 offen sc1 lds
    s_add_u32 m0, s14, 12288
    s_nop 0
    buffer_load_dwordx4 v35, s[40:43], s90 offen sc1 lds
    s_add_u32 s14, s93, 98304
    s_xor_b32 s16, s94, 0
    s_mul_i32 s90, s16, 49152
    s_add_u32 s90, s90, 16384
    s_add_u32 m0, s14, 0
    s_nop 0
    buffer_load_dwordx4 v32, s[40:43], s90 offen sc1 lds
    s_add_u32 m0, s14, 4096
    s_nop 0
    buffer_load_dwordx4 v33, s[40:43], s90 offen sc1 lds
    s_add_u32 m0, s14, 8192
    s_nop 0
    buffer_load_dwordx4 v34, s[40:43], s90 offen sc1 lds
    s_add_u32 m0, s14, 12288
    s_nop 0
    buffer_load_dwordx4 v35, s[40:43], s90 offen sc1 lds
    s_waitcnt vmcnt(12)
L_go_37:
    buffer_load_dword v29, v59, s[40:43], 0 offen offset:256 sc1
    s_barrier
    s_add_u32 s14, s93, 131072
    s_xor_b32 s16, s94, 1
    s_mul_i32 s90, s16, 49152
    s_add_u32 s90, s90, 16384
    s_mul_i32 s91, s16, 458752
    s_add_u32 s91, s91, 131072
    s_add_u32 m0, s14, 0
    s_nop 0
    buffer_load_dwordx4 v32, s[40:43], s90 offen sc1 lds
    s_add_u32 m0, s14, 4096
    s_nop 0
    buffer_load_dwordx4 v33, s[40:43], s90 offen sc1 lds
    s_add_u32 m0, s14, 8192
    s_nop 0
    buffer_load_dwordx4 v34, s[40:43], s90 offen sc1 lds
    s_add_u32 m0, s14, 12288
    s_nop 0
    buffer_load_dwordx4 v35, s[40:43], s90 offen sc1 lds
    s_add_u32 m0, s14, 16384
    s_nop 0
    buffer_load_dwordx4 v36, s[56:59], s91 offen lds
    s_add_u32 m0, s14, 20480
    s_nop 0
    buffer_load_dwordx4 v37, s[56:59], s91 offen lds
    s_add_u32 m0, s14, 24576
    s_nop 0
    buffer_load_dwordx4 v38, s[56:59], s91 offen lds
    s_add_u32 m0, s14, 28672
    s_nop 0
    buffer_load_dwordx4 v39, s[56:59], s91 offen lds
    s_xor_b32 s96, s94, 6
    s_mul_i32 s96, s96, 458752
    s_load_dword s29, s[30:31], s96 offset:0
    s_load_dword s29, s[30:31], s96 offset:64
    s_load_dword s29, s[30:31], s96 offset:128
    s_load_dword s29, s[30:31], s96 offset:192
    s_load_dword s29, s[30:31], s96 offset:2048
    s_load_dword s29, s[30:31], s96 offset:2112
    s_load_dword s29, s[30:31], s96 offset:2176
    s_load_dword s29, s[30:31], s96 offset:2240
    s_waitcnt vmcnt(17)
    s_barrier
    s_add_u32 s14, s93, 0
    s_xor_b32 s16, s94, 2
    s_mul_i32 s90, s16, 49152
    s_add_u32 s90, s90, 16384
    s_mul_i32 s91, s16, 458752
    s_add_u32 s91, s91, 131072
    s_add_u32 m0, s14, 0
    s_nop 0
    buffer_load_dwordx4 v32, s[40:43], s90 offen sc1 lds
    s_add_u32 m0, s14, 4096
    s_nop 0
    buffer_load_dwordx4 v33, s[40:43], s90 offen sc1 lds
    s_add_u32 m0, s14, 8192
    s_nop 0
    buffer_load_dwordx4 v34, s[40:43], s90 offen sc1 lds
    s_add_u32 m0, s14, 12288
    s_nop 0
    buffer_load_dwordx4 v35, s[40:43], s90 offen sc1 lds
    s_add_u32 m0, s14, 16384
    s_nop 0
    buffer_load_dwordx4 v36, s[56:59], s91 offen lds
    s_add_u32 m0, s14, 20480
    s_nop 0
    buffer_load_dwordx4 v37, s[56:59], s91 offen lds
    s_add_u32 m0, s14, 24576
    s_nop 0
    buffer_load_dwordx4 v38, s[56:59], s91 offen lds
    s_add_u32 m0, s14, 28672
    s_nop 0
    buffer_load_dwordx4 v39, s[56:59], s91 offen lds
    s_xor_b32 s96, s94, 7
    s_mul_i32 s96, s96, 458752
    s_load_dword s29, s[30:31], s96 offset:0
    s_load_dword s29, s[30:31], s96 offset:64
    s_load_dword s29, s[30:31], s96 offset:128
    s_load_dword s29, s[30:31], s96 offset:192
    s_load_dword s29, s[30:31], s96 offset:2048
    s_load_dword s29, s[30:31], s96 offset:2112
    s_load_dword s29, s[30:31], s96 offset:2176
    s_load_dword s29, s[30:31], s96 offset:2240
    s_waitcnt vmcnt(21)
    s_barrier
    s_add_u32 s14, s93, 32768
    s_xor_b32 s16, s94, 3
    s_mul_i32 s90, s16, 49152
    s_add_u32 s90, s90, 16384
    s_mul_i32 s91, s16, 458752
    s_add_u32 s91, s91, 131072
    s_add_u32 m0, s14, 0
    s_nop 0
    buffer_load_dwordx4 v32, s[40:43], s90 offen sc1 lds
    s_add_u32 m0, s14, 4096
    s_nop 0
    buffer_load_dwordx4 v33, s[40:43], s90 offen sc1 lds
    s_add_u32 m0, s14, 8192
    s_nop 0
    buffer_load_dwordx4 v34, s[40:43], s90 offen sc1 lds
    s_add_u32 m0, s14, 12288
    s_nop 0
    buffer_load_dwordx4 v35, s[40:43], s90 offen sc1 lds
    s_add_u32 m0, s14, 16384
    s_nop 0
    buffer_load_dwordx4 v36, s[56:59], s91 offen lds
    s_add_u32 m0, s14, 20480
    s_nop 0
    buffer_load_dwordx4 v37, s[56:59], s91 offen lds
    s_add_u32 m0, s14, 24576
    s_nop 0
    buffer_load_dwordx4 v38, s[56:59], s91 offen lds
    s_add_u32 m0, s14, 28672
    s_nop 0
    buffer_load_dwordx4 v39, s[56:59], s91 offen lds
    s_xor_b32 s96, s94, 4
    s_mul_i32 s96, s96, 458752
    s_add_u32 s96, s96, 131072
    s_load_dword s29, s[30:31], s96 offset:0
    s_load_dword s29, s[30:31], s96 offset:64
    s_load_dword s29, s[30:31], s96 offset:128
    s_load_dword s29, s[30:31], s96 offset:192
    s_load_dword s29, s[30:31], s96 offset:2048
    s_load_dword s29, s[30:31], s96 offset:2112
    s_load_dword s29, s[30:31], s96 offset:2176
    s_load_dword s29, s[30:31], s96 offset:2240
    s_waitcnt vmcnt(24)
    s_mov_b32 s23, 0
    s_branch L_pchk_46
L_poll_44:
    buffer_load_dword v29, v59, s[40:43], 0 offen offset:256 sc1
    s_waitcnt vmcnt(0)
L_pchk_46:
    s_add_u32 s23, s23, 1
    v_cmp_ne_u32 vcc, s38, v29
    s_nop 0
    s_and_b64 vcc, vcc, s[76:77]
    s_cbranch_scc0 L_pdone_45
    s_sleep 4
    s_cmp_lt_u32 s23, 200000
    s_cbranch_scc1 L_poll_44
L_pdone_45:
    s_barrier
    s_add_u32 s14, s93, 65536
    s_xor_b32 s16, s94, 0
    s_mul_i32 s90, s16, 49152
    s_add_u32 s90, s90, 32768
    s_mul_i32 s91, s16, 458752
    s_add_u32 s91, s91, 262144
    s_add_u32 m0, s14, 0
    s_nop 0
    buffer_load_dwordx4 v32, s[40:43], s90 offen sc1 lds
    s_add_u32 m0, s14, 4096
    s_nop 0
    buffer_load_dwordx4 v33, s[40:43], s90 offen sc1 lds
    s_add_u32 m0, s14, 8192
    s_nop 0
    buffer_load_dwordx4 v34, s[40:43], s90 offen sc1 lds
    s_add_u32 m0, s14, 12288
    s_nop 0
    buffer_load_dwordx4 v35, s[40:43], s90 offen sc1 lds
    s_add_u32 m0, s14, 16384
    s_nop 0
    buffer_load_dwordx4 v36, s[56:59], s91 offen lds
    s_add_u32 m0, s14, 20480
    s_nop 0
    buffer_load_dwordx4 v37, s[56:59], s91 offen lds
    s_add_u32 m0, s14, 24576
    s_nop 0
    buffer_load_dwordx4 v38, s[56:59], s91 offen lds
    s_add_u32 m0, s14, 28672
    s_nop 0
    buffer_load_dwordx4 v39, s[56:59], s91 offen lds
    s_xor_b32 s96, s94, 5
    s_mul_i32 s96, s96, 458752
    s_add_u32 s96, s96, 131072
    s_load_dword s29, s[30:31], s96 offset:0
    s_load_dword s29, s[30:31], s96 offset:64
    s_load_dword s29, s[30:31], s96 offset:128
    s_load_dword s29, s[30:31], s96 offset:192
    s_load_dword s29, s[30:31], s96 offset:2048
    s_load_dword s29, s[30:31], s96 offset:2112
    s_load_dword s29, s[30:31], s96 offset:2176
    s_load_dword s29, s[30:31], s96 offset:2240
    buffer_load_dword v29, v59, s[40:43], 0 offen offset:256 sc1
    s_waitcnt vmcnt(25)
    s_barrier
    s_add_u32 s14, s93, 98304
    s_xor_b32 s16, s94, 1
    s_mul_i32 s90, s16, 49152
    s_add_u32 s90, s90, 32768
    s_mul_i32 s91, s16, 458752
    s_add_u32 s91, s91, 262144
    s_add_u32 m0, s14, 0
    s_nop 0
    buffer_load_dwordx4 v32, s[40:43], s90 offen sc1 lds
    s_add_u32 m0, s14, 4096
    s_nop 0
    buffer_load_dwordx4 v33, s[40:43], s90 offen sc1 lds
    s_add_u32 m0, s14, 8192
    s_nop 0
    buffer_load_dwordx4 v34, s[40:43], s90 offen sc1 lds
    s_add_u32 m0, s14, 12288
    s_nop 0
    buffer_load_dwordx4 v35, s[40:43], s90 offen sc1 lds
    s_add_u32 m0, s14, 16384
    s_nop 0
    buffer_load_dwordx4 v36, s[56:59], s91 offen lds
    s_add_u32 m0, s14, 20480
    s_nop 0
    buffer_load_dwordx4 v37, s[56:59], s91 offen lds
    s_add_u32 m0, s14, 24576
    s_nop 0
    buffer_load_dwordx4 v38, s[56:59], s91 offen lds
    s_add_u32 m0, s14, 28672
    s_nop 0
    buffer_load_dwordx4 v39, s[56:59], s91 offen lds
    s_xor_b32 s96, s94, 6
    s_mul_i32 s96, s96, 458752
    s_add_u32 s96, s96, 131072
    s_load_dword s29, s[30:31], s96 offset:0
    s_load_dword s29, s[30:31], s96 offset:64
    s_load_dword s29, s[30:31], s96 offset:128
    s_load_dword s29, s[30:31], s96 offset:192
    s_load_dword s29, s[30:31], s96 offset:2048
    s_load_dword s29, s[30:31], s96 offset:2112
    s_load_dword s29, s[30:31], s96 offset:2176
    s_load_dword s29, s[30:31], s96 offset:2240
    s_waitcnt vmcnt(25)
    s_barrier
    s_add_u32 s14, s93, 131072
    s_xor_b32 s16, s94, 2
    s_mul_i32 s90, s16, 49152
    s_add_u32 s90, s90, 32768
    s_mul_i32 s91, s16, 458752
    s_add_u32 s91, s91, 262144
    s_add_u32 m0, s14, 0
    s_nop 0
    buffer_load_dwordx4 v32, s[40:43], s90 offen sc1 lds
    s_add_u32 m0, s14, 4096
    s_nop 0
    buffer_load_dwordx4 v33, s[40:43], s90 offen sc1 lds
    s_add_u32 m0, s14, 8192
    s_nop 0
    buffer_load_dwordx4 v34, s[40:43], s90 offen sc1 lds
    s_add_u32 m0, s14, 12288
    s_nop 0
    buffer_load_dwordx4 v35, s[40:43], s90 offen sc1 lds
    s_add_u32 m0, s14, 16384
    s_nop 0
    buffer_load_dwordx4 v36, s[56:59], s91 offen lds
    s_add_u32 m0, s14, 20480
    s_nop 0
    buffer_load_dwordx4 v37, s[56:59], s91 offen lds
    s_add_u32 m0, s14, 24576
    s_nop 0
    buffer_load_dwordx4 v38, s[56:59], s91 offen lds
    s_add_u32 m0, s14, 28672
    s_nop 0
    buffer_load_dwordx4 v39, s[56:59], s91 offen lds
    s_xor_b32 s96, s94, 7
    s_mul_i32 s96, s96, 458752
    s_add_u32 s96, s96, 131072
    s_load_dword s29, s[30:31], s96 offset:0
    s_load_dword s29, s[30:31], s96 offset:64
    s_load_dword s29, s[30:31], s96 offset:128
    s_load_dword s29, s[30:31], s96 offset:192
    s_load_dword s29, s[30:31], s96 offset:2048
    s_load_dword s29, s[30:31], s96 offset:2112
    s_load_dword s29, s[30:31], s96 offset:2176
    s_load_dword s29, s[30:31], s96 offset:2240
    s_waitcnt vmcnt(25)
    s_barrier
    s_add_u32 s14, s93, 0
    s_xor_b32 s16, s94, 3
    s_mul_i32 s90, s16, 49152
    s_add_u32 s90, s90, 32768
    s_mul_i32 s91, s16, 458752
    s_add_u32 s91, s91, 262144
    s_add_u32 m0, s14, 0
    s_nop 0
    buffer_load_dwordx4 v32, s[40:43], s90 offen sc1 lds
    s_add_u32 m0, s14, 4096
    s_nop 0
    buffer_load_dwordx4 v33, s[40:43], s90 offen sc1 lds
    s_add_u32 m0, s14, 8192
    s_nop 0
    buffer_load_dwordx4 v34, s[40:43], s90 offen sc1 lds
    s_add_u32 m0, s14, 12288
    s_nop 0
    buffer_load_dwordx4 v35, s[40:43], s90 offen sc1 lds
    s_add_u32 m0, s14, 16384
    s_nop 0
    buffer_load_dwordx4 v36, s[56:59], s91 offen lds
    s_add_u32 m0, s14, 20480
    s_nop 0
    buffer_load_dwordx4 v37, s[56:59], s91 offen lds
    s_add_u32 m0, s14, 24576
    s_nop 0
    buffer_load_dwordx4 v38, s[56:59], s91 offen lds
    s_add_u32 m0, s14, 28672
    s_nop 0
    buffer_load_dwordx4 v39, s[56:59], s91 offen lds
    s_xor_b32 s96, s94, 4
    s_mul_i32 s96, s96, 458752
    s_add_u32 s96, s96, 262144
    s_load_dword s29, s[30:31], s96 offset:0
    s_load_dword s29, s[30:31], s96 offset:64
    s_load_dword s29, s[30:31], s96 offset:128
    s_load_dword s29, s[30:31], s96 offset:192
    s_load_dword s29, s[30:31], s96 offset:2048
    s_load_dword s29, s[30:31], s96 offset:2112
    s_load_dword s29, s[30:31], s96 offset:2176
    s_load_dword s29, s[30:31], s96 offset:2240
    s_cmp_lg_u32 s3, 4
    s_cbranch_scc1 L_nf_47
    s_lshr_b32 s96, s8, 3
    s_lshl_b32 s96, s96, 7
    s_and_b32 s97, s8, 7
    s_lshl_b32 s97, s97, 2
    s_add_u32 s96, s96, s97
    s_add_u32 s96, s96, 0x54000
    v_mov_b32 v2, s96
    v_mov_b32 v1, s38
    s_mov_b64 exec, 1
    buffer_store_dword v1, v2, s[40:43], 0 offen sc1
    s_mov_b64 exec, -1
    s_nop 3
L_nf_47:
    s_waitcnt vmcnt(24)
    s_mov_b32 s23, 0
    s_branch L_pchk_50
L_poll_48:
    buffer_load_dword v29, v59, s[40:43], 0 offen offset:256 sc1
    s_waitcnt vmcnt(0)
L_pchk_50:
    s_add_u32 s23, s23, 1
    v_cmp_ne_u32 vcc, s38, v29
    s_nop 0
    s_and_b64 vcc, vcc, s[78:79]
    s_cbranch_scc0 L_pdone_49
    s_sleep 4
    s_cmp_lt_u32 s23, 200000
    s_cbranch_scc1 L_poll_48
L_pdone_49:
    s_barrier
    s_add_u32 s14, s93, 32768
    s_xor_b32 s16, s94, 4
    s_mul_i32 s90, s16, 49152
    s_mul_i32 s91, s16, 458752
    s_add_u32 m0, s14, 0
    s_nop 0
    buffer_load_dwordx4 v32, s[40:43], s90 offen sc1 lds
    s_add_u32 m0, s14, 4096
    s_nop 0
    buffer_load_dwordx4 v33, s[40:43], s90 offen sc1 lds
    s_add_u32 m0, s14, 8192
    s_nop 0
    buffer_load_dwordx4 v34, s[40:43], s90 offen sc1 lds
    s_add_u32 m0, s14, 12288
    s_nop 0
    buffer_load_dwordx4 v35, s[40:43], s90 offen sc1 lds
    s_add_u32 m0, s14, 16384
    s_nop 0
    buffer_load_dwordx4 v36, s[56:59], s91 offen lds
    s_add_u32 m0, s14, 20480
    s_nop 0
    buffer_load_dwordx4 v37, s[56:59], s91 offen lds
    s_add_u32 m0, s14, 24576
    s_nop 0
    buffer_load_dwordx4 v38, s[56:59], s91 offen lds
    s_add_u32 m0, s14, 28672
    s_nop 0
    buffer_load_dwordx4 v39, s[56:59], s91 offen lds
    s_xor_b32 s96, s94, 5
    s_mul_i32 s96, s96, 458752
    s_add_u32 s96, s96, 262144
    s_load_dword s29, s[30:31], s96 offset:0
    s_load_dword s29, s[30:31], s96 offset:64
    s_load_dword s29, s[30:31], s96 offset:128
    s_load_dword s29, s[30:31], s96 offset:192
    s_load_dword s29, s[30:31], s96 offset:2048
    s_load_dword s29, s[30:31], s96 offset:2112
    s_load_dword s29, s[30:31], s96 offset:2176
    s_load_dword s29, s[30:31], s96 offset:2240
    s_waitcnt vmcnt(24)
    s_barrier
    s_add_u32 s14, s93, 65536
    s_xor_b32 s16, s94, 5
    s_mul_i32 s90, s16, 49152
    s_mul_i32 s91, s16, 458752
    s_add_u32 m0, s14, 0
    s_nop 0
    buffer_load_dwordx4 v32, s[40:43], s90 offen sc1 lds
    s_add_u32 m0, s14, 4096
    s_nop 0
    buffer_load_dwordx4 v33, s[40:43], s90 offen sc1 lds
    s_add_u32 m0, s14, 8192
    s_nop 0
    buffer_load_dwordx4 v34, s[40:43], s90 offen sc1 lds
    s_add_u32 m0, s14, 12288
    s_nop 0
    buffer_load_dwordx4 v35, s[40:43], s90 offen sc1 lds
    s_add_u32 m0, s14, 16384
    s_nop 0
    buffer_load_dwordx4 v36, s[56:59], s91 offen lds
    s_add_u32 m0, s14, 20480
    s_nop 0
    buffer_load_dwordx4 v37, s[56:59], s91 offen lds
    s_add_u32 m0, s14, 24576
    s_nop 0
    buffer_load_dwordx4 v38, s[56:59], s91 offen lds
    s_add_u32 m0, s14, 28672
    s_nop 0
    buffer_load_dwordx4 v39, s[56:59], s91 offen lds
    s_xor_b32 s96, s94, 6
    s_mul_i32 s96, s96, 458752
    s_add_u32 s96, s96, 262144
    s_load_dword s29, s[30:31], s96 offset:0
    s_load_dword s29, s[30:31], s96 offset:64
    s_load_dword s29, s[30:31], s96 offset:128
    s_load_dword s29, s[30:31], s96 offset:192
    s_load_dword s29, s[30:31], s96 offset:2048
    s_load_dword s29, s[30:31], s96 offset:2112
    s_load_dword s29, s[30:31], s96 offset:2176
    s_load_dword s29, s[30:31], s96 offset:2240
    s_waitcnt vmcnt(24)
    s_barrier
    s_add_u32 s14, s93, 98304
    s_xor_b32 s16, s94, 6
    s_mul_i32 s90, s16, 49152
    s_mul_i32 s91, s16, 458752
    s_add_u32 m0, s14, 0
    s_nop 0
    buffer_load_dwordx4 v32, s[40:43], s90 offen sc1 lds
    s_add_u32 m0, s14, 4096
    s_nop 0
    buffer_load_dwordx4 v33, s[40:43], s90 offen sc1 lds
    s_add_u32 m0, s14, 8192
    s_nop 0
    buffer_load_dwordx4 v34, s[40:43], s90 offen sc1 lds
    s_add_u32 m0, s14, 12288
    s_nop 0
    buffer_load_dwordx4 v35, s[40:43], s90 offen sc1 lds
    s_add_u32 m0, s14, 16384
    s_nop 0
    buffer_load_dwordx4 v36, s[56:59], s91 offen lds
    s_add_u32 m0, s14, 20480
    s_nop 0
    buffer_load_dwordx4 v37, s[56:59], s91 offen lds
    s_add_u32 m0, s14, 24576
    s_nop 0
    buffer_load_dwordx4 v38, s[56:59], s91 offen lds
    s_add_u32 m0, s14, 28672
    s_nop 0
    buffer_load_dwordx4 v39, s[56:59], s91 offen lds
    s_xor_b32 s96, s94, 7
    s_mul_i32 s96, s96, 458752
    s_add_u32 s96, s96, 262144
    s_load_dword s29, s[30:31], s96 offset:0
    s_load_dword s29, s[30:31], s96 offset:64
    s_load_dword s29, s[30:31], s96 offset:128
    s_load_dword s29, s[30:31], s96 offset:192
    s_load_dword s29, s[30:31], s96 offset:2048
    s_load_dword s29, s[30:31], s96 offset:2112
    s_load_dword s29, s[30:31], s96 offset:2176
    s_load_dword s29, s[30:31], s96 offset:2240
    s_waitcnt vmcnt(24)
    s_barrier
    s_add_u32 s14, s93, 131072
    s_xor_b32 s16, s94, 7
    s_mul_i32 s90, s16, 49152
    s_mul_i32 s91, s16, 458752
    s_add_u32 m0, s14, 0
    s_nop 0
    buffer_load_dwordx4 v32, s[40:43], s90 offen sc1 lds
    s_add_u32 m0, s14, 4096
    s_nop 0
    buffer_load_dwordx4 v33, s[40:43], s90 offen sc1 lds
    s_add_u32 m0, s14, 8192
    s_nop 0
    buffer_load_dwordx4 v34, s[40:43], s90 offen sc1 lds
    s_add_u32 m0, s14, 12288
    s_nop 0
    buffer_load_dwordx4 v35, s[40:43], s90 offen sc1 lds
    s_add_u32 m0, s14, 16384
    s_nop 0
    buffer_load_dwordx4 v36, s[56:59], s91 offen lds
    s_add_u32 m0, s14, 20480
    s_nop 0
    buffer_load_dwordx4 v37, s[56:59], s91 offen lds
    s_add_u32 m0, s14, 24576
    s_nop 0
    buffer_load_dwordx4 v38, s[56:59], s91 offen lds
    s_add_u32 m0, s14, 28672
    s_nop 0
    buffer_load_dwordx4 v39, s[56:59], s91 offen lds
    s_add_u32 s96, s95, 393216
    s_load_dword s29, s[30:31], s96 offset:0
    s_load_dword s29, s[30:31], s96 offset:64
    s_load_dword s29, s[30:31], s96 offset:128
    s_load_dword s29, s[30:31], s96 offset:192
    s_load_dword s29, s[30:31], s96 offset:2048
    s_load_dword s29, s[30:31], s96 offset:2112
    s_load_dword s29, s[30:31], s96 offset:2176
    s_load_dword s29, s[30:31], s96 offset:2240
    s_waitcnt vmcnt(24)
    s_barrier
    s_add_u32 s14, s93, 0
    s_xor_b32 s16, s94, 4
    s_mul_i32 s90, s16, 49152
    s_add_u32 s90, s90, 16384
    s_mul_i32 s91, s16, 458752
    s_add_u32 s91, s91, 131072
    s_add_u32 m0, s14, 0
    s_nop 0
    buffer_load_dwordx4 v32, s[40:43], s90 offen sc1 lds
    s_add_u32 m0, s14, 4096
    s_nop 0
    buffer_load_dwordx4 v33, s[40:43], s90 offen sc1 lds
    s_add_u32 m0, s14, 8192
    s_nop 0
    buffer_load_dwordx4 v34, s[40:43], s90 offen sc1 lds
    s_add_u32 m0, s14, 12288
    s_nop 0
    buffer_load_dwordx4 v35, s[40:43], s90 offen sc1 lds
    s_add_u32 m0, s14, 16384
    s_nop 0
    buffer_load_dwordx4 v36, s[56:59], s91 offen lds
    s_add_u32 m0, s14, 20480
    s_nop 0
    buffer_load_dwordx4 v37, s[56:59], s91 offen lds
    s_add_u32 m0, s14, 24576
    s_nop 0
    buffer_load_dwordx4 v38, s[56:59], s91 offen lds
    s_add_u32 m0, s14, 28672
    s_nop 0
    buffer_load_dwordx4 v39, s[56:59], s91 offen lds
    s_add_u32 s96, s95, 1310720
    s_load_dword s29, s[30:31], s96 offset:0
    s_load_dword s29, s[30:31], s96 offset:64
    s_load_dword s29, s[30:31], s96 offset:128
    s_load_dword s29, s[30:31], s96 offset:192
    s_load_dword s29, s[30:31], s96 offset:2048
    s_load_dword s29, s[30:31], s96 offset:2112
    s_load_dword s29, s[30:31], s96 offset:2176
    s_load_dword s29, s[30:31], s96 offset:2240
    s_waitcnt vmcnt(24)
    s_barrier
    s_add_u32 s14, s93, 32768
    s_xor_b32 s16, s94, 5
    s_mul_i32 s90, s16, 49152
    s_add_u32 s90, s90, 16384
    s_mul_i32 s91, s16, 458752
    s_add_u32 s91, s91, 131072
    s_add_u32 m0, s14, 0
    s_nop 0
    buffer_load_dwordx4 v32, s[40:43], s90 offen sc1 lds
    s_add_u32 m0, s14, 4096
    s_nop 0
    buffer_load_dwordx4 v33, s[40:43], s90 offen sc1 lds
    s_add_u32 m0, s14, 8192
    s_nop 0
    buffer_load_dwordx4 v34, s[40:43], s90 offen sc1 lds
    s_add_u32 m0, s14, 12288
    s_nop 0
    buffer_load_dwordx4 v35, s[40:43], s90 offen sc1 lds
    s_add_u32 m0, s14, 16384
    s_nop 0
    buffer_load_dwordx4 v36, s[56:59], s91 offen lds
    s_add_u32 m0, s14, 20480
    s_nop 0
    buffer_load_dwordx4 v37, s[56:59], s91 offen lds
    s_add_u32 m0, s14, 24576
    s_nop 0
    buffer_load_dwordx4 v38, s[56:59], s91 offen lds
    s_add_u32 m0, s14, 28672
    s_nop 0
    buffer_load_dwordx4 v39, s[56:59], s91 offen lds
    s_add_u32 s96, s95, 2228224
    s_load_dword s29, s[30:31], s96 offset:0
    s_load_dword s29, s[30:31], s96 offset:64
    s_load_dword s29, s[30:31], s96 offset:128
    s_load_dword s29, s[30:31], s96 offset:192
    s_load_dword s29, s[30:31], s96 offset:2048
    s_load_dword s29, s[30:31], s96 offset:2112
    s_load_dword s29, s[30:31], s96 offset:2176
    s_load_dword s29, s[30:31], s96 offset:2240
    s_waitcnt vmcnt(24)
    s_barrier
    s_add_u32 s14, s93, 65536
    s_xor_b32 s16, s94, 6
    s_mul_i32 s90, s16, 49152
    s_add_u32 s90, s90, 16384
    s_mul_i32 s91, s16, 458752
    s_add_u32 s91, s91, 131072
    s_add_u32 m0, s14, 0
    s_nop 0
    buffer_load_dwordx4 v32, s[40:43], s90 offen sc1 lds
    s_add_u32 m0, s14, 4096
    s_nop 0
    buffer_load_dwordx4 v33, s[40:43], s90 offen sc1 lds
    s_add_u32 m0, s14, 8192
    s_nop 0
    buffer_load_dwordx4 v34, s[40:43], s90 offen sc1 lds
    s_add_u32 m0, s14, 12288
    s_nop 0
    buffer_load_dwordx4 v35, s[40:43], s90 offen sc1 lds
    s_add_u32 m0, s14, 16384
    s_nop 0
    buffer_load_dwordx4 v36, s[56:59], s91 offen lds
    s_add_u32 m0, s14, 20480
    s_nop 0
    buffer_load_dwordx4 v37, s[56:59], s91 offen lds
    s_add_u32 m0, s14, 24576
    s_nop 0
    buffer_load_dwordx4 v38, s[56:59], s91 offen lds
    s_add_u32 m0, s14, 28672
    s_nop 0
    buffer_load_dwordx4 v39, s[56:59], s91 offen lds
    s_add_u32 s96, s95, 3145728
    s_load_dword s29, s[30:31], s96 offset:0
    s_load_dword s29, s[30:31], s96 offset:64
    s_load_dword s29, s[30:31], s96 offset:128
    s_load_dword s29, s[30:31], s96 offset:192
    s_load_dword s29, s[30:31], s96 offset:2048
    s_load_dword s29, s[30:31], s96 offset:2112
    s_load_dword s29, s[30:31], s96 offset:2176
    s_load_dword s29, s[30:31], s96 offset:2240
    s_waitcnt vmcnt(24)
    s_barrier
    s_add_u32 s14, s93, 98304
    s_xor_b32 s16, s94, 7
    s_mul_i32 s90, s16, 49152
    s_add_u32 s90, s90, 16384
    s_mul_i32 s91, s16, 458752
    s_add_u32 s91, s91, 131072
    s_add_u32 m0, s14, 0
    s_nop 0
    buffer_load_dwordx4 v32, s[40:43], s90 offen sc1 lds
    s_add_u32 m0, s14, 4096
    s_nop 0
    buffer_load_dwordx4 v33, s[40:43], s90 offen sc1 lds
    s_add_u32 m0, s14, 8192
    s_nop 0
    buffer_load_dwordx4 v34, s[40:43], s90 offen sc1 lds
    s_add_u32 m0, s14, 12288
    s_nop 0
    buffer_load_dwordx4 v35, s[40:43], s90 offen sc1 lds
    s_add_u32 m0, s14, 16384
    s_nop 0
    buffer_load_dwordx4 v36, s[56:59], s91 offen lds
    s_add_u32 m0, s14, 20480
    s_nop 0
    buffer_load_dwordx4 v37, s[56:59], s91 offen lds
    s_add_u32 m0, s14, 24576
    s_nop 0
    buffer_load_dwordx4 v38, s[56:59], s91 offen lds
    s_add_u32 m0, s14, 28672
    s_nop 0
    buffer_load_dwordx4 v39, s[56:59], s91 offen lds
    s_waitcnt vmcnt(24)
    s_barrier
    s_add_u32 s14, s93, 131072
    s_xor_b32 s16, s94, 4
    s_mul_i32 s90, s16, 49152
    s_add_u32 s90, s90, 32768
    s_mul_i32 s91, s16, 458752
    s_add_u32 s91, s91, 262144
    s_add_u32 m0, s14, 0
    s_nop 0
    buffer_load_dwordx4 v32, s[40:43], s90 offen sc1 lds
    s_add_u32 m0, s14, 4096
    s_nop 0
    buffer_load_dwordx4 v33, s[40:43], s90 offen sc1 lds
    s_add_u32 m0, s14, 8192
    s_nop 0
    buffer_load_dwordx4 v34, s[40:43], s90 offen sc1 lds
    s_add_u32 m0, s14, 12288
    s_nop 0
    buffer_load_dwordx4 v35, s[40:43], s90 offen sc1 lds
    s_add_u32 m0, s14, 16384
    s_nop 0
    buffer_load_dwordx4 v36, s[56:59], s91 offen lds
    s_add_u32 m0, s14, 20480
    s_nop 0
    buffer_load_dwordx4 v37, s[56:59], s91 offen lds
    s_add_u32 m0, s14, 24576
    s_nop 0
    buffer_load_dwordx4 v38, s[56:59], s91 offen lds
    s_add_u32 m0, s14, 28672
    s_nop 0
    buffer_load_dwordx4 v39, s[56:59], s91 offen lds
    s_waitcnt vmcnt(24)
    s_barrier
    s_add_u32 s14, s93, 0
    s_xor_b32 s16, s94, 5
    s_mul_i32 s90, s16, 49152
    s_add_u32 s90, s90, 32768
    s_mul_i32 s91, s16, 458752
    s_add_u32 s91, s91, 262144
    s_add_u32 m0, s14, 0
    s_nop 0
    buffer_load_dwordx4 v32, s[40:43], s90 offen sc1 lds
    s_add_u32 m0, s14, 4096
    s_nop 0
    buffer_load_dwordx4 v33, s[40:43], s90 offen sc1 lds
    s_add_u32 m0, s14, 8192
    s_nop 0
    buffer_load_dwordx4 v34, s[40:43], s90 offen sc1 lds
    s_add_u32 m0, s14, 12288
    s_nop 0
    buffer_load_dwordx4 v35, s[40:43], s90 offen sc1 lds
    s_add_u32 m0, s14, 16384
    s_nop 0
    buffer_load_dwordx4 v36, s[56:59], s91 offen lds
    s_add_u32 m0, s14, 20480
    s_nop 0
    buffer_load_dwordx4 v37, s[56:59], s91 offen lds
    s_add_u32 m0, s14, 24576
    s_nop 0
    buffer_load_dwordx4 v38, s[56:59], s91 offen lds
    s_add_u32 m0, s14, 28672
    s_nop 0
    buffer_load_dwordx4 v39, s[56:59], s91 offen lds
    s_waitcnt vmcnt(24)
    s_barrier
    s_add_u32 s14, s93, 32768
    s_xor_b32 s16, s94, 6
    s_mul_i32 s90, s16, 49152
    s_add_u32 s90, s90, 32768
    s_mul_i32 s91, s16, 458752
    s_add_u32 s91, s91, 262144
    s_add_u32 m0, s14, 0
    s_nop 0
    buffer_load_dwordx4 v32, s[40:43], s90 offen sc1 lds
    s_add_u32 m0, s14, 4096
    s_nop 0
    buffer_load_dwordx4 v33, s[40:43], s90 offen sc1 lds
    s_add_u32 m0, s14, 8192
    s_nop 0
    buffer_load_dwordx4 v34, s[40:43], s90 offen sc1 lds
    s_add_u32 m0, s14, 12288
    s_nop 0
    buffer_load_dwordx4 v35, s[40:43], s90 offen sc1 lds
    s_add_u32 m0, s14, 16384
    s_nop 0
    buffer_load_dwordx4 v36, s[56:59], s91 offen lds
    s_add_u32 m0, s14, 20480
    s_nop 0
    buffer_load_dwordx4 v37, s[56:59], s91 offen lds
    s_add_u32 m0, s14, 24576
    s_nop 0
    buffer_load_dwordx4 v38, s[56:59], s91 offen lds
    s_add_u32 m0, s14, 28672
    s_nop 0
    buffer_load_dwordx4 v39, s[56:59], s91 offen lds
    s_waitcnt vmcnt(24)
    s_barrier
    s_add_u32 s14, s93, 65536
    s_xor_b32 s16, s94, 7
    s_mul_i32 s90, s16, 49152
    s_add_u32 s90, s90, 32768
    s_mul_i32 s91, s16, 458752
    s_add_u32 s91, s91, 262144
    s_add_u32 m0, s14, 0
    s_nop 0
    buffer_load_dwordx4 v32, s[40:43], s90 offen sc1 lds
    s_add_u32 m0, s14, 4096
    s_nop 0
    buffer_load_dwordx4 v33, s[40:43], s90 offen sc1 lds
    s_add_u32 m0, s14, 8192
    s_nop 0
    buffer_load_dwordx4 v34, s[40:43], s90 offen sc1 lds
    s_add_u32 m0, s14, 12288
    s_nop 0
    buffer_load_dwordx4 v35, s[40:43], s90 offen sc1 lds
    s_add_u32 m0, s14, 16384
    s_nop 0
    buffer_load_dwordx4 v36, s[56:59], s91 offen lds
    s_add_u32 m0, s14, 20480
    s_nop 0
    buffer_load_dwordx4 v37, s[56:59], s91 offen lds
    s_add_u32 m0, s14, 24576
    s_nop 0
    buffer_load_dwordx4 v38, s[56:59], s91 offen lds
    s_add_u32 m0, s14, 28672
    s_nop 0
    buffer_load_dwordx4 v39, s[56:59], s91 offen lds
    s_waitcnt vmcnt(24)
    s_barrier
    s_add_u32 s14, s93, 98304
    s_mov_b32 s90, 0
    s_mov_b32 s91, 393216
    s_add_u32 m0, s14, 0
    s_nop 0
    buffer_load_dwordx4 v40, s[40:43], s90 offen sc1 lds
    s_add_u32 m0, s14, 4096
    s_nop 0
    buffer_load_dwordx4 v41, s[40:43], s90 offen sc1 lds
    s_add_u32 m0, s14, 8192
    s_nop 0
    buffer_load_dwordx4 v42, s[40:43], s90 offen sc1 lds
    s_add_u32 m0, s14, 12288
    s_nop 0
    buffer_load_dwordx4 v43, s[40:43], s90 offen sc1 lds
    s_add_u32 m0, s14, 16384
    s_nop 0
    buffer_load_dwordx4 v36, s[56:59], s91 offen lds
    s_add_u32 m0, s14, 20480
    s_nop 0
    buffer_load_dwordx4 v37, s[56:59], s91 offen lds
    s_add_u32 m0, s14, 24576
    s_nop 0
    buffer_load_dwordx4 v44, s[56:59], s91 offen lds
    s_add_u32 m0, s14, 28672
    s_nop 0
    buffer_load_dwordx4 v45, s[56:59], s91 offen lds
    buffer_load_dword v29, v58, s[40:43], 0 offen offset:0 sc1
    s_waitcnt vmcnt(25)
    s_barrier
    s_add_u32 s14, s93, 131072
    s_mov_b32 s90, 16384
    s_mov_b32 s91, 1310720
    s_add_u32 m0, s14, 0
    s_nop 0
    buffer_load_dwordx4 v40, s[40:43], s90 offen sc1 lds
    s_add_u32 m0, s14, 4096
    s_nop 0
    buffer_load_dwordx4 v41, s[40:43], s90 offen sc1 lds
    s_add_u32 m0, s14, 8192
    s_nop 0
    buffer_load_dwordx4 v42, s[40:43], s90 offen sc1 lds
    s_add_u32 m0, s14, 12288
    s_nop 0
    buffer_load_dwordx4 v43, s[40:43], s90 offen sc1 lds
    s_add_u32 m0, s14, 16384
    s_nop 0
    buffer_load_dwordx4 v36, s[56:59], s91 offen lds
    s_add_u32 m0, s14, 20480
    s_nop 0
    buffer_load_dwordx4 v37, s[56:59], s91 offen lds
    s_add_u32 m0, s14, 24576
    s_nop 0
    buffer_load_dwordx4 v44, s[56:59], s91 offen lds
    s_add_u32 m0, s14, 28672
    s_nop 0
    buffer_load_dwordx4 v45, s[56:59], s91 offen lds
    s_waitcnt vmcnt(25)
    s_barrier
    s_add_u32 s14, s93, 0
    s_mov_b32 s90, 32768
    s_mov_b32 s91, 2228224
    s_add_u32 m0, s14, 0
    s_nop 0
    buffer_load_dwordx4 v40, s[40:43], s90 offen sc1 lds
    s_add_u32 m0, s14, 4096
    s_nop 0
    buffer_load_dwordx4 v41, s[40:43], s90 offen sc1 lds
    s_add_u32 m0, s14, 8192
    s_nop 0
    buffer_load_dwordx4 v42, s[40:43], s90 offen sc1 lds
    s_add_u32 m0, s14, 12288
    s_nop 0
    buffer_load_dwordx4 v43, s[40:43], s90 offen sc1 lds
    s_add_u32 m0, s14, 16384
    s_nop 0
    buffer_load_dwordx4 v36, s[56:59], s91 offen lds
    s_add_u32 m0, s14, 20480
    s_nop 0
    buffer_load_dwordx4 v37, s[56:59], s91 offen lds
    s_add_u32 m0, s14, 24576
    s_nop 0
    buffer_load_dwordx4 v44, s[56:59], s91 offen lds
    s_add_u32 m0, s14, 28672
    s_nop 0
    buffer_load_dwordx4 v45, s[56:59], s91 offen lds
    s_waitcnt vmcnt(25)
    s_barrier
    s_add_u32 s14, s93, 32768
    s_mov_b32 s90, 49152
    s_mov_b32 s91, 3145728
    s_add_u32 m0, s14, 0
    s_nop 0
    buffer_load_dwordx4 v40, s[40:43], s90 offen sc1 lds
    s_add_u32 m0, s14, 4096
    s_nop 0
    buffer_load_dwordx4 v41, s[40:43], s90 offen sc1 lds
    s_add_u32 m0, s14, 8192
    s_nop 0
    buffer_load_dwordx4 v42, s[40:43], s90 offen sc1 lds
    s_add_u32 m0, s14, 12288
    s_nop 0
    buffer_load_dwordx4 v43, s[40:43], s90 offen sc1 lds
    s_add_u32 m0, s14, 16384
    s_nop 0
    buffer_load_dwordx4 v36, s[56:59], s91 offen lds
    s_add_u32 m0, s14, 20480
    s_nop 0
    buffer_load_dwordx4 v37, s[56:59], s91 offen lds
    s_add_u32 m0, s14, 24576
    s_nop 0
    buffer_load_dwordx4 v44, s[56:59], s91 offen lds
    s_add_u32 m0, s14, 28672
    s_nop 0
    buffer_load_dwordx4 v45, s[56:59], s91 offen lds
    s_waitcnt vmcnt(24)
    s_mov_b32 s76, -1
    s_mov_b32 s23, 0
    s_branch L_pchk_53
L_poll_51:
    buffer_load_dword v29, v58, s[40:43], 0 offen offset:0 sc1
    s_waitcnt vmcnt(0)
L_pchk_53:
    s_add_u32 s23, s23, 1
    v_cmp_ne_u32 vcc, s38, v29
    s_nop 0
    s_and_b64 vcc, vcc, s[76:77]
    s_cbranch_scc0 L_pdone_52
    s_sleep 4
    s_cmp_lt_u32 s23, 200000
    s_cbranch_scc1 L_poll_51
L_pdone_52:
    s_barrier
    s_add_u32 s14, s93, 65536
    s_add_u32 s14, s93, 65536
    s_mov_b32 s90, 0
    s_mov_b32 s91, 0
    s_add_u32 m0, s14, 0
    s_nop 0
    buffer_load_dwordx4 v48, s[40:43], s90 offen sc1 lds
    s_add_u32 m0, s14, 4096
    s_nop 0
    buffer_load_dwordx4 v49, s[40:43], s90 offen sc1 lds
    s_add_u32 m0, s14, 8192
    s_nop 0
    buffer_load_dwordx4 v50, s[40:43], s90 offen sc1 lds
    s_add_u32 m0, s14, 12288
    s_nop 0
    buffer_load_dwordx4 v51, s[40:43], s90 offen sc1 lds
    s_add_u32 m0, s14, 16384
    s_nop 0
    buffer_load_dwordx4 v52, s[40:43], s91 offen sc1 lds
    s_add_u32 m0, s14, 20480
    s_nop 0
    buffer_load_dwordx4 v53, s[40:43], s91 offen sc1 lds
    s_waitcnt vmcnt(22)
    s_barrier
    s_add_u32 s14, s93, 98304
    s_add_u32 s14, s93, 90112
    s_mov_b32 s90, 128
    s_mov_b32 s91, 131072
    s_add_u32 m0, s14, 0
    s_nop 0
    buffer_load_dwordx4 v48, s[40:43], s90 offen sc1 lds
    s_add_u32 m0, s14, 4096
    s_nop 0
    buffer_load_dwordx4 v49, s[40:43], s90 offen sc1 lds
    s_add_u32 m0, s14, 8192
    s_nop 0
    buffer_load_dwordx4 v50, s[40:43], s90 offen sc1 lds
    s_add_u32 m0, s14, 12288
    s_nop 0
    buffer_load_dwordx4 v51, s[40:43], s90 offen sc1 lds
    s_add_u32 m0, s14, 16384
    s_nop 0
    buffer_load_dwordx4 v52, s[40:43], s91 offen sc1 lds
    s_add_u32 m0, s14, 20480
    s_nop 0
    buffer_load_dwordx4 v53, s[40:43], s91 offen sc1 lds
    s_waitcnt vmcnt(20)
    s_barrier
    s_add_u32 s14, s93, 131072
    s_add_u32 s14, s93, 114688
    s_mov_b32 s90, 32768
    s_mov_b32 s91, 262144
    s_add_u32 m0, s14, 0
    s_nop 0
    buffer_load_dwordx4 v48, s[40:43], s90 offen sc1 lds
    s_add_u32 m0, s14, 4096
    s_nop 0
    buffer_load_dwordx4 v49, s[40:43], s90 offen sc1 lds
    s_add_u32 m0, s14, 8192
    s_nop 0
    buffer_load_dwordx4 v50, s[40:43], s90 offen sc1 lds
    s_add_u32 m0, s14, 12288
    s_nop 0
    buffer_load_dwordx4 v51, s[40:43], s90 offen sc1 lds
    s_add_u32 m0, s14, 16384
    s_nop 0
    buffer_load_dwordx4 v52, s[40:43], s91 offen sc1 lds
    s_add_u32 m0, s14, 20480
    s_nop 0
    buffer_load_dwordx4 v53, s[40:43], s91 offen sc1 lds
    s_add_u32 s14, s93, 0
    s_add_u32 s14, s93, 139264
    s_mov_b32 s90, 32896
    s_mov_b32 s91, 393216
    s_add_u32 m0, s14, 0
    s_nop 0
    buffer_load_dwordx4 v48, s[40:43], s90 offen sc1 lds
    s_add_u32 m0, s14, 4096
    s_nop 0
    buffer_load_dwordx4 v49, s[40:43], s90 offen sc1 lds
    s_add_u32 m0, s14, 8192
    s_nop 0
    buffer_load_dwordx4 v50, s[40:43], s90 offen sc1 lds
    s_add_u32 m0, s14, 12288
    s_nop 0
    buffer_load_dwordx4 v51, s[40:43], s90 offen sc1 lds
    s_add_u32 m0, s14, 16384
    s_nop 0
    buffer_load_dwordx4 v52, s[40:43], s91 offen sc1 lds
    s_add_u32 m0, s14, 20480
    s_nop 0
    buffer_load_dwordx4 v53, s[40:43], s91 offen sc1 lds
    s_waitcnt vmcnt(24)
    s_barrier
    s_waitcnt vmcnt(12)
    s_barrier
    s_lshl_b32 s16, s2, 15
    s_lshl_b32 s17, s12, 13
    s_add_u32 s16, s16, s17
    s_add_u32 s16, s16, 0x1c00000
    v_lshlrev_b32 v6, 4, v3
    v_add_u32 v24, s16, v6
    v_add_u32 v25, 4096, v24
    s_add_u32 s17, s17, 32768
    v_add_u32 v6, s17, v6
    v_mov_b32 v28, 0xff
    v_mov_b32 v31, s38
    s_waitcnt vmcnt(0)
    s_barrier
    s_barrier
    s_mov_b32 s23, 0
L_rx_54:
    buffer_load_dwordx4 v[64:67], v24, s[40:43], 0 offen offset:0 sc1
    buffer_load_dwordx4 v[68:71], v24, s[40:43], 0 offen offset:1024 sc1
    buffer_load_dwordx4 v[72:75], v24, s[40:43], 0 offen offset:2048 sc1
    buffer_load_dwordx4 v[76:79], v24, s[40:43], 0 offen offset:3072 sc1
    buffer_load_dwordx4 v[80:83], v25, s[40:43], 0 offen offset:0 sc1
    buffer_load_dwordx4 v[84:87], v25, s[40:43], 0 offen offset:1024 sc1
    buffer_load_dwordx4 v[88:91], v25, s[40:43], 0 offen offset:2048 sc1
    buffer_load_dwordx4 v[92:95], v25, s[40:43], 0 offen offset:3072 sc1
    s_waitcnt vmcnt(0)
    v_or3_b32 v26, v64, v65, v66
    v_bitop3_b32 v27, v64, v65, v66 bitop3:0x80
    v_or3_b32 v26, v26, v67, v68
    v_bitop3_b32 v27, v27, v67, v68 bitop3:0x80
    v_or3_b32 v26, v26, v69, v70
    v_bitop3_b32 v27, v27, v69, v70 bitop3:0x80
    v_or3_b32 v26, v26, v71, v72
    v_bitop3_b32 v27, v27, v71, v72 bitop3:0x80
    v_or3_b32 v26, v26, v73, v74
    v_bitop3_b32 v27, v27, v73, v74 bitop3:0x80
    v_or3_b32 v26, v26, v75, v76
    v_bitop3_b32 v27, v27, v75, v76 bitop3:0x80
    v_or3_b32 v26, v26, v77, v78
    v_bitop3_b32 v27, v27, v77, v78 bitop3:0x80
    v_or3_b32 v26, v26, v79, v80
    v_bitop3_b32 v27, v27, v79, v80 bitop3:0x80
    v_or3_b32 v26, v26, v81, v82
    v_bitop3_b32 v27, v27, v81, v82 bitop3:0x80
    v_or3_b32 v26, v26, v83, v84
    v_bitop3_b32 v27, v27, v83, v84 bitop3:0x80
    v_or3_b32 v26, v26, v85, v86
    v_bitop3_b32 v27, v27, v85, v86 bitop3:0x80
    v_or3_b32 v26, v26, v87, v88
    v_bitop3_b32 v27, v27, v87, v88 bitop3:0x80
    v_or3_b32 v26, v26, v89, v90
    v_bitop3_b32 v27, v27, v89, v90 bitop3:0x80
    v_or3_b32 v26, v26, v91, v92
    v_bitop3_b32 v27, v27, v91, v92 bitop3:0x80
    v_or3_b32 v26, v26, v93, v94
    v_bitop3_b32 v27, v27, v93, v94 bitop3:0x80
    v_or_b32 v26, v26, v95
    v_and_b32 v27, v27, v95
    v_xor_b32 v26, v26, v31
    v_xor_b32 v27, v27, v31
    v_or_b32 v26, v26, v27
    v_and_b32 v26, v26, v28
    v_cmp_ne_u32 vcc, 0, v26
    s_add_u32 s23, s23, 1
    s_nop 3
    s_cbranch_vccz L_rxok_55
    s_sleep 2
    s_cmp_lt_u32 s23, 200000
    s_cbranch_scc1 L_rx_54
L_rxok_55:
    v_bfi_b32 v64, v28, 0, v64
    v_bfi_b32 v65, v28, 0, v65
    v_bfi_b32 v66, v28, 0, v66
    v_bfi_b32 v67, v28, 0, v67
    ds_write_b128 v6, v[64:67] offset:0
    v_bfi_b32 v68, v28, 0, v68
    v_bfi_b32 v69, v28, 0, v69
    v_bfi_b32 v70, v28, 0, v70
    v_bfi_b32 v71, v28, 0, v71
    ds_write_b128 v6, v[68:71] offset:1024
    v_bfi_b32 v72, v28, 0, v72
    v_bfi_b32 v73, v28, 0, v73
    v_bfi_b32 v74, v28, 0, v74
    v_bfi_b32 v75, v28, 0, v75
    ds_write_b128 v6, v[72:75] offset:2048
    v_bfi_b32 v76, v28, 0, v76
    v_bfi_b32 v77, v28, 0, v77
    v_bfi_b32 v78, v28, 0, v78
    v_bfi_b32 v79, v28, 0, v79
    ds_write_b128 v6, v[76:79] offset:3072
    v_bfi_b32 v80, v28, 0, v80
    v_bfi_b32 v81, v28, 0, v81
    v_bfi_b32 v82, v28, 0, v82
    v_bfi_b32 v83, v28, 0, v83
    ds_write_b128 v6, v[80:83] offset:4096
    v_bfi_b32 v84, v28, 0, v84
    v_bfi_b32 v85, v28, 0, v85
    v_bfi_b32 v86, v28, 0, v86
    v_bfi_b32 v87, v28, 0, v87
    ds_write_b128 v6, v[84:87] offset:5120
    v_bfi_b32 v88, v28, 0, v88
    v_bfi_b32 v89, v28, 0, v89
    v_bfi_b32 v90, v28, 0, v90
    v_bfi_b32 v91, v28, 0, v91
    ds_write_b128 v6, v[88:91] offset:6144
    v_bfi_b32 v92, v28, 0, v92
    v_bfi_b32 v93, v28, 0, v93
    v_bfi_b32 v94, v28, 0, v94
    v_bfi_b32 v95, v28, 0, v95
    ds_write_b128 v6, v[92:95] offset:7168
    s_waitcnt lgkmcnt(0)
    s_barrier
    s_endpgm
L_end:
    s_endpgm
.section .rodata,"a"
.p2align 6
.amdhsa_kernel recurrent_scan__spectral_fnet__dense_activation_silu__prompt_kernel
  .amdhsa_next_free_vgpr 256
  .amdhsa_next_free_sgpr 100
  .amdhsa_accum_offset 256
  .amdhsa_group_segment_fixed_size 0
  .amdhsa_kernarg_size 88
  .amdhsa_user_sgpr_count 2
  .amdhsa_user_sgpr_kernarg_segment_ptr 1
  .amdhsa_system_sgpr_workgroup_id_x 1
.end_amdhsa_kernel
```
